```python
import torch

def _softmax(x, axis=-1):
    return torch.softmax(x, dim=axis)
def _gelu(x):
    return torch.nn.functional.gelu(x, approximate="tanh")
def _silu(x):
    return torch.nn.functional.silu(x)
def _sigmoid(x):
    return torch.sigmoid(x)
def _layernorm(x, axis=-1, eps=1e-5):
    m = x.mean(dim=axis, keepdim=True)
    v = x.var(dim=axis, keepdim=True, unbiased=False)
    return (x - m) / torch.sqrt(v + eps)
def _scatter_add(tgt, idx, src, axis=0):
    return tgt.clone().index_add_(axis, idx, src)
def _segment_sum(src, seg, n):
    out = torch.zeros((n,) + src.shape[1:], dtype=src.dtype)
    return out.index_add_(0, seg, src)
def _pad(x, pw):
    flat = tuple(v for pair in reversed(pw) for v in pair)
    return torch.nn.functional.pad(x, flat)

kernel_name = 'gated_mix__spectral_gfnet__dense_activation_silu__prompt'

def setup_inputs():

    _w = (lambda a: (lambda t: t.to(torch.bfloat16) if t.is_floating_point() else t)(torch.as_tensor(a)))
    def _A_setup():
        B, S, D = 1, 2048, 1024
        Df = D // 2 + 1
        return {
            "x": _w((lambda *s: torch.randn(*s, dtype=torch.bfloat16) * 0.05)(B, S, D)),
            "w_r": _w((lambda *s: torch.randn(*s, dtype=torch.bfloat16) * 0.8)(S, Df) * 0.02),
            "w_i": _w((lambda *s: torch.randn(*s, dtype=torch.bfloat16) * 0.8)(S, Df) * 0.02),
        }
    _A_in = _A_setup()

    def _B_setup():
        B, S, D, F = 1, 2048, 1024, 3584
        return {
            "x": _w((lambda *s: torch.randn(*s, dtype=torch.bfloat16) * 0.05)(B, S, D)),
            "w1": _w((lambda *s: torch.randn(*s, dtype=torch.bfloat16) * 3.2)(D, F) * (D ** -0.5)),
            "w2": _w((lambda *s: torch.randn(*s, dtype=torch.bfloat16) * 0.05)(F, D) * (F ** -0.5)),
        }
    _B_in = _B_setup()

    return {
        "A_x": _A_in["x"],
        "A_w_r": _A_in["w_r"],
        "A_w_i": _A_in["w_i"],
        "B_x": _B_in["x"],
        "B_w1": _B_in["w1"],
        "B_w2": _B_in["w2"],
        "gate_w": _w((lambda *s: torch.randn(*s, dtype=torch.bfloat16) * 0.05)(1024) * 16.0),
    }

def reference(A_x, A_w_r, A_w_i, B_x, B_w1, B_w2, gate_w):
    def _A_ref(x, w_r, w_i):
        B, S, D = x.shape
        X = (lambda x, axes=(-2,-1): torch.fft.rfft2(x.float(), dim=axes))(x, axes=(-2, -1))
        W = w_r + 1j * w_i
        X = X * W
        y = (lambda x, s, axes=(-2,-1): torch.fft.irfft2(x, s=s, dim=axes).to(torch.bfloat16))(X, (S, D), axes=(-2, -1))
        return y

    def _B_ref(x, w1, w2):
        h = torch.einsum("bsd,df->bsf", x, w1)
        h = _silu(h)
        out = torch.einsum("bsf,fd->bsd", h, w2)
        return out

    x = A_x
    g = _sigmoid((x * gate_w).sum(-1, keepdims=True))
    a = _A_ref(x, A_w_r, A_w_i)
    b = _B_ref(x, B_w1, B_w2)
    return g * a + (1 - g) * b
```

```asm
; @launch grid=(256,1,1) block=(512,1,1) lds=163840
.amdgcn_target "amdgcn-amd-amdhsa--gfx950"
.text
.globl gated_mix__spectral_gfnet__dense_activation_silu__prompt_kernel
.p2align 8
.type gated_mix__spectral_gfnet__dense_activation_silu__prompt_kernel,@function
gated_mix__spectral_gfnet__dense_activation_silu__prompt_kernel:
  s_cmp_ge_u32 s2, 256
  s_cbranch_scc1 MG_end
  s_load_dwordx2 s[4:5], s[0:1], 0
  s_load_dwordx2 s[94:95], s[0:1], 8
  s_load_dwordx2 s[96:97], s[0:1], 16
  s_load_dwordx2 s[88:89], s[0:1], 32
  s_load_dwordx2 s[90:91], s[0:1], 40
  s_load_dwordx2 s[92:93], s[0:1], 48
  s_load_dwordx2 s[28:29], s[0:1], 56
  s_load_dwordx2 s[98:99], s[0:1], 64
  s_load_dwordx2 s[6:7], s[0:1], 72
  v_lshrrev_b32 v1, 6, v0
  s_nop 0
  v_readfirstlane_b32 s20, v1
  s_and_b32 s33, s2, 3
  s_bfe_u32 s23, s2, 0x10002
  s_lshr_b32 s34, s2, 3
  s_and_b32 s21, s34, 3
  s_lshr_b32 s30, s34, 2
  s_lshl_b32 s24, s21, 2
  s_add_u32 s24, s24, s33
  s_lshl_b32 s22, s23, 3
  s_add_u32 s22, s22, s30
  s_mov_b32 s25, s22
  s_add_u32 s26, s21, s30
  s_and_b32 s26, s26, 3
  s_lshr_b32 s3, s22, 2
  s_add_u32 s3, s3, s33
  s_and_b32 s3, s3, 3
  s_lshl_b32 s27, s33, 1
  s_cmp_eq_u32 s33, 3
  s_cselect_b32 s27, 5, s27
  s_waitcnt lgkmcnt(0)
  s_and_b32 s33, s2, 7
  s_lshl_b32 s33, s33, 3
  s_lshr_b32 s34, s2, 5
  s_add_u32 s33, s33, s34
  s_bfe_u32 s34, s2, 0x20003
  s_add_u32 s35, s34, 1
  s_lshr_b32 s35, s35, 1
  s_lshl_b32 s35, s35, 7
  s_add_u32 s36, s35, s33
  s_sub_u32 s37, s35, s33
  s_bitcmp1_b32 s34, 0
  s_cselect_b32 s0, s37, s36
  s_cmp_eq_u32 s33, 0
  s_cbranch_scc0 MG_gdone
  s_cmp_eq_u32 s34, 2
  s_cselect_b32 s0, 64, s0
  s_cmp_eq_u32 s34, 3
  s_cselect_b32 s0, 192, s0
MG_gdone:
  s_cmp_ge_u32 s20, 4
  s_cbranch_scc1 MG_producer
  v_and_b32 v112, 63, v0
  s_mov_b32 s8, s4
  s_mov_b32 s9, s5
  s_mov_b32 s10, 0x400000
  s_mov_b32 s11, 0x20000
  s_mov_b32 s12, s92
  s_mov_b32 s13, s93
  s_mov_b32 s14, 0x800
  s_mov_b32 s15, 0x20000
  s_lshl_b32 s35, s22, 3
  s_lshl_b32 s36, s20, 1
  s_add_u32 s35, s35, s36
  s_lshl_b32 s35, s35, 15
  s_lshl_b32 s36, s24, 11
  s_add_u32 s35, s35, s36
  v_lshlrev_b32 v152, 5, v112
  buffer_load_dwordx4 v[128:131], v152, s[8:11], s35 offen
  buffer_load_dwordx4 v[132:135], v152, s[8:11], s35 offen offset:16
  s_add_u32 s35, s35, 32768
  buffer_load_dwordx4 v[136:139], v152, s[8:11], s35 offen
  buffer_load_dwordx4 v[140:143], v152, s[8:11], s35 offen offset:16
  buffer_load_dwordx4 v[144:147], v152, s[12:15], 0 offen
  buffer_load_dwordx4 v[148:151], v152, s[12:15], 0 offen offset:16
  s_mov_b32 s16, s98
  s_mov_b32 s17, s99
  s_mov_b32 s18, 0x100
  s_mov_b32 s19, 0x20000
  v_mov_b32 v159, 0
  s_or_b32 s35, s2, s20
  s_cmp_eq_u32 s35, 0
  s_cbranch_scc0 C1_notag
  s_memrealtime s[36:37]
  s_waitcnt lgkmcnt(0)
  s_and_b32 s36, s36, 0x0fffffff
  s_or_b32 s36, s36, 1
  v_mov_b32 v158, s36
  s_mov_b64 exec, 1
  buffer_store_dword v158, v159, s[16:19], 0 offen sc1
  s_mov_b64 exec, -1
C1_notag:
  s_cmp_eq_u32 s20, 3
  s_cbranch_scc0 C1_nopf
  s_getpc_b64 s[36:37]
C1_pc:
  s_sub_u32 s36, s36, C1_pc-gated_mix__spectral_gfnet__dense_activation_silu__prompt_kernel
  s_subb_u32 s37, s37, 0
  s_lshr_b32 s35, s2, 3
  s_lshl_b32 s35, s35, 11
  v_lshlrev_b32 v153, 7, v112
  v_add_u32 v153, s35, v153
  v_min_u32 v153, MG_end-gated_mix__spectral_gfnet__dense_activation_silu__prompt_kernel, v153
  s_mov_b64 exec, 0xffff
  global_load_dword v154, v153, s[36:37]
  s_mov_b64 exec, -1
C1_nopf:
  s_lshr_b32 s31, s20, 1
  s_and_b32 s32, s20, 1
  v_lshrrev_b32 v1, 4, v112
  v_bfe_u32 v2, v112, 2, 2
  v_and_b32 v3, 3, v112
  v_lshl_add_u32 v4, v1, 3, v2
  v_mul_u32_u24 v4, 448, v4
  v_lshl_add_u32 v4, v3, 3, v4
  s_mul_i32 s33, s31, 224
  s_add_u32 s33, s33, 16384
  v_add_u32 v4, s33, v4
  v_and_b32 v5, 1, v1
  v_lshlrev_b32 v5, 5, v5
  v_add_u32 v6, v4, v5
  v_sub_u32 v7, v4, v5
  s_cmp_eq_u32 s31, 0
  s_cselect_b64 vcc, -1, 0
  v_cndmask_b32 v113, v7, v6, vcc
  v_cndmask_b32 v114, v6, v7, vcc
  v_and_b32 v4, 15, v112
  v_lshrrev_b32 v5, 1, v4
  v_xor_b32 v5, v5, v1
  v_lshlrev_b32 v5, 4, v5
  v_lshl_add_u32 v5, v4, 7, v5
  s_lshl_b32 s33, s32, 13
  v_add_u32 v115, s33, v5
  v_xor_b32 v116, 64, v115
  v_and_b32 v16, 31, v112
  v_lshrrev_b32 v17, 5, v112
  v_cvt_f32_u32 v16, v16
  v_cvt_f32_u32 v17, v17
  v_lshlrev_b32 v21, 4, v112
  v_add_u32 v21, 135168, v21
  v_mul_f32 v18, 0x3a800000, v16
  v_mul_f32 v19, 4.0, v17
  v_mul_f32 v19, v19, v18
  s_lshl_b32 s35, s20, 3
  v_cvt_f32_u32 v20, s35
  v_fma_f32 v19, v20, v18, v19
  v_add_f32 v20, 0x3e800000, v19
  v_fmamk_f32 v24, v18, 0x00000000, v19
  v_fmamk_f32 v28, v18, 0x00000000, v20
  v_fmamk_f32 v25, v18, 0x3f800000, v19
  v_fmamk_f32 v29, v18, 0x3f800000, v20
  v_fmamk_f32 v26, v18, 0x40000000, v19
  v_fmamk_f32 v30, v18, 0x40000000, v20
  v_fmamk_f32 v27, v18, 0x40400000, v19
  v_fmamk_f32 v31, v18, 0x40400000, v20
  v_cos_f32 v24, v24
  v_cos_f32 v25, v25
  v_cos_f32 v26, v26
  v_cos_f32 v27, v27
  v_cos_f32 v28, v28
  v_cos_f32 v29, v29
  v_cos_f32 v30, v30
  v_cos_f32 v31, v31
  s_lshl_b32 s35, s20, 10
  v_add_u32 v22, s35, v21
  ds_write_b128 v22, v[24:27] offset:7168
  ds_write_b128 v22, v[28:31] offset:11264
  s_cmp_eq_u32 s20, 3
  s_cbranch_scc1 C1_cm
  v_mul_f32 v18, 0x3d000000, v16
  v_mul_f32 v19, 4.0, v17
  v_mul_f32 v19, v19, v18
  s_mov_b32 s35, 0
  s_cmp_eq_u32 s20, 1
  s_cselect_b32 s35, 0x3e800000, s35
  s_cmp_eq_u32 s20, 2
  s_cselect_b32 s35, 0xbe800000, s35
  v_add_f32 v20, s35, v19
  s_lshl_b32 s35, s20, 11
  v_add_u32 v22, s35, v21
  v_fmamk_f32 v24, v18, 0x00000000, v20
  v_fmamk_f32 v25, v18, 0x3f800000, v20
  v_fmamk_f32 v26, v18, 0x40000000, v20
  v_fmamk_f32 v27, v18, 0x40400000, v20
  v_fmamk_f32 v28, v18, 0x41000000, v20
  v_fmamk_f32 v29, v18, 0x41100000, v20
  v_fmamk_f32 v30, v18, 0x41200000, v20
  v_fmamk_f32 v31, v18, 0x41300000, v20
  v_cos_f32 v24, v24
  v_cos_f32 v25, v25
  v_cos_f32 v26, v26
  v_cos_f32 v27, v27
  v_cos_f32 v28, v28
  v_cos_f32 v29, v29
  v_cos_f32 v30, v30
  v_cos_f32 v31, v31
  s_nop 0
  v_cvt_pk_bf16_f32 v32, v24, v25
  v_cvt_pk_bf16_f32 v33, v26, v27
  v_cvt_pk_bf16_f32 v34, v28, v29
  v_cvt_pk_bf16_f32 v35, v30, v31
  ds_write_b128 v22, v[32:35] offset:0
  s_nop 0
  v_fmamk_f32 v24, v18, 0x41800000, v20
  v_fmamk_f32 v25, v18, 0x41880000, v20
  v_fmamk_f32 v26, v18, 0x41900000, v20
  v_fmamk_f32 v27, v18, 0x41980000, v20
  v_fmamk_f32 v28, v18, 0x41c00000, v20
  v_fmamk_f32 v29, v18, 0x41c80000, v20
  v_fmamk_f32 v30, v18, 0x41d00000, v20
  v_fmamk_f32 v31, v18, 0x41d80000, v20
  v_cos_f32 v24, v24
  v_cos_f32 v25, v25
  v_cos_f32 v26, v26
  v_cos_f32 v27, v27
  v_cos_f32 v28, v28
  v_cos_f32 v29, v29
  v_cos_f32 v30, v30
  v_cos_f32 v31, v31
  s_nop 0
  v_cvt_pk_bf16_f32 v32, v24, v25
  v_cvt_pk_bf16_f32 v33, v26, v27
  v_cvt_pk_bf16_f32 v34, v28, v29
  v_cvt_pk_bf16_f32 v35, v30, v31
  ds_write_b128 v22, v[32:35] offset:1024
  s_nop 0
  s_branch C1_cm_done
C1_cm:
  s_and_b32 s35, s0, 127
  s_sub_u32 s36, 128, s35
  s_cmp_gt_u32 s35, 64
  s_cselect_b32 s36, s36, s35
  s_cselect_b32 s37, 0xbf800000, 1.0
  s_and_b32 s35, s36, 63
  s_cmp_eq_u32 s35, 0
  s_cselect_b32 s37, 0, s37
  v_and_b32 v16, 15, v112
  v_lshrrev_b32 v17, 4, v112
  v_lshrrev_b32 v18, 1, v16
  v_and_b32 v18, 3, v18
  v_lshlrev_b32 v19, 9, v18
  v_add_u32 v19, s0, v19
  v_and_b32 v20, 1, v16
  v_cvt_f32_u32 v20, v20
  v_mul_f32 v20, 0x3e800000, v20
  s_cmp_eq_u32 s0, 0
  s_cbranch_scc0 C1_gen_cols
  v_mov_b32 v23, 256
  v_cmp_eq_u32 vcc, 2, v18
  s_nop 1
  v_cndmask_b32 v19, v19, v23, vcc
  v_mov_b32 v23, 768
  v_cmp_eq_u32 vcc, 3, v18
  s_nop 1
  v_cndmask_b32 v19, v19, v23, vcc
  v_mov_b32 v23, 1024
  v_mov_b32 v22, 0
  v_cmp_eq_u32 vcc, 1, v16
  s_nop 1
  v_cndmask_b32 v19, v19, v23, vcc
  v_cndmask_b32 v20, v20, v22, vcc
C1_gen_cols:
  v_cmp_gt_u32 vcc, 8, v16
  v_mov_b32 v32, 0
  v_mov_b32 v22, 1.0
  v_mov_b32 v23, s37
  v_cndmask_b32 v22, v32, v22, vcc
  v_cndmask_b32 v23, v32, v23, vcc
  v_lshlrev_b32 v32, 1, v17
  v_add_u32 v24, 0, v32
  v_mul_u32_u24 v24, v24, v19
  v_and_b32 v24, 2047, v24
  v_cvt_f32_u32 v24, v24
  v_fmamk_f32 v24, v24, 0x3a000000, v20
  v_add_u32 v25, 0, v32
  v_mul_u32_u24 v25, v25, v19
  v_and_b32 v25, 2047, v25
  v_cvt_f32_u32 v25, v25
  v_fmamk_f32 v25, v25, 0x3a000000, v20
  v_add_f32 v25, 0xbe800000, v25
  v_add_u32 v26, 1, v32
  v_mul_u32_u24 v26, v26, v19
  v_and_b32 v26, 2047, v26
  v_cvt_f32_u32 v26, v26
  v_fmamk_f32 v26, v26, 0x3a000000, v20
  v_add_u32 v27, 1, v32
  v_mul_u32_u24 v27, v27, v19
  v_and_b32 v27, 2047, v27
  v_cvt_f32_u32 v27, v27
  v_fmamk_f32 v27, v27, 0x3a000000, v20
  v_add_f32 v27, 0xbe800000, v27
  v_add_u32 v28, 8, v32
  v_mul_u32_u24 v28, v28, v19
  v_and_b32 v28, 2047, v28
  v_cvt_f32_u32 v28, v28
  v_fmamk_f32 v28, v28, 0x3a000000, v20
  v_add_u32 v29, 8, v32
  v_mul_u32_u24 v29, v29, v19
  v_and_b32 v29, 2047, v29
  v_cvt_f32_u32 v29, v29
  v_fmamk_f32 v29, v29, 0x3a000000, v20
  v_add_f32 v29, 0xbe800000, v29
  v_add_u32 v30, 9, v32
  v_mul_u32_u24 v30, v30, v19
  v_and_b32 v30, 2047, v30
  v_cvt_f32_u32 v30, v30
  v_fmamk_f32 v30, v30, 0x3a000000, v20
  v_add_u32 v31, 9, v32
  v_mul_u32_u24 v31, v31, v19
  v_and_b32 v31, 2047, v31
  v_cvt_f32_u32 v31, v31
  v_fmamk_f32 v31, v31, 0x3a000000, v20
  v_add_f32 v31, 0xbe800000, v31
  v_cos_f32 v24, v24
  v_cos_f32 v25, v25
  v_cos_f32 v26, v26
  v_cos_f32 v27, v27
  v_cos_f32 v28, v28
  v_cos_f32 v29, v29
  v_cos_f32 v30, v30
  v_cos_f32 v31, v31
  s_nop 0
  v_mul_f32 v24, v24, v22
  v_mul_f32 v25, v25, v23
  v_mul_f32 v26, v26, v22
  v_mul_f32 v27, v27, v23
  v_mul_f32 v28, v28, v22
  v_mul_f32 v29, v29, v23
  v_mul_f32 v30, v30, v22
  v_mul_f32 v31, v31, v23
  v_cvt_pk_bf16_f32 v32, v24, v25
  v_cvt_pk_bf16_f32 v33, v26, v27
  v_cvt_pk_bf16_f32 v34, v28, v29
  v_cvt_pk_bf16_f32 v35, v30, v31
  ds_write_b128 v21, v[32:35] offset:6144
C1_cm_done:
  v_lshrrev_b32 v16, 4, v112
  v_bfe_u32 v17, v112, 2, 2
  v_and_b32 v18, 3, v112
  v_lshrrev_b32 v19, 1, v16
  v_lshlrev_b32 v19, 4, v19
  v_and_b32 v20, 1, v16
  v_lshl_add_u32 v19, v20, 3, v19
  v_and_b32 v21, 1, v17
  v_lshrrev_b32 v22, 1, v17
  v_lshl_add_u32 v21, v22, 2, v21
  v_add_u32 v21, v19, v21
  v_lshlrev_b32 v23, 2, v20
  v_lshl_add_u32 v23, v22, 1, v23
  v_lshrrev_b32 v24, 1, v18
  v_and_b32 v25, 1, v18
  v_add_u32 v26, 0, v24
  v_add_u32 v27, 0, v23
  v_xor_b32 v26, v26, v27
  v_lshlrev_b32 v26, 4, v26
  v_lshl_add_u32 v26, v25, 3, v26
  v_add_u32 v27, 0, v21
  v_lshl_add_u32 v117, v27, 7, v26
  v_add_u32 v26, 0, v24
  v_add_u32 v27, 1, v23
  v_xor_b32 v26, v26, v27
  v_lshlrev_b32 v26, 4, v26
  v_lshl_add_u32 v26, v25, 3, v26
  v_add_u32 v27, 2, v21
  v_lshl_add_u32 v118, v27, 7, v26
  v_add_u32 v26, 2, v24
  v_add_u32 v27, 0, v23
  v_xor_b32 v26, v26, v27
  v_lshlrev_b32 v26, 4, v26
  v_lshl_add_u32 v26, v25, 3, v26
  v_add_u32 v27, 0, v21
  v_lshl_add_u32 v119, v27, 7, v26
  v_add_u32 v26, 2, v24
  v_add_u32 v27, 1, v23
  v_xor_b32 v26, v26, v27
  v_lshlrev_b32 v26, 4, v26
  v_lshl_add_u32 v26, v25, 3, v26
  v_add_u32 v27, 2, v21
  v_lshl_add_u32 v120, v27, 7, v26
  v_add_u32 v26, 4, v24
  v_add_u32 v27, 0, v23
  v_xor_b32 v26, v26, v27
  v_lshlrev_b32 v26, 4, v26
  v_lshl_add_u32 v26, v25, 3, v26
  v_add_u32 v27, 0, v21
  v_lshl_add_u32 v121, v27, 7, v26
  v_add_u32 v26, 4, v24
  v_add_u32 v27, 1, v23
  v_xor_b32 v26, v26, v27
  v_lshlrev_b32 v26, 4, v26
  v_lshl_add_u32 v26, v25, 3, v26
  v_add_u32 v27, 2, v21
  v_lshl_add_u32 v122, v27, 7, v26
  v_add_u32 v26, 6, v24
  v_add_u32 v27, 0, v23
  v_xor_b32 v26, v26, v27
  v_lshlrev_b32 v26, 4, v26
  v_lshl_add_u32 v26, v25, 3, v26
  v_add_u32 v27, 0, v21
  v_lshl_add_u32 v123, v27, 7, v26
  v_add_u32 v26, 6, v24
  v_add_u32 v27, 1, v23
  v_xor_b32 v26, v26, v27
  v_lshlrev_b32 v26, 4, v26
  v_lshl_add_u32 v26, v25, 3, v26
  v_add_u32 v27, 2, v21
  v_lshl_add_u32 v124, v27, 7, v26
  v_and_b32 v17, 15, v112
  v_and_b32 v125, 1, v16
  v_lshlrev_b32 v125, 4, v125
  v_lshrrev_b32 v18, 1, v16
  v_lshl_add_u32 v125, v18, 3, v125
  v_lshlrev_b32 v125, 1, v125
  v_lshl_add_u32 v125, v17, 11, v125
  v_cvt_f32_u32 v19, v19
  s_lshl_b32 s35, s20, 5
  s_add_u32 s35, s35, 0
  v_add_u32 v20, s35, v17
  v_lshrrev_b32 v21, 1, v20
  v_and_b32 v22, 1, v20
  v_cvt_f32_u32 v21, v21
  v_cvt_f32_u32 v22, v22
  v_mul_f32 v22, 0x3e800000, v22
  v_cmp_eq_u32 vcc, 1, v20
  v_mov_b32 v23, 0x42800000
  v_mov_b32 v18, 0
  v_cndmask_b32 v21, v21, v23, vcc
  v_cndmask_b32 v22, v22, v18, vcc
  v_mul_f32 v21, 0x3c000000, v21
  v_fma_f32 v23, v21, v19, v22
  v_fmamk_f32 v24, v21, 0x00000000, v23
  v_fmamk_f32 v25, v21, 0x3f800000, v23
  v_fmamk_f32 v26, v21, 0x40800000, v23
  v_fmamk_f32 v27, v21, 0x40a00000, v23
  v_fmamk_f32 v28, v21, 0x40000000, v23
  v_fmamk_f32 v29, v21, 0x40400000, v23
  v_fmamk_f32 v30, v21, 0x40c00000, v23
  v_fmamk_f32 v31, v21, 0x40e00000, v23
  v_cos_f32 v24, v24
  v_cos_f32 v25, v25
  v_cos_f32 v26, v26
  v_cos_f32 v27, v27
  v_cos_f32 v28, v28
  v_cos_f32 v29, v29
  v_cos_f32 v30, v30
  v_cos_f32 v31, v31
  s_nop 0
  v_cvt_pk_bf16_f32 v32, v24, v25
  v_cvt_pk_bf16_f32 v33, v26, v27
  v_cvt_pk_bf16_f32 v34, v28, v29
  v_cvt_pk_bf16_f32 v35, v30, v31
  v_accvgpr_write_b32 a64, v32
  v_accvgpr_write_b32 a65, v33
  v_accvgpr_write_b32 a66, v34
  v_accvgpr_write_b32 a67, v35
  v_fmamk_f32 v24, v21, 0x42000000, v23
  v_fmamk_f32 v25, v21, 0x42040000, v23
  v_fmamk_f32 v26, v21, 0x42100000, v23
  v_fmamk_f32 v27, v21, 0x42140000, v23
  v_fmamk_f32 v28, v21, 0x42080000, v23
  v_fmamk_f32 v29, v21, 0x420c0000, v23
  v_fmamk_f32 v30, v21, 0x42180000, v23
  v_fmamk_f32 v31, v21, 0x421c0000, v23
  v_cos_f32 v24, v24
  v_cos_f32 v25, v25
  v_cos_f32 v26, v26
  v_cos_f32 v27, v27
  v_cos_f32 v28, v28
  v_cos_f32 v29, v29
  v_cos_f32 v30, v30
  v_cos_f32 v31, v31
  s_nop 0
  v_cvt_pk_bf16_f32 v32, v24, v25
  v_cvt_pk_bf16_f32 v33, v26, v27
  v_cvt_pk_bf16_f32 v34, v28, v29
  v_cvt_pk_bf16_f32 v35, v30, v31
  v_accvgpr_write_b32 a68, v32
  v_accvgpr_write_b32 a69, v33
  v_accvgpr_write_b32 a70, v34
  v_accvgpr_write_b32 a71, v35
  v_fmamk_f32 v24, v21, 0x42800000, v23
  v_fmamk_f32 v25, v21, 0x42820000, v23
  v_fmamk_f32 v26, v21, 0x42880000, v23
  v_fmamk_f32 v27, v21, 0x428a0000, v23
  v_fmamk_f32 v28, v21, 0x42840000, v23
  v_fmamk_f32 v29, v21, 0x42860000, v23
  v_fmamk_f32 v30, v21, 0x428c0000, v23
  v_fmamk_f32 v31, v21, 0x428e0000, v23
  v_cos_f32 v24, v24
  v_cos_f32 v25, v25
  v_cos_f32 v26, v26
  v_cos_f32 v27, v27
  v_cos_f32 v28, v28
  v_cos_f32 v29, v29
  v_cos_f32 v30, v30
  v_cos_f32 v31, v31
  s_nop 0
  v_cvt_pk_bf16_f32 v32, v24, v25
  v_cvt_pk_bf16_f32 v33, v26, v27
  v_cvt_pk_bf16_f32 v34, v28, v29
  v_cvt_pk_bf16_f32 v35, v30, v31
  v_accvgpr_write_b32 a72, v32
  v_accvgpr_write_b32 a73, v33
  v_accvgpr_write_b32 a74, v34
  v_accvgpr_write_b32 a75, v35
  v_fmamk_f32 v24, v21, 0x42c00000, v23
  v_fmamk_f32 v25, v21, 0x42c20000, v23
  v_fmamk_f32 v26, v21, 0x42c80000, v23
  v_fmamk_f32 v27, v21, 0x42ca0000, v23
  v_fmamk_f32 v28, v21, 0x42c40000, v23
  v_fmamk_f32 v29, v21, 0x42c60000, v23
  v_fmamk_f32 v30, v21, 0x42cc0000, v23
  v_fmamk_f32 v31, v21, 0x42ce0000, v23
  v_cos_f32 v24, v24
  v_cos_f32 v25, v25
  v_cos_f32 v26, v26
  v_cos_f32 v27, v27
  v_cos_f32 v28, v28
  v_cos_f32 v29, v29
  v_cos_f32 v30, v30
  v_cos_f32 v31, v31
  s_nop 0
  v_cvt_pk_bf16_f32 v32, v24, v25
  v_cvt_pk_bf16_f32 v33, v26, v27
  v_cvt_pk_bf16_f32 v34, v28, v29
  v_cvt_pk_bf16_f32 v35, v30, v31
  v_accvgpr_write_b32 a76, v32
  v_accvgpr_write_b32 a77, v33
  v_accvgpr_write_b32 a78, v34
  v_accvgpr_write_b32 a79, v35
  s_lshl_b32 s35, s20, 5
  s_add_u32 s35, s35, 16
  v_add_u32 v20, s35, v17
  v_lshrrev_b32 v21, 1, v20
  v_and_b32 v22, 1, v20
  v_cvt_f32_u32 v21, v21
  v_cvt_f32_u32 v22, v22
  v_mul_f32 v22, 0x3e800000, v22
  v_cmp_eq_u32 vcc, 1, v20
  v_mov_b32 v23, 0x42800000
  v_mov_b32 v18, 0
  v_cndmask_b32 v21, v21, v23, vcc
  v_cndmask_b32 v22, v22, v18, vcc
  v_mul_f32 v21, 0x3c000000, v21
  v_fma_f32 v23, v21, v19, v22
  v_fmamk_f32 v24, v21, 0x00000000, v23
  v_fmamk_f32 v25, v21, 0x3f800000, v23
  v_fmamk_f32 v26, v21, 0x40800000, v23
  v_fmamk_f32 v27, v21, 0x40a00000, v23
  v_fmamk_f32 v28, v21, 0x40000000, v23
  v_fmamk_f32 v29, v21, 0x40400000, v23
  v_fmamk_f32 v30, v21, 0x40c00000, v23
  v_fmamk_f32 v31, v21, 0x40e00000, v23
  v_cos_f32 v24, v24
  v_cos_f32 v25, v25
  v_cos_f32 v26, v26
  v_cos_f32 v27, v27
  v_cos_f32 v28, v28
  v_cos_f32 v29, v29
  v_cos_f32 v30, v30
  v_cos_f32 v31, v31
  s_nop 0
  v_cvt_pk_bf16_f32 v32, v24, v25
  v_cvt_pk_bf16_f32 v33, v26, v27
  v_cvt_pk_bf16_f32 v34, v28, v29
  v_cvt_pk_bf16_f32 v35, v30, v31
  v_accvgpr_write_b32 a80, v32
  v_accvgpr_write_b32 a81, v33
  v_accvgpr_write_b32 a82, v34
  v_accvgpr_write_b32 a83, v35
  v_fmamk_f32 v24, v21, 0x42000000, v23
  v_fmamk_f32 v25, v21, 0x42040000, v23
  v_fmamk_f32 v26, v21, 0x42100000, v23
  v_fmamk_f32 v27, v21, 0x42140000, v23
  v_fmamk_f32 v28, v21, 0x42080000, v23
  v_fmamk_f32 v29, v21, 0x420c0000, v23
  v_fmamk_f32 v30, v21, 0x42180000, v23
  v_fmamk_f32 v31, v21, 0x421c0000, v23
  v_cos_f32 v24, v24
  v_cos_f32 v25, v25
  v_cos_f32 v26, v26
  v_cos_f32 v27, v27
  v_cos_f32 v28, v28
  v_cos_f32 v29, v29
  v_cos_f32 v30, v30
  v_cos_f32 v31, v31
  s_nop 0
  v_cvt_pk_bf16_f32 v32, v24, v25
  v_cvt_pk_bf16_f32 v33, v26, v27
  v_cvt_pk_bf16_f32 v34, v28, v29
  v_cvt_pk_bf16_f32 v35, v30, v31
  v_accvgpr_write_b32 a84, v32
  v_accvgpr_write_b32 a85, v33
  v_accvgpr_write_b32 a86, v34
  v_accvgpr_write_b32 a87, v35
  v_fmamk_f32 v24, v21, 0x42800000, v23
  v_fmamk_f32 v25, v21, 0x42820000, v23
  v_fmamk_f32 v26, v21, 0x42880000, v23
  v_fmamk_f32 v27, v21, 0x428a0000, v23
  v_fmamk_f32 v28, v21, 0x42840000, v23
  v_fmamk_f32 v29, v21, 0x42860000, v23
  v_fmamk_f32 v30, v21, 0x428c0000, v23
  v_fmamk_f32 v31, v21, 0x428e0000, v23
  v_cos_f32 v24, v24
  v_cos_f32 v25, v25
  v_cos_f32 v26, v26
  v_cos_f32 v27, v27
  v_cos_f32 v28, v28
  v_cos_f32 v29, v29
  v_cos_f32 v30, v30
  v_cos_f32 v31, v31
  s_nop 0
  v_cvt_pk_bf16_f32 v32, v24, v25
  v_cvt_pk_bf16_f32 v33, v26, v27
  v_cvt_pk_bf16_f32 v34, v28, v29
  v_cvt_pk_bf16_f32 v35, v30, v31
  v_accvgpr_write_b32 a88, v32
  v_accvgpr_write_b32 a89, v33
  v_accvgpr_write_b32 a90, v34
  v_accvgpr_write_b32 a91, v35
  v_fmamk_f32 v24, v21, 0x42c00000, v23
  v_fmamk_f32 v25, v21, 0x42c20000, v23
  v_fmamk_f32 v26, v21, 0x42c80000, v23
  v_fmamk_f32 v27, v21, 0x42ca0000, v23
  v_fmamk_f32 v28, v21, 0x42c40000, v23
  v_fmamk_f32 v29, v21, 0x42c60000, v23
  v_fmamk_f32 v30, v21, 0x42cc0000, v23
  v_fmamk_f32 v31, v21, 0x42ce0000, v23
  v_cos_f32 v24, v24
  v_cos_f32 v25, v25
  v_cos_f32 v26, v26
  v_cos_f32 v27, v27
  v_cos_f32 v28, v28
  v_cos_f32 v29, v29
  v_cos_f32 v30, v30
  v_cos_f32 v31, v31
  s_nop 0
  v_cvt_pk_bf16_f32 v32, v24, v25
  v_cvt_pk_bf16_f32 v33, v26, v27
  v_cvt_pk_bf16_f32 v34, v28, v29
  v_cvt_pk_bf16_f32 v35, v30, v31
  v_accvgpr_write_b32 a92, v32
  v_accvgpr_write_b32 a93, v33
  v_accvgpr_write_b32 a94, v34
  v_accvgpr_write_b32 a95, v35
  s_lshl_b32 s45, s3, 2
  s_add_u32 s45, s45, s26
  s_lshl_b32 s46, s24, 7
  s_lshl_b32 s35, s20, 5
  s_add_u32 s46, s46, s35
  s_lshl_b32 s46, s46, 11
  s_lshl_b32 s35, s45, 7
  s_add_u32 s46, s46, s35
  v_mov_b32 v0, 0
  v_mov_b32 v1, 0
  v_mov_b32 v2, 0
  v_mov_b32 v3, 0
  v_mov_b32 v4, 0
  v_mov_b32 v5, 0
  v_mov_b32 v6, 0
  v_mov_b32 v7, 0
  v_mov_b32 v8, 0
  v_mov_b32 v9, 0
  v_mov_b32 v10, 0
  v_mov_b32 v11, 0
  v_mov_b32 v12, 0
  v_mov_b32 v13, 0
  v_mov_b32 v14, 0
  v_mov_b32 v15, 0
  v_mov_b32 v16, 0
  v_mov_b32 v17, 0
  v_mov_b32 v18, 0
  v_mov_b32 v19, 0
  v_mov_b32 v20, 0
  v_mov_b32 v21, 0
  v_mov_b32 v22, 0
  v_mov_b32 v23, 0
  v_mov_b32 v24, 0
  v_mov_b32 v25, 0
  v_mov_b32 v26, 0
  v_mov_b32 v27, 0
  v_mov_b32 v28, 0
  v_mov_b32 v29, 0
  v_mov_b32 v30, 0
  v_mov_b32 v31, 0
  v_mov_b32 v32, 0
  v_mov_b32 v33, 0
  v_mov_b32 v34, 0
  v_mov_b32 v35, 0
  v_mov_b32 v36, 0
  v_mov_b32 v37, 0
  v_mov_b32 v38, 0
  v_mov_b32 v39, 0
  v_mov_b32 v40, 0
  v_mov_b32 v41, 0
  v_mov_b32 v42, 0
  v_mov_b32 v43, 0
  v_mov_b32 v44, 0
  v_mov_b32 v45, 0
  v_mov_b32 v46, 0
  v_mov_b32 v47, 0
  v_mov_b32 v48, 0
  v_mov_b32 v49, 0
  v_mov_b32 v50, 0
  v_mov_b32 v51, 0
  v_mov_b32 v52, 0
  v_mov_b32 v53, 0
  v_mov_b32 v54, 0
  v_mov_b32 v55, 0
  v_mov_b32 v56, 0
  v_mov_b32 v57, 0
  v_mov_b32 v58, 0
  v_mov_b32 v59, 0
  v_mov_b32 v60, 0
  v_mov_b32 v61, 0
  v_mov_b32 v62, 0
  v_mov_b32 v63, 0
  v_mov_b32 v64, 0
  v_mov_b32 v65, 0
  v_mov_b32 v66, 0
  v_mov_b32 v67, 0
  v_mov_b32 v68, 0
  v_mov_b32 v69, 0
  v_mov_b32 v70, 0
  v_mov_b32 v71, 0
  v_mov_b32 v72, 0
  v_mov_b32 v73, 0
  v_mov_b32 v74, 0
  v_mov_b32 v75, 0
  v_mov_b32 v76, 0
  v_mov_b32 v77, 0
  v_mov_b32 v78, 0
  v_mov_b32 v79, 0
  v_mov_b32 v80, 0
  v_mov_b32 v81, 0
  v_mov_b32 v82, 0
  v_mov_b32 v83, 0
  v_mov_b32 v84, 0
  v_mov_b32 v85, 0
  v_mov_b32 v86, 0
  v_mov_b32 v87, 0
  v_mov_b32 v88, 0
  v_mov_b32 v89, 0
  v_mov_b32 v90, 0
  v_mov_b32 v91, 0
  v_mov_b32 v92, 0
  v_mov_b32 v93, 0
  v_mov_b32 v94, 0
  v_mov_b32 v95, 0
  v_mov_b32 v96, 0
  v_mov_b32 v97, 0
  v_mov_b32 v98, 0
  v_mov_b32 v99, 0
  v_mov_b32 v100, 0
  v_mov_b32 v101, 0
  v_mov_b32 v102, 0
  v_mov_b32 v103, 0
  v_mov_b32 v104, 0
  v_mov_b32 v105, 0
  v_mov_b32 v106, 0
  v_mov_b32 v107, 0
  v_mov_b32 v108, 0
  v_mov_b32 v109, 0
  v_mov_b32 v110, 0
  v_mov_b32 v111, 0
  s_waitcnt vmcnt(0)
  v_lshlrev_b32 v153, 16, v128
  v_and_b32 v154, 0xffff0000, v128
  v_lshlrev_b32 v155, 16, v144
  v_and_b32 v156, 0xffff0000, v144
  v_mul_f32 v153, v153, v155
  v_mul_f32 v154, v154, v156
  v_cvt_pk_bf16_f32 v153, v153, v154
  v_lshlrev_b32 v155, 16, v153
  v_and_b32 v156, 0xffff0000, v153
  v_add_f32 v157, v155, v156
  v_lshlrev_b32 v153, 16, v129
  v_and_b32 v154, 0xffff0000, v129
  v_lshlrev_b32 v155, 16, v145
  v_and_b32 v156, 0xffff0000, v145
  v_mul_f32 v153, v153, v155
  v_mul_f32 v154, v154, v156
  v_cvt_pk_bf16_f32 v153, v153, v154
  v_lshlrev_b32 v155, 16, v153
  v_and_b32 v156, 0xffff0000, v153
  v_add_f32 v157, v157, v155
  v_add_f32 v157, v157, v156
  v_lshlrev_b32 v153, 16, v130
  v_and_b32 v154, 0xffff0000, v130
  v_lshlrev_b32 v155, 16, v146
  v_and_b32 v156, 0xffff0000, v146
  v_mul_f32 v153, v153, v155
  v_mul_f32 v154, v154, v156
  v_cvt_pk_bf16_f32 v153, v153, v154
  v_lshlrev_b32 v155, 16, v153
  v_and_b32 v156, 0xffff0000, v153
  v_add_f32 v157, v157, v155
  v_add_f32 v157, v157, v156
  v_lshlrev_b32 v153, 16, v131
  v_and_b32 v154, 0xffff0000, v131
  v_lshlrev_b32 v155, 16, v147
  v_and_b32 v156, 0xffff0000, v147
  v_mul_f32 v153, v153, v155
  v_mul_f32 v154, v154, v156
  v_cvt_pk_bf16_f32 v153, v153, v154
  v_lshlrev_b32 v155, 16, v153
  v_and_b32 v156, 0xffff0000, v153
  v_add_f32 v157, v157, v155
  v_add_f32 v157, v157, v156
  v_lshlrev_b32 v153, 16, v132
  v_and_b32 v154, 0xffff0000, v132
  v_lshlrev_b32 v155, 16, v148
  v_and_b32 v156, 0xffff0000, v148
  v_mul_f32 v153, v153, v155
  v_mul_f32 v154, v154, v156
  v_cvt_pk_bf16_f32 v153, v153, v154
  v_lshlrev_b32 v155, 16, v153
  v_and_b32 v156, 0xffff0000, v153
  v_add_f32 v157, v157, v155
  v_add_f32 v157, v157, v156
  v_lshlrev_b32 v153, 16, v133
  v_and_b32 v154, 0xffff0000, v133
  v_lshlrev_b32 v155, 16, v149
  v_and_b32 v156, 0xffff0000, v149
  v_mul_f32 v153, v153, v155
  v_mul_f32 v154, v154, v156
  v_cvt_pk_bf16_f32 v153, v153, v154
  v_lshlrev_b32 v155, 16, v153
  v_and_b32 v156, 0xffff0000, v153
  v_add_f32 v157, v157, v155
  v_add_f32 v157, v157, v156
  v_lshlrev_b32 v153, 16, v134
  v_and_b32 v154, 0xffff0000, v134
  v_lshlrev_b32 v155, 16, v150
  v_and_b32 v156, 0xffff0000, v150
  v_mul_f32 v153, v153, v155
  v_mul_f32 v154, v154, v156
  v_cvt_pk_bf16_f32 v153, v153, v154
  v_lshlrev_b32 v155, 16, v153
  v_and_b32 v156, 0xffff0000, v153
  v_add_f32 v157, v157, v155
  v_add_f32 v157, v157, v156
  v_lshlrev_b32 v153, 16, v135
  v_and_b32 v154, 0xffff0000, v135
  v_lshlrev_b32 v155, 16, v151
  v_and_b32 v156, 0xffff0000, v151
  v_mul_f32 v153, v153, v155
  v_mul_f32 v154, v154, v156
  v_cvt_pk_bf16_f32 v153, v153, v154
  v_lshlrev_b32 v155, 16, v153
  v_and_b32 v156, 0xffff0000, v153
  v_add_f32 v157, v157, v155
  v_add_f32 v157, v157, v156
  v_lshlrev_b32 v153, 16, v136
  v_and_b32 v154, 0xffff0000, v136
  v_lshlrev_b32 v155, 16, v144
  v_and_b32 v156, 0xffff0000, v144
  v_mul_f32 v153, v153, v155
  v_mul_f32 v154, v154, v156
  v_cvt_pk_bf16_f32 v153, v153, v154
  v_lshlrev_b32 v155, 16, v153
  v_and_b32 v156, 0xffff0000, v153
  v_add_f32 v158, v155, v156
  v_lshlrev_b32 v153, 16, v137
  v_and_b32 v154, 0xffff0000, v137
  v_lshlrev_b32 v155, 16, v145
  v_and_b32 v156, 0xffff0000, v145
  v_mul_f32 v153, v153, v155
  v_mul_f32 v154, v154, v156
  v_cvt_pk_bf16_f32 v153, v153, v154
  v_lshlrev_b32 v155, 16, v153
  v_and_b32 v156, 0xffff0000, v153
  v_add_f32 v158, v158, v155
  v_add_f32 v158, v158, v156
  v_lshlrev_b32 v153, 16, v138
  v_and_b32 v154, 0xffff0000, v138
  v_lshlrev_b32 v155, 16, v146
  v_and_b32 v156, 0xffff0000, v146
  v_mul_f32 v153, v153, v155
  v_mul_f32 v154, v154, v156
  v_cvt_pk_bf16_f32 v153, v153, v154
  v_lshlrev_b32 v155, 16, v153
  v_and_b32 v156, 0xffff0000, v153
  v_add_f32 v158, v158, v155
  v_add_f32 v158, v158, v156
  v_lshlrev_b32 v153, 16, v139
  v_and_b32 v154, 0xffff0000, v139
  v_lshlrev_b32 v155, 16, v147
  v_and_b32 v156, 0xffff0000, v147
  v_mul_f32 v153, v153, v155
  v_mul_f32 v154, v154, v156
  v_cvt_pk_bf16_f32 v153, v153, v154
  v_lshlrev_b32 v155, 16, v153
  v_and_b32 v156, 0xffff0000, v153
  v_add_f32 v158, v158, v155
  v_add_f32 v158, v158, v156
  v_lshlrev_b32 v153, 16, v140
  v_and_b32 v154, 0xffff0000, v140
  v_lshlrev_b32 v155, 16, v148
  v_and_b32 v156, 0xffff0000, v148
  v_mul_f32 v153, v153, v155
  v_mul_f32 v154, v154, v156
  v_cvt_pk_bf16_f32 v153, v153, v154
  v_lshlrev_b32 v155, 16, v153
  v_and_b32 v156, 0xffff0000, v153
  v_add_f32 v158, v158, v155
  v_add_f32 v158, v158, v156
  v_lshlrev_b32 v153, 16, v141
  v_and_b32 v154, 0xffff0000, v141
  v_lshlrev_b32 v155, 16, v149
  v_and_b32 v156, 0xffff0000, v149
  v_mul_f32 v153, v153, v155
  v_mul_f32 v154, v154, v156
  v_cvt_pk_bf16_f32 v153, v153, v154
  v_lshlrev_b32 v155, 16, v153
  v_and_b32 v156, 0xffff0000, v153
  v_add_f32 v158, v158, v155
  v_add_f32 v158, v158, v156
  v_lshlrev_b32 v153, 16, v142
  v_and_b32 v154, 0xffff0000, v142
  v_lshlrev_b32 v155, 16, v150
  v_and_b32 v156, 0xffff0000, v150
  v_mul_f32 v153, v153, v155
  v_mul_f32 v154, v154, v156
  v_cvt_pk_bf16_f32 v153, v153, v154
  v_lshlrev_b32 v155, 16, v153
  v_and_b32 v156, 0xffff0000, v153
  v_add_f32 v158, v158, v155
  v_add_f32 v158, v158, v156
  v_lshlrev_b32 v153, 16, v143
  v_and_b32 v154, 0xffff0000, v143
  v_lshlrev_b32 v155, 16, v151
  v_and_b32 v156, 0xffff0000, v151
  v_mul_f32 v153, v153, v155
  v_mul_f32 v154, v154, v156
  v_cvt_pk_bf16_f32 v153, v153, v154
  v_lshlrev_b32 v155, 16, v153
  v_and_b32 v156, 0xffff0000, v153
  v_add_f32 v158, v158, v155
  v_add_f32 v158, v158, v156
  s_nop 0
  v_add_f32_dpp v157, v157, v157 row_shr:1 row_mask:0xf bank_mask:0xf bound_ctrl:0
  v_add_f32_dpp v158, v158, v158 row_shr:1 row_mask:0xf bank_mask:0xf bound_ctrl:0
  s_nop 0
  v_add_f32_dpp v157, v157, v157 row_shr:2 row_mask:0xf bank_mask:0xf bound_ctrl:0
  v_add_f32_dpp v158, v158, v158 row_shr:2 row_mask:0xf bank_mask:0xf bound_ctrl:0
  s_nop 0
  v_add_f32_dpp v157, v157, v157 row_shr:4 row_mask:0xf bank_mask:0xf bound_ctrl:0
  v_add_f32_dpp v158, v158, v158 row_shr:4 row_mask:0xf bank_mask:0xf bound_ctrl:0
  s_nop 0
  v_add_f32_dpp v157, v157, v157 row_shr:8 row_mask:0xf bank_mask:0xf bound_ctrl:0
  v_add_f32_dpp v158, v158, v158 row_shr:8 row_mask:0xf bank_mask:0xf bound_ctrl:0
  s_nop 0
  v_add_f32_dpp v157, v157, v157 row_bcast:15 row_mask:0xa bank_mask:0xf
  v_add_f32_dpp v158, v158, v158 row_bcast:15 row_mask:0xa bank_mask:0xf
  s_nop 0
  v_add_f32_dpp v157, v157, v157 row_bcast:31 row_mask:0xc bank_mask:0xf
  v_add_f32_dpp v158, v158, v158 row_bcast:31 row_mask:0xc bank_mask:0xf
  s_nop 0
  v_readlane_b32 s36, v157, 63
  v_readlane_b32 s37, v158, 63
  s_nop 3
  v_mov_b32 v153, s36
  v_mov_b32 v154, s37
  v_cmp_eq_u32 vcc, 1, v112
  s_nop 1
  v_cndmask_b32 v153, v153, v154, vcc
  v_cvt_pk_bf16_f32 v153, v153, v153
  v_and_b32 v153, 0xffff0000, v153
  v_mul_f32 v154, 0xbfb8aa3b, v153
  v_exp_f32 v154, v154
  s_nop 0
  v_add_f32 v154, 1.0, v154
  v_rcp_f32 v154, v154
  s_nop 0
  v_cvt_pk_bf16_f32 v154, v154, v154
  v_and_b32 v154, 0xffff0000, v154
  v_sub_f32 v155, 1.0, v154
  v_cvt_pk_bf16_f32 v155, v155, v155
  v_and_b32 v155, 0xffff0000, v155
  s_add_u32 s12, s6, 25165824
  s_addc_u32 s13, s7, 0
  s_mov_b32 s14, 0x4000
  s_mov_b32 s15, 0x20000
  s_lshl_b32 s36, s24, 7
  s_lshl_b32 s37, s22, 3
  s_add_u32 s36, s36, s37
  s_lshl_b32 s37, s20, 1
  s_add_u32 s36, s36, s37
  s_lshl_b32 s36, s36, 2
  s_add_u32 s37, s36, 8192
  v_lshlrev_b32 v156, 2, v112
  s_mov_b64 exec, 3
  buffer_store_dword v155, v156, s[12:15], s36 offen sc1
  buffer_store_dword v154, v156, s[12:15], s37 offen sc1
  s_mov_b64 exec, -1
  s_mov_b32 s40, 0
  s_mov_b32 s42, 8
  s_mov_b32 s43, 45056
  s_mov_b32 s44, 4294877184
  s_waitcnt lgkmcnt(0)
  s_barrier
  ds_read_b64_tr_b16 a[0:1], v117 offset:0
  ds_read_b64_tr_b16 a[2:3], v118 offset:0
  ds_read_b64_tr_b16 a[4:5], v117 offset:4096
  ds_read_b64_tr_b16 a[6:7], v118 offset:4096
  ds_read_b64_tr_b16 a[8:9], v117 offset:8192
  ds_read_b64_tr_b16 a[10:11], v118 offset:8192
  ds_read_b64_tr_b16 a[12:13], v117 offset:12288
  ds_read_b64_tr_b16 a[14:15], v118 offset:12288
  ds_read_b64_tr_b16 a[16:17], v119 offset:0
  ds_read_b64_tr_b16 a[18:19], v120 offset:0
  ds_read_b64_tr_b16 a[20:21], v119 offset:4096
  ds_read_b64_tr_b16 a[22:23], v120 offset:4096
  ds_read_b64_tr_b16 a[24:25], v119 offset:8192
  ds_read_b64_tr_b16 a[26:27], v120 offset:8192
  ds_read_b64_tr_b16 a[28:29], v119 offset:12288
  ds_read_b64_tr_b16 a[30:31], v120 offset:12288
  ds_read_b64_tr_b16 a[32:33], v121 offset:0
  ds_read_b64_tr_b16 a[34:35], v122 offset:0
  ds_read_b64_tr_b16 a[36:37], v121 offset:4096
  ds_read_b64_tr_b16 a[38:39], v122 offset:4096
  ds_read_b64_tr_b16 a[40:41], v121 offset:8192
  ds_read_b64_tr_b16 a[42:43], v122 offset:8192
  ds_read_b64_tr_b16 a[44:45], v121 offset:12288
  ds_read_b64_tr_b16 a[46:47], v122 offset:12288
  ds_read_b64_tr_b16 a[48:49], v123 offset:0
  ds_read_b64_tr_b16 a[50:51], v124 offset:0
  ds_read_b64_tr_b16 a[52:53], v123 offset:4096
  ds_read_b64_tr_b16 a[54:55], v124 offset:4096
  ds_read_b64_tr_b16 a[56:57], v123 offset:8192
  ds_read_b64_tr_b16 a[58:59], v124 offset:8192
  ds_read_b64_tr_b16 a[60:61], v123 offset:12288
  ds_read_b64_tr_b16 a[62:63], v124 offset:12288
  s_add_u32 s8, s6, 16777216
  s_addc_u32 s9, s7, 0
  s_mov_b32 s10, 0x400000
  s_mov_b32 s11, 0x20000
  s_waitcnt lgkmcnt(0)
  v_mfma_f32_16x16x32_bf16 v[128:131], a[0:3], a[64:67], 0
  v_mfma_f32_16x16x32_bf16 v[132:135], a[16:19], a[64:67], 0
  v_mfma_f32_16x16x32_bf16 v[136:139], a[32:35], a[64:67], 0
  v_mfma_f32_16x16x32_bf16 v[140:143], a[48:51], a[64:67], 0
  v_mfma_f32_16x16x32_bf16 v[144:147], a[0:3], a[80:83], 0
  v_mfma_f32_16x16x32_bf16 v[148:151], a[16:19], a[80:83], 0
  v_mfma_f32_16x16x32_bf16 v[152:155], a[32:35], a[80:83], 0
  v_mfma_f32_16x16x32_bf16 v[156:159], a[48:51], a[80:83], 0
  v_mfma_f32_16x16x32_bf16 v[128:131], a[4:7], a[68:71], v[128:131]
  v_mfma_f32_16x16x32_bf16 v[132:135], a[20:23], a[68:71], v[132:135]
  v_mfma_f32_16x16x32_bf16 v[136:139], a[36:39], a[68:71], v[136:139]
  v_mfma_f32_16x16x32_bf16 v[140:143], a[52:55], a[68:71], v[140:143]
  v_mfma_f32_16x16x32_bf16 v[144:147], a[4:7], a[84:87], v[144:147]
  v_mfma_f32_16x16x32_bf16 v[148:151], a[20:23], a[84:87], v[148:151]
  v_mfma_f32_16x16x32_bf16 v[152:155], a[36:39], a[84:87], v[152:155]
  v_mfma_f32_16x16x32_bf16 v[156:159], a[52:55], a[84:87], v[156:159]
  v_mfma_f32_16x16x32_bf16 v[128:131], a[8:11], a[72:75], v[128:131]
  v_mfma_f32_16x16x32_bf16 v[132:135], a[24:27], a[72:75], v[132:135]
  v_mfma_f32_16x16x32_bf16 v[136:139], a[40:43], a[72:75], v[136:139]
  v_mfma_f32_16x16x32_bf16 v[140:143], a[56:59], a[72:75], v[140:143]
  v_mfma_f32_16x16x32_bf16 v[144:147], a[8:11], a[88:91], v[144:147]
  v_mfma_f32_16x16x32_bf16 v[148:151], a[24:27], a[88:91], v[148:151]
  v_mfma_f32_16x16x32_bf16 v[152:155], a[40:43], a[88:91], v[152:155]
  v_mfma_f32_16x16x32_bf16 v[156:159], a[56:59], a[88:91], v[156:159]
  v_mfma_f32_16x16x32_bf16 v[128:131], a[12:15], a[76:79], v[128:131]
  v_mfma_f32_16x16x32_bf16 v[132:135], a[28:31], a[76:79], v[132:135]
  v_mfma_f32_16x16x32_bf16 v[136:139], a[44:47], a[76:79], v[136:139]
  v_mfma_f32_16x16x32_bf16 v[140:143], a[60:63], a[76:79], v[140:143]
  v_mfma_f32_16x16x32_bf16 v[144:147], a[12:15], a[92:95], v[144:147]
  v_mfma_f32_16x16x32_bf16 v[148:151], a[28:31], a[92:95], v[148:151]
  v_mfma_f32_16x16x32_bf16 v[152:155], a[44:47], a[92:95], v[152:155]
  v_mfma_f32_16x16x32_bf16 v[156:159], a[60:63], a[92:95], v[156:159]
  ds_read_b128 a[64:67], v115 offset:0
  ds_read_b128 a[68:71], v116 offset:0
  ds_read_b128 a[72:75], v115 offset:2048
  ds_read_b128 a[76:79], v116 offset:2048
  ds_read_b128 a[80:83], v115 offset:4096
  ds_read_b128 a[84:87], v116 offset:4096
  ds_read_b128 a[88:91], v115 offset:6144
  ds_read_b128 a[92:95], v116 offset:6144
  ds_read_b64_tr_b16 a[0:1], v113 offset:0
  ds_read_b64_tr_b16 a[2:3], v113 offset:1792
  ds_read_b64_tr_b16 a[4:5], v113 offset:14336
  ds_read_b64_tr_b16 a[6:7], v113 offset:16128
  ds_read_b64_tr_b16 a[8:9], v114 offset:32
  ds_read_b64_tr_b16 a[10:11], v114 offset:1824
  ds_read_b64_tr_b16 a[12:13], v114 offset:14368
  ds_read_b64_tr_b16 a[14:15], v114 offset:16160
  ds_read_b64_tr_b16 a[16:17], v113 offset:64
  ds_read_b64_tr_b16 a[18:19], v113 offset:1856
  ds_read_b64_tr_b16 a[20:21], v113 offset:14400
  ds_read_b64_tr_b16 a[22:23], v113 offset:16192
  ds_read_b64_tr_b16 a[24:25], v114 offset:96
  ds_read_b64_tr_b16 a[26:27], v114 offset:1888
  ds_read_b64_tr_b16 a[28:29], v114 offset:14432
  ds_read_b64_tr_b16 a[30:31], v114 offset:16224
  ds_read_b64_tr_b16 a[32:33], v113 offset:128
  ds_read_b64_tr_b16 a[34:35], v113 offset:1920
  ds_read_b64_tr_b16 a[36:37], v113 offset:14464
  ds_read_b64_tr_b16 a[38:39], v113 offset:16256
  ds_read_b64_tr_b16 a[48:49], v113 offset:192
  ds_read_b64_tr_b16 a[50:51], v113 offset:1984
  ds_read_b64_tr_b16 a[52:53], v113 offset:14528
  ds_read_b64_tr_b16 a[54:55], v113 offset:16320
  v_cvt_pk_bf16_f32 v128, v128, v129
  v_cvt_pk_bf16_f32 v129, v130, v131
  v_cvt_pk_bf16_f32 v130, v132, v133
  v_cvt_pk_bf16_f32 v131, v134, v135
  s_nop 1
  v_permlane16_swap_b32 v128, v130
  v_permlane16_swap_b32 v129, v131
  s_add_u32 s35, s46, 0
  buffer_store_dwordx4 v[128:131], v125, s[8:11], s35 offen offset:0 sc1
  v_cvt_pk_bf16_f32 v136, v136, v137
  v_cvt_pk_bf16_f32 v137, v138, v139
  v_cvt_pk_bf16_f32 v138, v140, v141
  v_cvt_pk_bf16_f32 v139, v142, v143
  s_nop 1
  v_permlane16_swap_b32 v136, v138
  v_permlane16_swap_b32 v137, v139
  s_add_u32 s35, s46, 0
  buffer_store_dwordx4 v[136:139], v125, s[8:11], s35 offen offset:64 sc1
  v_cvt_pk_bf16_f32 v144, v144, v145
  v_cvt_pk_bf16_f32 v145, v146, v147
  v_cvt_pk_bf16_f32 v146, v148, v149
  v_cvt_pk_bf16_f32 v147, v150, v151
  s_nop 1
  v_permlane16_swap_b32 v144, v146
  v_permlane16_swap_b32 v145, v147
  s_add_u32 s35, s46, 32768
  buffer_store_dwordx4 v[144:147], v125, s[8:11], s35 offen offset:0 sc1
  v_cvt_pk_bf16_f32 v152, v152, v153
  v_cvt_pk_bf16_f32 v153, v154, v155
  v_cvt_pk_bf16_f32 v154, v156, v157
  v_cvt_pk_bf16_f32 v155, v158, v159
  s_nop 1
  v_permlane16_swap_b32 v152, v154
  v_permlane16_swap_b32 v153, v155
  s_add_u32 s35, s46, 32768
  buffer_store_dwordx4 v[152:155], v125, s[8:11], s35 offen offset:64 sc1
  s_add_u32 s16, s6, 25231360
  s_addc_u32 s17, s7, 0
  s_mov_b32 s18, 0xa000
  s_mov_b32 s19, 0x20000
  s_lshr_b32 s35, s2, 4
  s_lshl_b32 s35, s35, 7
  s_and_b32 s36, s2, 15
  s_lshl_b32 s36, s36, 2
  s_add_u32 s47, s35, s36
  s_add_u32 s35, s47, 32768
  v_mov_b32 v125, s35
  s_mov_b32 s12, s98
  s_mov_b32 s13, s99
  s_mov_b32 s14, 0x100
  s_mov_b32 s15, 0x20000
  v_mov_b32 v124, 0
  buffer_load_dword v126, v124, s[12:15], 0 offen sc1
  s_mov_b32 s54, 132
  s_getreg_b32 s55, hwreg(HW_REG_XCC_ID)
  s_and_b32 s55, s55, 15
  s_lshl_b32 s55, s55, 28
  s_waitcnt lgkmcnt(0)
.p2align 6
C1_loop:
  v_mfma_f32_16x16x32_bf16 v[0:3], a[0:3], a[64:67], v[0:3]
  ds_read_b64_tr_b16 a[40:41], v114 offset:160
  ds_read_b64_tr_b16 a[42:43], v114 offset:1952
  v_mfma_f32_16x16x32_bf16 v[0:3], a[4:7], a[68:71], v[0:3]
  ds_read_b64_tr_b16 a[44:45], v114 offset:14496
  ds_read_b64_tr_b16 a[46:47], v114 offset:16288
  v_mfma_f32_16x16x32_bf16 v[4:7], a[0:3], a[72:75], v[4:7]
  v_mfma_f32_16x16x32_bf16 v[4:7], a[4:7], a[76:79], v[4:7]
  v_mfma_f32_16x16x32_bf16 v[8:11], a[0:3], a[80:83], v[8:11]
  s_add_u32 s40, s40, 1
  v_mfma_f32_16x16x32_bf16 v[8:11], a[4:7], a[84:87], v[8:11]
  s_cmp_eq_u32 s40, 3
  v_mfma_f32_16x16x32_bf16 v[12:15], a[0:3], a[88:91], v[12:15]
  s_cselect_b32 s41, s44, s43
  v_mfma_f32_16x16x32_bf16 v[12:15], a[4:7], a[92:95], v[12:15]
  s_cselect_b32 s40, 0, s40
  v_add_u32 v113, s41, v113
  v_add_u32 v114, s41, v114
  v_add_u32 v115, s41, v115
  v_add_u32 v116, s41, v116
  s_waitcnt lgkmcnt(0)
  s_barrier
  v_mfma_f32_16x16x32_bf16 v[16:19], a[8:11], a[64:67], v[16:19]
  ds_read_b128 v[128:131], v115 offset:0
  v_mfma_f32_16x16x32_bf16 v[16:19], a[12:15], a[68:71], v[16:19]
  ds_read_b128 v[132:135], v116 offset:0
  v_mfma_f32_16x16x32_bf16 v[20:23], a[8:11], a[72:75], v[20:23]
  ds_read_b128 v[136:139], v115 offset:2048
  v_mfma_f32_16x16x32_bf16 v[20:23], a[12:15], a[76:79], v[20:23]
  ds_read_b128 v[140:143], v116 offset:2048
  v_mfma_f32_16x16x32_bf16 v[24:27], a[8:11], a[80:83], v[24:27]
  ds_read_b128 v[144:147], v115 offset:4096
  v_mfma_f32_16x16x32_bf16 v[24:27], a[12:15], a[84:87], v[24:27]
  ds_read_b128 v[148:151], v116 offset:4096
  v_mfma_f32_16x16x32_bf16 v[28:31], a[8:11], a[88:91], v[28:31]
  ds_read_b128 v[152:155], v115 offset:6144
  v_mfma_f32_16x16x32_bf16 v[28:31], a[12:15], a[92:95], v[28:31]
  ds_read_b128 v[156:159], v116 offset:6144
  v_mfma_f32_16x16x32_bf16 v[32:35], a[16:19], a[64:67], v[32:35]
  ds_read_b64_tr_b16 a[0:1], v113 offset:0
  v_mfma_f32_16x16x32_bf16 v[32:35], a[20:23], a[68:71], v[32:35]
  ds_read_b64_tr_b16 a[2:3], v113 offset:1792
  v_mfma_f32_16x16x32_bf16 v[36:39], a[16:19], a[72:75], v[36:39]
  ds_read_b64_tr_b16 a[4:5], v113 offset:14336
  v_mfma_f32_16x16x32_bf16 v[36:39], a[20:23], a[76:79], v[36:39]
  ds_read_b64_tr_b16 a[6:7], v113 offset:16128
  v_mfma_f32_16x16x32_bf16 v[40:43], a[16:19], a[80:83], v[40:43]
  ds_read_b64_tr_b16 a[56:57], v113 offset:192
  v_mfma_f32_16x16x32_bf16 v[40:43], a[20:23], a[84:87], v[40:43]
  ds_read_b64_tr_b16 a[58:59], v113 offset:1984
  v_mfma_f32_16x16x32_bf16 v[44:47], a[16:19], a[88:91], v[44:47]
  ds_read_b64_tr_b16 a[60:61], v113 offset:14528
  v_mfma_f32_16x16x32_bf16 v[44:47], a[20:23], a[92:95], v[44:47]
  ds_read_b64_tr_b16 a[62:63], v113 offset:16320
  v_mfma_f32_16x16x32_bf16 v[48:51], a[24:27], a[64:67], v[48:51]
  ds_read_b64_tr_b16 a[8:9], v114 offset:32
  v_mfma_f32_16x16x32_bf16 v[48:51], a[28:31], a[68:71], v[48:51]
  ds_read_b64_tr_b16 a[10:11], v114 offset:1824
  v_mfma_f32_16x16x32_bf16 v[52:55], a[24:27], a[72:75], v[52:55]
  ds_read_b64_tr_b16 a[12:13], v114 offset:14368
  v_mfma_f32_16x16x32_bf16 v[52:55], a[28:31], a[76:79], v[52:55]
  ds_read_b64_tr_b16 a[14:15], v114 offset:16160
  v_mfma_f32_16x16x32_bf16 v[56:59], a[24:27], a[80:83], v[56:59]
  v_mfma_f32_16x16x32_bf16 v[56:59], a[28:31], a[84:87], v[56:59]
  v_mfma_f32_16x16x32_bf16 v[60:63], a[24:27], a[88:91], v[60:63]
  v_mfma_f32_16x16x32_bf16 v[60:63], a[28:31], a[92:95], v[60:63]
  v_mfma_f32_16x16x32_bf16 v[64:67], a[32:35], a[64:67], v[64:67]
  ds_read_b64_tr_b16 a[16:17], v113 offset:64
  v_mfma_f32_16x16x32_bf16 v[64:67], a[36:39], a[68:71], v[64:67]
  ds_read_b64_tr_b16 a[18:19], v113 offset:1856
  v_mfma_f32_16x16x32_bf16 v[68:71], a[32:35], a[72:75], v[68:71]
  ds_read_b64_tr_b16 a[20:21], v113 offset:14400
  v_mfma_f32_16x16x32_bf16 v[68:71], a[36:39], a[76:79], v[68:71]
  ds_read_b64_tr_b16 a[22:23], v113 offset:16192
  v_mfma_f32_16x16x32_bf16 v[72:75], a[32:35], a[80:83], v[72:75]
  v_mfma_f32_16x16x32_bf16 v[72:75], a[36:39], a[84:87], v[72:75]
  v_mfma_f32_16x16x32_bf16 v[76:79], a[32:35], a[88:91], v[76:79]
  v_mfma_f32_16x16x32_bf16 v[76:79], a[36:39], a[92:95], v[76:79]
  v_mfma_f32_16x16x32_bf16 v[80:83], a[40:43], a[64:67], v[80:83]
  ds_read_b64_tr_b16 a[24:25], v114 offset:96
  v_mfma_f32_16x16x32_bf16 v[80:83], a[44:47], a[68:71], v[80:83]
  ds_read_b64_tr_b16 a[26:27], v114 offset:1888
  v_mfma_f32_16x16x32_bf16 v[84:87], a[40:43], a[72:75], v[84:87]
  ds_read_b64_tr_b16 a[28:29], v114 offset:14432
  v_mfma_f32_16x16x32_bf16 v[84:87], a[44:47], a[76:79], v[84:87]
  ds_read_b64_tr_b16 a[30:31], v114 offset:16224
  v_mfma_f32_16x16x32_bf16 v[88:91], a[40:43], a[80:83], v[88:91]
  v_mfma_f32_16x16x32_bf16 v[88:91], a[44:47], a[84:87], v[88:91]
  v_mfma_f32_16x16x32_bf16 v[92:95], a[40:43], a[88:91], v[92:95]
  v_mfma_f32_16x16x32_bf16 v[92:95], a[44:47], a[92:95], v[92:95]
  v_mfma_f32_16x16x32_bf16 v[96:99], a[48:51], a[64:67], v[96:99]
  ds_read_b64_tr_b16 a[32:33], v113 offset:128
  v_mfma_f32_16x16x32_bf16 v[96:99], a[52:55], a[68:71], v[96:99]
  ds_read_b64_tr_b16 a[34:35], v113 offset:1920
  v_mfma_f32_16x16x32_bf16 v[100:103], a[48:51], a[72:75], v[100:103]
  ds_read_b64_tr_b16 a[36:37], v113 offset:14464
  v_mfma_f32_16x16x32_bf16 v[100:103], a[52:55], a[76:79], v[100:103]
  ds_read_b64_tr_b16 a[38:39], v113 offset:16256
  v_mfma_f32_16x16x32_bf16 v[104:107], a[48:51], a[80:83], v[104:107]
  v_mfma_f32_16x16x32_bf16 v[104:107], a[52:55], a[84:87], v[104:107]
  v_mfma_f32_16x16x32_bf16 v[108:111], a[48:51], a[88:91], v[108:111]
  v_mfma_f32_16x16x32_bf16 v[108:111], a[52:55], a[92:95], v[108:111]
  v_mfma_f32_16x16x32_bf16 v[0:3], a[0:3], v[128:131], v[0:3]
  ds_read_b64_tr_b16 a[40:41], v114 offset:160
  ds_read_b64_tr_b16 a[42:43], v114 offset:1952
  v_mfma_f32_16x16x32_bf16 v[0:3], a[4:7], v[132:135], v[0:3]
  ds_read_b64_tr_b16 a[44:45], v114 offset:14496
  ds_read_b64_tr_b16 a[46:47], v114 offset:16288
  v_mfma_f32_16x16x32_bf16 v[4:7], a[0:3], v[136:139], v[4:7]
  v_mfma_f32_16x16x32_bf16 v[4:7], a[4:7], v[140:143], v[4:7]
  v_mfma_f32_16x16x32_bf16 v[8:11], a[0:3], v[144:147], v[8:11]
  s_add_u32 s40, s40, 1
  v_mfma_f32_16x16x32_bf16 v[8:11], a[4:7], v[148:151], v[8:11]
  s_cmp_eq_u32 s40, 3
  v_mfma_f32_16x16x32_bf16 v[12:15], a[0:3], v[152:155], v[12:15]
  s_cselect_b32 s41, s44, s43
  v_mfma_f32_16x16x32_bf16 v[12:15], a[4:7], v[156:159], v[12:15]
  s_cselect_b32 s40, 0, s40
  v_add_u32 v113, s41, v113
  v_add_u32 v114, s41, v114
  v_add_u32 v115, s41, v115
  v_add_u32 v116, s41, v116
  s_bitcmp1_b32 s54, s42
  s_cbranch_scc1 C1_rare
C1_back:
  s_waitcnt lgkmcnt(0)
  s_barrier
C1_back2:
  v_mfma_f32_16x16x32_bf16 v[16:19], a[8:11], v[128:131], v[16:19]
  ds_read_b128 a[64:67], v115 offset:0
  v_mfma_f32_16x16x32_bf16 v[16:19], a[12:15], v[132:135], v[16:19]
  ds_read_b128 a[68:71], v116 offset:0
  v_mfma_f32_16x16x32_bf16 v[20:23], a[8:11], v[136:139], v[20:23]
  ds_read_b128 a[72:75], v115 offset:2048
  v_mfma_f32_16x16x32_bf16 v[20:23], a[12:15], v[140:143], v[20:23]
  ds_read_b128 a[76:79], v116 offset:2048
  v_mfma_f32_16x16x32_bf16 v[24:27], a[8:11], v[144:147], v[24:27]
  ds_read_b128 a[80:83], v115 offset:4096
  v_mfma_f32_16x16x32_bf16 v[24:27], a[12:15], v[148:151], v[24:27]
  ds_read_b128 a[84:87], v116 offset:4096
  v_mfma_f32_16x16x32_bf16 v[28:31], a[8:11], v[152:155], v[28:31]
  ds_read_b128 a[88:91], v115 offset:6144
  v_mfma_f32_16x16x32_bf16 v[28:31], a[12:15], v[156:159], v[28:31]
  ds_read_b128 a[92:95], v116 offset:6144
  v_mfma_f32_16x16x32_bf16 v[32:35], a[16:19], v[128:131], v[32:35]
  ds_read_b64_tr_b16 a[0:1], v113 offset:0
  v_mfma_f32_16x16x32_bf16 v[32:35], a[20:23], v[132:135], v[32:35]
  ds_read_b64_tr_b16 a[2:3], v113 offset:1792
  v_mfma_f32_16x16x32_bf16 v[36:39], a[16:19], v[136:139], v[36:39]
  ds_read_b64_tr_b16 a[4:5], v113 offset:14336
  v_mfma_f32_16x16x32_bf16 v[36:39], a[20:23], v[140:143], v[36:39]
  ds_read_b64_tr_b16 a[6:7], v113 offset:16128
  v_mfma_f32_16x16x32_bf16 v[40:43], a[16:19], v[144:147], v[40:43]
  ds_read_b64_tr_b16 a[48:49], v113 offset:192
  v_mfma_f32_16x16x32_bf16 v[40:43], a[20:23], v[148:151], v[40:43]
  ds_read_b64_tr_b16 a[50:51], v113 offset:1984
  v_mfma_f32_16x16x32_bf16 v[44:47], a[16:19], v[152:155], v[44:47]
  ds_read_b64_tr_b16 a[52:53], v113 offset:14528
  v_mfma_f32_16x16x32_bf16 v[44:47], a[20:23], v[156:159], v[44:47]
  ds_read_b64_tr_b16 a[54:55], v113 offset:16320
  v_mfma_f32_16x16x32_bf16 v[48:51], a[24:27], v[128:131], v[48:51]
  ds_read_b64_tr_b16 a[8:9], v114 offset:32
  v_mfma_f32_16x16x32_bf16 v[48:51], a[28:31], v[132:135], v[48:51]
  ds_read_b64_tr_b16 a[10:11], v114 offset:1824
  v_mfma_f32_16x16x32_bf16 v[52:55], a[24:27], v[136:139], v[52:55]
  ds_read_b64_tr_b16 a[12:13], v114 offset:14368
  v_mfma_f32_16x16x32_bf16 v[52:55], a[28:31], v[140:143], v[52:55]
  ds_read_b64_tr_b16 a[14:15], v114 offset:16160
  v_mfma_f32_16x16x32_bf16 v[56:59], a[24:27], v[144:147], v[56:59]
  v_mfma_f32_16x16x32_bf16 v[56:59], a[28:31], v[148:151], v[56:59]
  v_mfma_f32_16x16x32_bf16 v[60:63], a[24:27], v[152:155], v[60:63]
  v_mfma_f32_16x16x32_bf16 v[60:63], a[28:31], v[156:159], v[60:63]
  v_mfma_f32_16x16x32_bf16 v[64:67], a[32:35], v[128:131], v[64:67]
  ds_read_b64_tr_b16 a[16:17], v113 offset:64
  v_mfma_f32_16x16x32_bf16 v[64:67], a[36:39], v[132:135], v[64:67]
  ds_read_b64_tr_b16 a[18:19], v113 offset:1856
  v_mfma_f32_16x16x32_bf16 v[68:71], a[32:35], v[136:139], v[68:71]
  ds_read_b64_tr_b16 a[20:21], v113 offset:14400
  v_mfma_f32_16x16x32_bf16 v[68:71], a[36:39], v[140:143], v[68:71]
  ds_read_b64_tr_b16 a[22:23], v113 offset:16192
  v_mfma_f32_16x16x32_bf16 v[72:75], a[32:35], v[144:147], v[72:75]
  v_mfma_f32_16x16x32_bf16 v[72:75], a[36:39], v[148:151], v[72:75]
  v_mfma_f32_16x16x32_bf16 v[76:79], a[32:35], v[152:155], v[76:79]
  v_mfma_f32_16x16x32_bf16 v[76:79], a[36:39], v[156:159], v[76:79]
  v_mfma_f32_16x16x32_bf16 v[80:83], a[40:43], v[128:131], v[80:83]
  ds_read_b64_tr_b16 a[24:25], v114 offset:96
  v_mfma_f32_16x16x32_bf16 v[80:83], a[44:47], v[132:135], v[80:83]
  ds_read_b64_tr_b16 a[26:27], v114 offset:1888
  v_mfma_f32_16x16x32_bf16 v[84:87], a[40:43], v[136:139], v[84:87]
  ds_read_b64_tr_b16 a[28:29], v114 offset:14432
  v_mfma_f32_16x16x32_bf16 v[84:87], a[44:47], v[140:143], v[84:87]
  ds_read_b64_tr_b16 a[30:31], v114 offset:16224
  v_mfma_f32_16x16x32_bf16 v[88:91], a[40:43], v[144:147], v[88:91]
  v_mfma_f32_16x16x32_bf16 v[88:91], a[44:47], v[148:151], v[88:91]
  v_mfma_f32_16x16x32_bf16 v[92:95], a[40:43], v[152:155], v[92:95]
  v_mfma_f32_16x16x32_bf16 v[92:95], a[44:47], v[156:159], v[92:95]
  v_mfma_f32_16x16x32_bf16 v[96:99], a[56:59], v[128:131], v[96:99]
  ds_read_b64_tr_b16 a[32:33], v113 offset:128
  v_mfma_f32_16x16x32_bf16 v[96:99], a[60:63], v[132:135], v[96:99]
  ds_read_b64_tr_b16 a[34:35], v113 offset:1920
  v_mfma_f32_16x16x32_bf16 v[100:103], a[56:59], v[136:139], v[100:103]
  ds_read_b64_tr_b16 a[36:37], v113 offset:14464
  v_mfma_f32_16x16x32_bf16 v[100:103], a[60:63], v[140:143], v[100:103]
  ds_read_b64_tr_b16 a[38:39], v113 offset:16256
  v_mfma_f32_16x16x32_bf16 v[104:107], a[56:59], v[144:147], v[104:107]
  v_mfma_f32_16x16x32_bf16 v[104:107], a[60:63], v[148:151], v[104:107]
  v_mfma_f32_16x16x32_bf16 v[108:111], a[56:59], v[152:155], v[108:111]
  v_mfma_f32_16x16x32_bf16 v[108:111], a[60:63], v[156:159], v[108:111]
  s_sub_u32 s42, s42, 1
  s_cmp_lg_u32 s42, 0
  s_cbranch_scc1 C1_loop
  s_branch C1_done
C1_rare:
  s_cmp_eq_u32 s42, 2
  s_cbranch_scc1 C1_rare2
  s_waitcnt vmcnt(0) lgkmcnt(0)
  v_readfirstlane_b32 s1, v126
  s_cmp_lg_u32 s1, 0
  s_cbranch_scc1 C1_tag_ok
  s_mov_b32 s49, 0
C1_tag:
  buffer_load_dword v126, v124, s[12:15], 0 offen sc1
  s_waitcnt vmcnt(0)
  v_readfirstlane_b32 s1, v126
  s_cmp_lg_u32 s1, 0
  s_cbranch_scc1 C1_tag_ok
  s_add_u32 s49, s49, 1
  s_cmp_lt_u32 s49, 1048576
  s_cbranch_scc0 C1_tag_ok
  s_sleep 1
  s_branch C1_tag
C1_tag_ok:
  s_barrier
  s_cmp_eq_u32 s20, 0
  s_cbranch_scc0 C1_back2
  s_or_b32 s35, s1, s55
  v_mov_b32 v126, s35
  s_mov_b64 exec, 1
  buffer_store_dword v126, v125, s[16:19], 0 offen sc1
  s_mov_b64 exec, -1
  s_branch C1_back2
C1_rare2:
  v_lshrrev_b32 v125, 4, v112
  v_lshlrev_b32 v125, 7, v125
  v_and_b32 v126, 15, v112
  v_lshl_add_u32 v125, v126, 2, v125
  s_mov_b32 s48, 32768
  buffer_load_dword v121, v125, s[16:19], s48 offen offset:0 sc1
  buffer_load_dword v122, v125, s[16:19], s48 offen offset:512 sc1
  buffer_load_dword v123, v125, s[16:19], s48 offen offset:1024 sc1
  buffer_load_dword v124, v125, s[16:19], s48 offen offset:1536 sc1
  s_branch C1_back
C1_done:
  s_waitcnt vmcnt(0) lgkmcnt(0)
  s_add_u32 s12, s6, 25231360
  s_addc_u32 s13, s7, 0
  s_mov_b32 s14, 0xa000
  s_mov_b32 s15, 0x20000
  v_xor_b32 v121, s1, v121
  v_xor_b32 v122, s1, v122
  v_xor_b32 v123, s1, v123
  v_xor_b32 v124, s1, v124
  v_or_b32 v126, v121, v122
  v_or3_b32 v126, v126, v123, v124
  v_and_b32 v126, 0x0fffffff, v126
  v_cmp_ne_u32 vcc, 0, v126
  s_nop 1
  s_cmp_eq_u64 vcc, 0
  s_cbranch_scc1 C1_a_ok
  s_mov_b32 s49, 0
C1_polla:
  buffer_load_dword v121, v125, s[12:15], s48 offen offset:0 sc1
  buffer_load_dword v122, v125, s[12:15], s48 offen offset:512 sc1
  buffer_load_dword v123, v125, s[12:15], s48 offen offset:1024 sc1
  buffer_load_dword v124, v125, s[12:15], s48 offen offset:1536 sc1
  s_waitcnt vmcnt(0)
  v_xor_b32 v121, s1, v121
  v_xor_b32 v122, s1, v122
  v_xor_b32 v123, s1, v123
  v_xor_b32 v124, s1, v124
  v_or_b32 v126, v121, v122
  v_or3_b32 v126, v126, v123, v124
  v_and_b32 v126, 0x0fffffff, v126
  v_cmp_ne_u32 vcc, 0, v126
  s_nop 1
  s_cmp_eq_u64 vcc, 0
  s_cbranch_scc1 C1_polla_ok
  s_add_u32 s49, s49, 1
  s_cmp_lt_u32 s49, 1048576
  s_cbranch_scc0 C1_polla_ok
  s_sleep 1
  s_branch C1_polla
C1_polla_ok:
C1_a_ok:
  v_xor_b32 v121, s55, v121
  v_xor_b32 v122, s55, v122
  v_xor_b32 v123, s55, v123
  v_xor_b32 v124, s55, v124
  v_or_b32 v121, v121, v122
  v_or3_b32 v121, v121, v123, v124
  v_cmp_ne_u32 vcc, 0, v121
  s_and_b32 s34, s2, 31
  s_lshl_b32 s34, 1, s34
  s_or_b32 s35, vcc_lo, vcc_hi
  s_and_b32 s35, s35, s34
  s_cmp_eq_u32 s35, 0
  s_cselect_b64 vcc, -1, 0
  s_mov_b32 s8, s6
  s_mov_b32 s9, s7
  s_mov_b32 s10, 0x1000000
  s_mov_b32 s11, 0x20000
  s_lshl_b32 s33, s24, 20
  s_mul_i32 s34, s25, 57344
  s_add_u32 s33, s33, s34
  s_lshl_b32 s34, s32, 12
  s_add_u32 s33, s33, s34
  v_lshlrev_b32 v117, 4, v112
  v_add_u32 v118, 8, v117
  s_mov_b32 s50, 0xbfb8aa3b
  s_mov_b32 s51, 0xbfb8aa3b
  s_mov_b32 s52, 1.0
  s_mov_b32 s53, 1.0
  s_cmp_lg_u32 s31, 0
  s_cbranch_scc1 C1_epi1
  v_pk_mul_f32 v[128:129], v[0:1], s[50:51]
  v_pk_mul_f32 v[130:131], v[2:3], s[50:51]
  v_pk_mul_f32 v[132:133], v[16:17], s[50:51]
  v_pk_mul_f32 v[134:135], v[18:19], s[50:51]
  v_exp_f32 v128, v128
  v_exp_f32 v129, v129
  v_exp_f32 v130, v130
  v_exp_f32 v131, v131
  v_exp_f32 v132, v132
  v_exp_f32 v133, v133
  v_exp_f32 v134, v134
  v_exp_f32 v135, v135
  v_pk_add_f32 v[128:129], v[128:129], s[52:53]
  v_pk_add_f32 v[130:131], v[130:131], s[52:53]
  v_pk_add_f32 v[132:133], v[132:133], s[52:53]
  v_pk_add_f32 v[134:135], v[134:135], s[52:53]
  v_rcp_f32 v128, v128
  v_rcp_f32 v129, v129
  v_rcp_f32 v130, v130
  v_rcp_f32 v131, v131
  v_rcp_f32 v132, v132
  v_rcp_f32 v133, v133
  v_rcp_f32 v134, v134
  v_rcp_f32 v135, v135
  v_pk_mul_f32 v[0:1], v[0:1], v[128:129]
  v_pk_mul_f32 v[2:3], v[2:3], v[130:131]
  v_pk_mul_f32 v[16:17], v[16:17], v[132:133]
  v_pk_mul_f32 v[18:19], v[18:19], v[134:135]
  v_cvt_pk_bf16_f32 v0, v0, v1
  v_cvt_pk_bf16_f32 v1, v2, v3
  v_cvt_pk_bf16_f32 v2, v16, v17
  v_cvt_pk_bf16_f32 v3, v18, v19
  s_add_u32 s34, s33, 0
  s_cbranch_vccnz L_hl_1
  buffer_store_dwordx4 v[0:3], v117, s[8:11], s34 offen sc1
  s_branch L_hn_2
L_hl_1:
  buffer_store_dwordx4 v[0:3], v117, s[8:11], s34 offen
L_hn_2:
  v_pk_mul_f32 v[128:129], v[32:33], s[50:51]
  v_pk_mul_f32 v[130:131], v[34:35], s[50:51]
  v_pk_mul_f32 v[132:133], v[48:49], s[50:51]
  v_pk_mul_f32 v[134:135], v[50:51], s[50:51]
  v_exp_f32 v128, v128
  v_exp_f32 v129, v129
  v_exp_f32 v130, v130
  v_exp_f32 v131, v131
  v_exp_f32 v132, v132
  v_exp_f32 v133, v133
  v_exp_f32 v134, v134
  v_exp_f32 v135, v135
  v_pk_add_f32 v[128:129], v[128:129], s[52:53]
  v_pk_add_f32 v[130:131], v[130:131], s[52:53]
  v_pk_add_f32 v[132:133], v[132:133], s[52:53]
  v_pk_add_f32 v[134:135], v[134:135], s[52:53]
  v_rcp_f32 v128, v128
  v_rcp_f32 v129, v129
  v_rcp_f32 v130, v130
  v_rcp_f32 v131, v131
  v_rcp_f32 v132, v132
  v_rcp_f32 v133, v133
  v_rcp_f32 v134, v134
  v_rcp_f32 v135, v135
  v_pk_mul_f32 v[32:33], v[32:33], v[128:129]
  v_pk_mul_f32 v[34:35], v[34:35], v[130:131]
  v_pk_mul_f32 v[48:49], v[48:49], v[132:133]
  v_pk_mul_f32 v[50:51], v[50:51], v[134:135]
  v_cvt_pk_bf16_f32 v32, v32, v33
  v_cvt_pk_bf16_f32 v33, v34, v35
  v_cvt_pk_bf16_f32 v34, v48, v49
  v_cvt_pk_bf16_f32 v35, v50, v51
  s_add_u32 s34, s33, 8192
  s_cbranch_vccnz L_hl_3
  buffer_store_dwordx4 v[32:35], v117, s[8:11], s34 offen sc1
  s_branch L_hn_4
L_hl_3:
  buffer_store_dwordx4 v[32:35], v117, s[8:11], s34 offen
L_hn_4:
  v_pk_mul_f32 v[128:129], v[64:65], s[50:51]
  v_pk_mul_f32 v[130:131], v[66:67], s[50:51]
  v_pk_mul_f32 v[132:133], v[80:81], s[50:51]
  v_pk_mul_f32 v[134:135], v[82:83], s[50:51]
  v_exp_f32 v128, v128
  v_exp_f32 v129, v129
  v_exp_f32 v130, v130
  v_exp_f32 v131, v131
  v_exp_f32 v132, v132
  v_exp_f32 v133, v133
  v_exp_f32 v134, v134
  v_exp_f32 v135, v135
  v_pk_add_f32 v[128:129], v[128:129], s[52:53]
  v_pk_add_f32 v[130:131], v[130:131], s[52:53]
  v_pk_add_f32 v[132:133], v[132:133], s[52:53]
  v_pk_add_f32 v[134:135], v[134:135], s[52:53]
  v_rcp_f32 v128, v128
  v_rcp_f32 v129, v129
  v_rcp_f32 v130, v130
  v_rcp_f32 v131, v131
  v_rcp_f32 v132, v132
  v_rcp_f32 v133, v133
  v_rcp_f32 v134, v134
  v_rcp_f32 v135, v135
  v_pk_mul_f32 v[64:65], v[64:65], v[128:129]
  v_pk_mul_f32 v[66:67], v[66:67], v[130:131]
  v_pk_mul_f32 v[80:81], v[80:81], v[132:133]
  v_pk_mul_f32 v[82:83], v[82:83], v[134:135]
  v_cvt_pk_bf16_f32 v64, v64, v65
  v_cvt_pk_bf16_f32 v65, v66, v67
  v_cvt_pk_bf16_f32 v66, v80, v81
  v_cvt_pk_bf16_f32 v67, v82, v83
  s_add_u32 s34, s33, 16384
  s_cbranch_vccnz L_hl_5
  buffer_store_dwordx4 v[64:67], v117, s[8:11], s34 offen sc1
  s_branch L_hn_6
L_hl_5:
  buffer_store_dwordx4 v[64:67], v117, s[8:11], s34 offen
L_hn_6:
  v_pk_mul_f32 v[128:129], v[96:97], s[50:51]
  v_pk_mul_f32 v[130:131], v[98:99], s[50:51]
  v_exp_f32 v128, v128
  v_exp_f32 v129, v129
  v_exp_f32 v130, v130
  v_exp_f32 v131, v131
  v_pk_add_f32 v[128:129], v[128:129], s[52:53]
  v_pk_add_f32 v[130:131], v[130:131], s[52:53]
  v_rcp_f32 v128, v128
  v_rcp_f32 v129, v129
  v_rcp_f32 v130, v130
  v_rcp_f32 v131, v131
  s_nop 0
  v_pk_mul_f32 v[96:97], v[96:97], v[128:129]
  v_pk_mul_f32 v[98:99], v[98:99], v[130:131]
  v_cvt_pk_bf16_f32 v96, v96, v97
  v_cvt_pk_bf16_f32 v97, v98, v99
  s_add_u32 s34, s33, 24576
  s_cbranch_vccnz L_hl_7
  buffer_store_dwordx2 v[96:97], v117, s[8:11], s34 offen sc1
  s_branch L_hn_8
L_hl_7:
  buffer_store_dwordx2 v[96:97], v117, s[8:11], s34 offen
L_hn_8:
  v_pk_mul_f32 v[128:129], v[4:5], s[50:51]
  v_pk_mul_f32 v[130:131], v[6:7], s[50:51]
  v_pk_mul_f32 v[132:133], v[20:21], s[50:51]
  v_pk_mul_f32 v[134:135], v[22:23], s[50:51]
  v_exp_f32 v128, v128
  v_exp_f32 v129, v129
  v_exp_f32 v130, v130
  v_exp_f32 v131, v131
  v_exp_f32 v132, v132
  v_exp_f32 v133, v133
  v_exp_f32 v134, v134
  v_exp_f32 v135, v135
  v_pk_add_f32 v[128:129], v[128:129], s[52:53]
  v_pk_add_f32 v[130:131], v[130:131], s[52:53]
  v_pk_add_f32 v[132:133], v[132:133], s[52:53]
  v_pk_add_f32 v[134:135], v[134:135], s[52:53]
  v_rcp_f32 v128, v128
  v_rcp_f32 v129, v129
  v_rcp_f32 v130, v130
  v_rcp_f32 v131, v131
  v_rcp_f32 v132, v132
  v_rcp_f32 v133, v133
  v_rcp_f32 v134, v134
  v_rcp_f32 v135, v135
  v_pk_mul_f32 v[4:5], v[4:5], v[128:129]
  v_pk_mul_f32 v[6:7], v[6:7], v[130:131]
  v_pk_mul_f32 v[20:21], v[20:21], v[132:133]
  v_pk_mul_f32 v[22:23], v[22:23], v[134:135]
  v_cvt_pk_bf16_f32 v4, v4, v5
  v_cvt_pk_bf16_f32 v5, v6, v7
  v_cvt_pk_bf16_f32 v6, v20, v21
  v_cvt_pk_bf16_f32 v7, v22, v23
  s_add_u32 s34, s33, 1024
  s_cbranch_vccnz L_hl_9
  buffer_store_dwordx4 v[4:7], v117, s[8:11], s34 offen sc1
  s_branch L_hn_10
L_hl_9:
  buffer_store_dwordx4 v[4:7], v117, s[8:11], s34 offen
L_hn_10:
  v_pk_mul_f32 v[128:129], v[36:37], s[50:51]
  v_pk_mul_f32 v[130:131], v[38:39], s[50:51]
  v_pk_mul_f32 v[132:133], v[52:53], s[50:51]
  v_pk_mul_f32 v[134:135], v[54:55], s[50:51]
  v_exp_f32 v128, v128
  v_exp_f32 v129, v129
  v_exp_f32 v130, v130
  v_exp_f32 v131, v131
  v_exp_f32 v132, v132
  v_exp_f32 v133, v133
  v_exp_f32 v134, v134
  v_exp_f32 v135, v135
  v_pk_add_f32 v[128:129], v[128:129], s[52:53]
  v_pk_add_f32 v[130:131], v[130:131], s[52:53]
  v_pk_add_f32 v[132:133], v[132:133], s[52:53]
  v_pk_add_f32 v[134:135], v[134:135], s[52:53]
  v_rcp_f32 v128, v128
  v_rcp_f32 v129, v129
  v_rcp_f32 v130, v130
  v_rcp_f32 v131, v131
  v_rcp_f32 v132, v132
  v_rcp_f32 v133, v133
  v_rcp_f32 v134, v134
  v_rcp_f32 v135, v135
  v_pk_mul_f32 v[36:37], v[36:37], v[128:129]
  v_pk_mul_f32 v[38:39], v[38:39], v[130:131]
  v_pk_mul_f32 v[52:53], v[52:53], v[132:133]
  v_pk_mul_f32 v[54:55], v[54:55], v[134:135]
  v_cvt_pk_bf16_f32 v36, v36, v37
  v_cvt_pk_bf16_f32 v37, v38, v39
  v_cvt_pk_bf16_f32 v38, v52, v53
  v_cvt_pk_bf16_f32 v39, v54, v55
  s_add_u32 s34, s33, 9216
  s_cbranch_vccnz L_hl_11
  buffer_store_dwordx4 v[36:39], v117, s[8:11], s34 offen sc1
  s_branch L_hn_12
L_hl_11:
  buffer_store_dwordx4 v[36:39], v117, s[8:11], s34 offen
L_hn_12:
  v_pk_mul_f32 v[128:129], v[68:69], s[50:51]
  v_pk_mul_f32 v[130:131], v[70:71], s[50:51]
  v_pk_mul_f32 v[132:133], v[84:85], s[50:51]
  v_pk_mul_f32 v[134:135], v[86:87], s[50:51]
  v_exp_f32 v128, v128
  v_exp_f32 v129, v129
  v_exp_f32 v130, v130
  v_exp_f32 v131, v131
  v_exp_f32 v132, v132
  v_exp_f32 v133, v133
  v_exp_f32 v134, v134
  v_exp_f32 v135, v135
  v_pk_add_f32 v[128:129], v[128:129], s[52:53]
  v_pk_add_f32 v[130:131], v[130:131], s[52:53]
  v_pk_add_f32 v[132:133], v[132:133], s[52:53]
  v_pk_add_f32 v[134:135], v[134:135], s[52:53]
  v_rcp_f32 v128, v128
  v_rcp_f32 v129, v129
  v_rcp_f32 v130, v130
  v_rcp_f32 v131, v131
  v_rcp_f32 v132, v132
  v_rcp_f32 v133, v133
  v_rcp_f32 v134, v134
  v_rcp_f32 v135, v135
  v_pk_mul_f32 v[68:69], v[68:69], v[128:129]
  v_pk_mul_f32 v[70:71], v[70:71], v[130:131]
  v_pk_mul_f32 v[84:85], v[84:85], v[132:133]
  v_pk_mul_f32 v[86:87], v[86:87], v[134:135]
  v_cvt_pk_bf16_f32 v68, v68, v69
  v_cvt_pk_bf16_f32 v69, v70, v71
  v_cvt_pk_bf16_f32 v70, v84, v85
  v_cvt_pk_bf16_f32 v71, v86, v87
  s_add_u32 s34, s33, 17408
  s_cbranch_vccnz L_hl_13
  buffer_store_dwordx4 v[68:71], v117, s[8:11], s34 offen sc1
  s_branch L_hn_14
L_hl_13:
  buffer_store_dwordx4 v[68:71], v117, s[8:11], s34 offen
L_hn_14:
  v_pk_mul_f32 v[128:129], v[100:101], s[50:51]
  v_pk_mul_f32 v[130:131], v[102:103], s[50:51]
  v_exp_f32 v128, v128
  v_exp_f32 v129, v129
  v_exp_f32 v130, v130
  v_exp_f32 v131, v131
  v_pk_add_f32 v[128:129], v[128:129], s[52:53]
  v_pk_add_f32 v[130:131], v[130:131], s[52:53]
  v_rcp_f32 v128, v128
  v_rcp_f32 v129, v129
  v_rcp_f32 v130, v130
  v_rcp_f32 v131, v131
  s_nop 0
  v_pk_mul_f32 v[100:101], v[100:101], v[128:129]
  v_pk_mul_f32 v[102:103], v[102:103], v[130:131]
  v_cvt_pk_bf16_f32 v100, v100, v101
  v_cvt_pk_bf16_f32 v101, v102, v103
  s_add_u32 s34, s33, 25600
  s_cbranch_vccnz L_hl_15
  buffer_store_dwordx2 v[100:101], v117, s[8:11], s34 offen sc1
  s_branch L_hn_16
L_hl_15:
  buffer_store_dwordx2 v[100:101], v117, s[8:11], s34 offen
L_hn_16:
  v_pk_mul_f32 v[128:129], v[8:9], s[50:51]
  v_pk_mul_f32 v[130:131], v[10:11], s[50:51]
  v_pk_mul_f32 v[132:133], v[24:25], s[50:51]
  v_pk_mul_f32 v[134:135], v[26:27], s[50:51]
  v_exp_f32 v128, v128
  v_exp_f32 v129, v129
  v_exp_f32 v130, v130
  v_exp_f32 v131, v131
  v_exp_f32 v132, v132
  v_exp_f32 v133, v133
  v_exp_f32 v134, v134
  v_exp_f32 v135, v135
  v_pk_add_f32 v[128:129], v[128:129], s[52:53]
  v_pk_add_f32 v[130:131], v[130:131], s[52:53]
  v_pk_add_f32 v[132:133], v[132:133], s[52:53]
  v_pk_add_f32 v[134:135], v[134:135], s[52:53]
  v_rcp_f32 v128, v128
  v_rcp_f32 v129, v129
  v_rcp_f32 v130, v130
  v_rcp_f32 v131, v131
  v_rcp_f32 v132, v132
  v_rcp_f32 v133, v133
  v_rcp_f32 v134, v134
  v_rcp_f32 v135, v135
  v_pk_mul_f32 v[8:9], v[8:9], v[128:129]
  v_pk_mul_f32 v[10:11], v[10:11], v[130:131]
  v_pk_mul_f32 v[24:25], v[24:25], v[132:133]
  v_pk_mul_f32 v[26:27], v[26:27], v[134:135]
  v_cvt_pk_bf16_f32 v8, v8, v9
  v_cvt_pk_bf16_f32 v9, v10, v11
  v_cvt_pk_bf16_f32 v10, v24, v25
  v_cvt_pk_bf16_f32 v11, v26, v27
  s_add_u32 s34, s33, 2048
  s_cbranch_vccnz L_hl_17
  buffer_store_dwordx4 v[8:11], v117, s[8:11], s34 offen sc1
  s_branch L_hn_18
L_hl_17:
  buffer_store_dwordx4 v[8:11], v117, s[8:11], s34 offen
L_hn_18:
  v_pk_mul_f32 v[128:129], v[40:41], s[50:51]
  v_pk_mul_f32 v[130:131], v[42:43], s[50:51]
  v_pk_mul_f32 v[132:133], v[56:57], s[50:51]
  v_pk_mul_f32 v[134:135], v[58:59], s[50:51]
  v_exp_f32 v128, v128
  v_exp_f32 v129, v129
  v_exp_f32 v130, v130
  v_exp_f32 v131, v131
  v_exp_f32 v132, v132
  v_exp_f32 v133, v133
  v_exp_f32 v134, v134
  v_exp_f32 v135, v135
  v_pk_add_f32 v[128:129], v[128:129], s[52:53]
  v_pk_add_f32 v[130:131], v[130:131], s[52:53]
  v_pk_add_f32 v[132:133], v[132:133], s[52:53]
  v_pk_add_f32 v[134:135], v[134:135], s[52:53]
  v_rcp_f32 v128, v128
  v_rcp_f32 v129, v129
  v_rcp_f32 v130, v130
  v_rcp_f32 v131, v131
  v_rcp_f32 v132, v132
  v_rcp_f32 v133, v133
  v_rcp_f32 v134, v134
  v_rcp_f32 v135, v135
  v_pk_mul_f32 v[40:41], v[40:41], v[128:129]
  v_pk_mul_f32 v[42:43], v[42:43], v[130:131]
  v_pk_mul_f32 v[56:57], v[56:57], v[132:133]
  v_pk_mul_f32 v[58:59], v[58:59], v[134:135]
  v_cvt_pk_bf16_f32 v40, v40, v41
  v_cvt_pk_bf16_f32 v41, v42, v43
  v_cvt_pk_bf16_f32 v42, v56, v57
  v_cvt_pk_bf16_f32 v43, v58, v59
  s_add_u32 s34, s33, 10240
  s_cbranch_vccnz L_hl_19
  buffer_store_dwordx4 v[40:43], v117, s[8:11], s34 offen sc1
  s_branch L_hn_20
L_hl_19:
  buffer_store_dwordx4 v[40:43], v117, s[8:11], s34 offen
L_hn_20:
  v_pk_mul_f32 v[128:129], v[72:73], s[50:51]
  v_pk_mul_f32 v[130:131], v[74:75], s[50:51]
  v_pk_mul_f32 v[132:133], v[88:89], s[50:51]
  v_pk_mul_f32 v[134:135], v[90:91], s[50:51]
  v_exp_f32 v128, v128
  v_exp_f32 v129, v129
  v_exp_f32 v130, v130
  v_exp_f32 v131, v131
  v_exp_f32 v132, v132
  v_exp_f32 v133, v133
  v_exp_f32 v134, v134
  v_exp_f32 v135, v135
  v_pk_add_f32 v[128:129], v[128:129], s[52:53]
  v_pk_add_f32 v[130:131], v[130:131], s[52:53]
  v_pk_add_f32 v[132:133], v[132:133], s[52:53]
  v_pk_add_f32 v[134:135], v[134:135], s[52:53]
  v_rcp_f32 v128, v128
  v_rcp_f32 v129, v129
  v_rcp_f32 v130, v130
  v_rcp_f32 v131, v131
  v_rcp_f32 v132, v132
  v_rcp_f32 v133, v133
  v_rcp_f32 v134, v134
  v_rcp_f32 v135, v135
  v_pk_mul_f32 v[72:73], v[72:73], v[128:129]
  v_pk_mul_f32 v[74:75], v[74:75], v[130:131]
  v_pk_mul_f32 v[88:89], v[88:89], v[132:133]
  v_pk_mul_f32 v[90:91], v[90:91], v[134:135]
  v_cvt_pk_bf16_f32 v72, v72, v73
  v_cvt_pk_bf16_f32 v73, v74, v75
  v_cvt_pk_bf16_f32 v74, v88, v89
  v_cvt_pk_bf16_f32 v75, v90, v91
  s_add_u32 s34, s33, 18432
  s_cbranch_vccnz L_hl_21
  buffer_store_dwordx4 v[72:75], v117, s[8:11], s34 offen sc1
  s_branch L_hn_22
L_hl_21:
  buffer_store_dwordx4 v[72:75], v117, s[8:11], s34 offen
L_hn_22:
  v_pk_mul_f32 v[128:129], v[104:105], s[50:51]
  v_pk_mul_f32 v[130:131], v[106:107], s[50:51]
  v_exp_f32 v128, v128
  v_exp_f32 v129, v129
  v_exp_f32 v130, v130
  v_exp_f32 v131, v131
  v_pk_add_f32 v[128:129], v[128:129], s[52:53]
  v_pk_add_f32 v[130:131], v[130:131], s[52:53]
  v_rcp_f32 v128, v128
  v_rcp_f32 v129, v129
  v_rcp_f32 v130, v130
  v_rcp_f32 v131, v131
  s_nop 0
  v_pk_mul_f32 v[104:105], v[104:105], v[128:129]
  v_pk_mul_f32 v[106:107], v[106:107], v[130:131]
  v_cvt_pk_bf16_f32 v104, v104, v105
  v_cvt_pk_bf16_f32 v105, v106, v107
  s_add_u32 s34, s33, 26624
  s_cbranch_vccnz L_hl_23
  buffer_store_dwordx2 v[104:105], v117, s[8:11], s34 offen sc1
  s_branch L_hn_24
L_hl_23:
  buffer_store_dwordx2 v[104:105], v117, s[8:11], s34 offen
L_hn_24:
  v_pk_mul_f32 v[128:129], v[12:13], s[50:51]
  v_pk_mul_f32 v[130:131], v[14:15], s[50:51]
  v_pk_mul_f32 v[132:133], v[28:29], s[50:51]
  v_pk_mul_f32 v[134:135], v[30:31], s[50:51]
  v_exp_f32 v128, v128
  v_exp_f32 v129, v129
  v_exp_f32 v130, v130
  v_exp_f32 v131, v131
  v_exp_f32 v132, v132
  v_exp_f32 v133, v133
  v_exp_f32 v134, v134
  v_exp_f32 v135, v135
  v_pk_add_f32 v[128:129], v[128:129], s[52:53]
  v_pk_add_f32 v[130:131], v[130:131], s[52:53]
  v_pk_add_f32 v[132:133], v[132:133], s[52:53]
  v_pk_add_f32 v[134:135], v[134:135], s[52:53]
  v_rcp_f32 v128, v128
  v_rcp_f32 v129, v129
  v_rcp_f32 v130, v130
  v_rcp_f32 v131, v131
  v_rcp_f32 v132, v132
  v_rcp_f32 v133, v133
  v_rcp_f32 v134, v134
  v_rcp_f32 v135, v135
  v_pk_mul_f32 v[12:13], v[12:13], v[128:129]
  v_pk_mul_f32 v[14:15], v[14:15], v[130:131]
  v_pk_mul_f32 v[28:29], v[28:29], v[132:133]
  v_pk_mul_f32 v[30:31], v[30:31], v[134:135]
  v_cvt_pk_bf16_f32 v12, v12, v13
  v_cvt_pk_bf16_f32 v13, v14, v15
  v_cvt_pk_bf16_f32 v14, v28, v29
  v_cvt_pk_bf16_f32 v15, v30, v31
  s_add_u32 s34, s33, 3072
  s_cbranch_vccnz L_hl_25
  buffer_store_dwordx4 v[12:15], v117, s[8:11], s34 offen sc1
  s_branch L_hn_26
L_hl_25:
  buffer_store_dwordx4 v[12:15], v117, s[8:11], s34 offen
L_hn_26:
  v_pk_mul_f32 v[128:129], v[44:45], s[50:51]
  v_pk_mul_f32 v[130:131], v[46:47], s[50:51]
  v_pk_mul_f32 v[132:133], v[60:61], s[50:51]
  v_pk_mul_f32 v[134:135], v[62:63], s[50:51]
  v_exp_f32 v128, v128
  v_exp_f32 v129, v129
  v_exp_f32 v130, v130
  v_exp_f32 v131, v131
  v_exp_f32 v132, v132
  v_exp_f32 v133, v133
  v_exp_f32 v134, v134
  v_exp_f32 v135, v135
  v_pk_add_f32 v[128:129], v[128:129], s[52:53]
  v_pk_add_f32 v[130:131], v[130:131], s[52:53]
  v_pk_add_f32 v[132:133], v[132:133], s[52:53]
  v_pk_add_f32 v[134:135], v[134:135], s[52:53]
  v_rcp_f32 v128, v128
  v_rcp_f32 v129, v129
  v_rcp_f32 v130, v130
  v_rcp_f32 v131, v131
  v_rcp_f32 v132, v132
  v_rcp_f32 v133, v133
  v_rcp_f32 v134, v134
  v_rcp_f32 v135, v135
  v_pk_mul_f32 v[44:45], v[44:45], v[128:129]
  v_pk_mul_f32 v[46:47], v[46:47], v[130:131]
  v_pk_mul_f32 v[60:61], v[60:61], v[132:133]
  v_pk_mul_f32 v[62:63], v[62:63], v[134:135]
  v_cvt_pk_bf16_f32 v44, v44, v45
  v_cvt_pk_bf16_f32 v45, v46, v47
  v_cvt_pk_bf16_f32 v46, v60, v61
  v_cvt_pk_bf16_f32 v47, v62, v63
  s_add_u32 s34, s33, 11264
  s_cbranch_vccnz L_hl_27
  buffer_store_dwordx4 v[44:47], v117, s[8:11], s34 offen sc1
  s_branch L_hn_28
L_hl_27:
  buffer_store_dwordx4 v[44:47], v117, s[8:11], s34 offen
L_hn_28:
  v_pk_mul_f32 v[128:129], v[76:77], s[50:51]
  v_pk_mul_f32 v[130:131], v[78:79], s[50:51]
  v_pk_mul_f32 v[132:133], v[92:93], s[50:51]
  v_pk_mul_f32 v[134:135], v[94:95], s[50:51]
  v_exp_f32 v128, v128
  v_exp_f32 v129, v129
  v_exp_f32 v130, v130
  v_exp_f32 v131, v131
  v_exp_f32 v132, v132
  v_exp_f32 v133, v133
  v_exp_f32 v134, v134
  v_exp_f32 v135, v135
  v_pk_add_f32 v[128:129], v[128:129], s[52:53]
  v_pk_add_f32 v[130:131], v[130:131], s[52:53]
  v_pk_add_f32 v[132:133], v[132:133], s[52:53]
  v_pk_add_f32 v[134:135], v[134:135], s[52:53]
  v_rcp_f32 v128, v128
  v_rcp_f32 v129, v129
  v_rcp_f32 v130, v130
  v_rcp_f32 v131, v131
  v_rcp_f32 v132, v132
  v_rcp_f32 v133, v133
  v_rcp_f32 v134, v134
  v_rcp_f32 v135, v135
  v_pk_mul_f32 v[76:77], v[76:77], v[128:129]
  v_pk_mul_f32 v[78:79], v[78:79], v[130:131]
  v_pk_mul_f32 v[92:93], v[92:93], v[132:133]
  v_pk_mul_f32 v[94:95], v[94:95], v[134:135]
  v_cvt_pk_bf16_f32 v76, v76, v77
  v_cvt_pk_bf16_f32 v77, v78, v79
  v_cvt_pk_bf16_f32 v78, v92, v93
  v_cvt_pk_bf16_f32 v79, v94, v95
  s_add_u32 s34, s33, 19456
  s_cbranch_vccnz L_hl_29
  buffer_store_dwordx4 v[76:79], v117, s[8:11], s34 offen sc1
  s_branch L_hn_30
L_hl_29:
  buffer_store_dwordx4 v[76:79], v117, s[8:11], s34 offen
L_hn_30:
  v_pk_mul_f32 v[128:129], v[108:109], s[50:51]
  v_pk_mul_f32 v[130:131], v[110:111], s[50:51]
  v_exp_f32 v128, v128
  v_exp_f32 v129, v129
  v_exp_f32 v130, v130
  v_exp_f32 v131, v131
  v_pk_add_f32 v[128:129], v[128:129], s[52:53]
  v_pk_add_f32 v[130:131], v[130:131], s[52:53]
  v_rcp_f32 v128, v128
  v_rcp_f32 v129, v129
  v_rcp_f32 v130, v130
  v_rcp_f32 v131, v131
  s_nop 0
  v_pk_mul_f32 v[108:109], v[108:109], v[128:129]
  v_pk_mul_f32 v[110:111], v[110:111], v[130:131]
  v_cvt_pk_bf16_f32 v108, v108, v109
  v_cvt_pk_bf16_f32 v109, v110, v111
  s_add_u32 s34, s33, 27648
  s_cbranch_vccnz L_hl_31
  buffer_store_dwordx2 v[108:109], v117, s[8:11], s34 offen sc1
  s_branch L_hn_32
L_hl_31:
  buffer_store_dwordx2 v[108:109], v117, s[8:11], s34 offen
L_hn_32:
  s_branch C1_stored
C1_epi1:
  v_pk_mul_f32 v[128:129], v[0:1], s[50:51]
  v_pk_mul_f32 v[130:131], v[2:3], s[50:51]
  v_exp_f32 v128, v128
  v_exp_f32 v129, v129
  v_exp_f32 v130, v130
  v_exp_f32 v131, v131
  v_pk_add_f32 v[128:129], v[128:129], s[52:53]
  v_pk_add_f32 v[130:131], v[130:131], s[52:53]
  v_rcp_f32 v128, v128
  v_rcp_f32 v129, v129
  v_rcp_f32 v130, v130
  v_rcp_f32 v131, v131
  s_nop 0
  v_pk_mul_f32 v[0:1], v[0:1], v[128:129]
  v_pk_mul_f32 v[2:3], v[2:3], v[130:131]
  v_cvt_pk_bf16_f32 v0, v0, v1
  v_cvt_pk_bf16_f32 v1, v2, v3
  s_add_u32 s34, s33, 24576
  s_cbranch_vccnz L_hl_33
  buffer_store_dwordx2 v[0:1], v118, s[8:11], s34 offen sc1
  s_branch L_hn_34
L_hl_33:
  buffer_store_dwordx2 v[0:1], v118, s[8:11], s34 offen
L_hn_34:
  v_pk_mul_f32 v[128:129], v[16:17], s[50:51]
  v_pk_mul_f32 v[130:131], v[18:19], s[50:51]
  v_pk_mul_f32 v[132:133], v[32:33], s[50:51]
  v_pk_mul_f32 v[134:135], v[34:35], s[50:51]
  v_exp_f32 v128, v128
  v_exp_f32 v129, v129
  v_exp_f32 v130, v130
  v_exp_f32 v131, v131
  v_exp_f32 v132, v132
  v_exp_f32 v133, v133
  v_exp_f32 v134, v134
  v_exp_f32 v135, v135
  v_pk_add_f32 v[128:129], v[128:129], s[52:53]
  v_pk_add_f32 v[130:131], v[130:131], s[52:53]
  v_pk_add_f32 v[132:133], v[132:133], s[52:53]
  v_pk_add_f32 v[134:135], v[134:135], s[52:53]
  v_rcp_f32 v128, v128
  v_rcp_f32 v129, v129
  v_rcp_f32 v130, v130
  v_rcp_f32 v131, v131
  v_rcp_f32 v132, v132
  v_rcp_f32 v133, v133
  v_rcp_f32 v134, v134
  v_rcp_f32 v135, v135
  v_pk_mul_f32 v[16:17], v[16:17], v[128:129]
  v_pk_mul_f32 v[18:19], v[18:19], v[130:131]
  v_pk_mul_f32 v[32:33], v[32:33], v[132:133]
  v_pk_mul_f32 v[34:35], v[34:35], v[134:135]
  v_cvt_pk_bf16_f32 v16, v16, v17
  v_cvt_pk_bf16_f32 v17, v18, v19
  v_cvt_pk_bf16_f32 v18, v32, v33
  v_cvt_pk_bf16_f32 v19, v34, v35
  s_add_u32 s34, s33, 32768
  s_cbranch_vccnz L_hl_35
  buffer_store_dwordx4 v[16:19], v117, s[8:11], s34 offen sc1
  s_branch L_hn_36
L_hl_35:
  buffer_store_dwordx4 v[16:19], v117, s[8:11], s34 offen
L_hn_36:
  v_pk_mul_f32 v[128:129], v[48:49], s[50:51]
  v_pk_mul_f32 v[130:131], v[50:51], s[50:51]
  v_pk_mul_f32 v[132:133], v[64:65], s[50:51]
  v_pk_mul_f32 v[134:135], v[66:67], s[50:51]
  v_exp_f32 v128, v128
  v_exp_f32 v129, v129
  v_exp_f32 v130, v130
  v_exp_f32 v131, v131
  v_exp_f32 v132, v132
  v_exp_f32 v133, v133
  v_exp_f32 v134, v134
  v_exp_f32 v135, v135
  v_pk_add_f32 v[128:129], v[128:129], s[52:53]
  v_pk_add_f32 v[130:131], v[130:131], s[52:53]
  v_pk_add_f32 v[132:133], v[132:133], s[52:53]
  v_pk_add_f32 v[134:135], v[134:135], s[52:53]
  v_rcp_f32 v128, v128
  v_rcp_f32 v129, v129
  v_rcp_f32 v130, v130
  v_rcp_f32 v131, v131
  v_rcp_f32 v132, v132
  v_rcp_f32 v133, v133
  v_rcp_f32 v134, v134
  v_rcp_f32 v135, v135
  v_pk_mul_f32 v[48:49], v[48:49], v[128:129]
  v_pk_mul_f32 v[50:51], v[50:51], v[130:131]
  v_pk_mul_f32 v[64:65], v[64:65], v[132:133]
  v_pk_mul_f32 v[66:67], v[66:67], v[134:135]
  v_cvt_pk_bf16_f32 v48, v48, v49
  v_cvt_pk_bf16_f32 v49, v50, v51
  v_cvt_pk_bf16_f32 v50, v64, v65
  v_cvt_pk_bf16_f32 v51, v66, v67
  s_add_u32 s34, s33, 40960
  s_cbranch_vccnz L_hl_37
  buffer_store_dwordx4 v[48:51], v117, s[8:11], s34 offen sc1
  s_branch L_hn_38
L_hl_37:
  buffer_store_dwordx4 v[48:51], v117, s[8:11], s34 offen
L_hn_38:
  v_pk_mul_f32 v[128:129], v[80:81], s[50:51]
  v_pk_mul_f32 v[130:131], v[82:83], s[50:51]
  v_pk_mul_f32 v[132:133], v[96:97], s[50:51]
  v_pk_mul_f32 v[134:135], v[98:99], s[50:51]
  v_exp_f32 v128, v128
  v_exp_f32 v129, v129
  v_exp_f32 v130, v130
  v_exp_f32 v131, v131
  v_exp_f32 v132, v132
  v_exp_f32 v133, v133
  v_exp_f32 v134, v134
  v_exp_f32 v135, v135
  v_pk_add_f32 v[128:129], v[128:129], s[52:53]
  v_pk_add_f32 v[130:131], v[130:131], s[52:53]
  v_pk_add_f32 v[132:133], v[132:133], s[52:53]
  v_pk_add_f32 v[134:135], v[134:135], s[52:53]
  v_rcp_f32 v128, v128
  v_rcp_f32 v129, v129
  v_rcp_f32 v130, v130
  v_rcp_f32 v131, v131
  v_rcp_f32 v132, v132
  v_rcp_f32 v133, v133
  v_rcp_f32 v134, v134
  v_rcp_f32 v135, v135
  v_pk_mul_f32 v[80:81], v[80:81], v[128:129]
  v_pk_mul_f32 v[82:83], v[82:83], v[130:131]
  v_pk_mul_f32 v[96:97], v[96:97], v[132:133]
  v_pk_mul_f32 v[98:99], v[98:99], v[134:135]
  v_cvt_pk_bf16_f32 v80, v80, v81
  v_cvt_pk_bf16_f32 v81, v82, v83
  v_cvt_pk_bf16_f32 v82, v96, v97
  v_cvt_pk_bf16_f32 v83, v98, v99
  s_add_u32 s34, s33, 49152
  s_cbranch_vccnz L_hl_39
  buffer_store_dwordx4 v[80:83], v117, s[8:11], s34 offen sc1
  s_branch L_hn_40
L_hl_39:
  buffer_store_dwordx4 v[80:83], v117, s[8:11], s34 offen
L_hn_40:
  v_pk_mul_f32 v[128:129], v[4:5], s[50:51]
  v_pk_mul_f32 v[130:131], v[6:7], s[50:51]
  v_exp_f32 v128, v128
  v_exp_f32 v129, v129
  v_exp_f32 v130, v130
  v_exp_f32 v131, v131
  v_pk_add_f32 v[128:129], v[128:129], s[52:53]
  v_pk_add_f32 v[130:131], v[130:131], s[52:53]
  v_rcp_f32 v128, v128
  v_rcp_f32 v129, v129
  v_rcp_f32 v130, v130
  v_rcp_f32 v131, v131
  s_nop 0
  v_pk_mul_f32 v[4:5], v[4:5], v[128:129]
  v_pk_mul_f32 v[6:7], v[6:7], v[130:131]
  v_cvt_pk_bf16_f32 v4, v4, v5
  v_cvt_pk_bf16_f32 v5, v6, v7
  s_add_u32 s34, s33, 25600
  s_cbranch_vccnz L_hl_41
  buffer_store_dwordx2 v[4:5], v118, s[8:11], s34 offen sc1
  s_branch L_hn_42
L_hl_41:
  buffer_store_dwordx2 v[4:5], v118, s[8:11], s34 offen
L_hn_42:
  v_pk_mul_f32 v[128:129], v[20:21], s[50:51]
  v_pk_mul_f32 v[130:131], v[22:23], s[50:51]
  v_pk_mul_f32 v[132:133], v[36:37], s[50:51]
  v_pk_mul_f32 v[134:135], v[38:39], s[50:51]
  v_exp_f32 v128, v128
  v_exp_f32 v129, v129
  v_exp_f32 v130, v130
  v_exp_f32 v131, v131
  v_exp_f32 v132, v132
  v_exp_f32 v133, v133
  v_exp_f32 v134, v134
  v_exp_f32 v135, v135
  v_pk_add_f32 v[128:129], v[128:129], s[52:53]
  v_pk_add_f32 v[130:131], v[130:131], s[52:53]
  v_pk_add_f32 v[132:133], v[132:133], s[52:53]
  v_pk_add_f32 v[134:135], v[134:135], s[52:53]
  v_rcp_f32 v128, v128
  v_rcp_f32 v129, v129
  v_rcp_f32 v130, v130
  v_rcp_f32 v131, v131
  v_rcp_f32 v132, v132
  v_rcp_f32 v133, v133
  v_rcp_f32 v134, v134
  v_rcp_f32 v135, v135
  v_pk_mul_f32 v[20:21], v[20:21], v[128:129]
  v_pk_mul_f32 v[22:23], v[22:23], v[130:131]
  v_pk_mul_f32 v[36:37], v[36:37], v[132:133]
  v_pk_mul_f32 v[38:39], v[38:39], v[134:135]
  v_cvt_pk_bf16_f32 v20, v20, v21
  v_cvt_pk_bf16_f32 v21, v22, v23
  v_cvt_pk_bf16_f32 v22, v36, v37
  v_cvt_pk_bf16_f32 v23, v38, v39
  s_add_u32 s34, s33, 33792
  s_cbranch_vccnz L_hl_43
  buffer_store_dwordx4 v[20:23], v117, s[8:11], s34 offen sc1
  s_branch L_hn_44
L_hl_43:
  buffer_store_dwordx4 v[20:23], v117, s[8:11], s34 offen
L_hn_44:
  v_pk_mul_f32 v[128:129], v[52:53], s[50:51]
  v_pk_mul_f32 v[130:131], v[54:55], s[50:51]
  v_pk_mul_f32 v[132:133], v[68:69], s[50:51]
  v_pk_mul_f32 v[134:135], v[70:71], s[50:51]
  v_exp_f32 v128, v128
  v_exp_f32 v129, v129
  v_exp_f32 v130, v130
  v_exp_f32 v131, v131
  v_exp_f32 v132, v132
  v_exp_f32 v133, v133
  v_exp_f32 v134, v134
  v_exp_f32 v135, v135
  v_pk_add_f32 v[128:129], v[128:129], s[52:53]
  v_pk_add_f32 v[130:131], v[130:131], s[52:53]
  v_pk_add_f32 v[132:133], v[132:133], s[52:53]
  v_pk_add_f32 v[134:135], v[134:135], s[52:53]
  v_rcp_f32 v128, v128
  v_rcp_f32 v129, v129
  v_rcp_f32 v130, v130
  v_rcp_f32 v131, v131
  v_rcp_f32 v132, v132
  v_rcp_f32 v133, v133
  v_rcp_f32 v134, v134
  v_rcp_f32 v135, v135
  v_pk_mul_f32 v[52:53], v[52:53], v[128:129]
  v_pk_mul_f32 v[54:55], v[54:55], v[130:131]
  v_pk_mul_f32 v[68:69], v[68:69], v[132:133]
  v_pk_mul_f32 v[70:71], v[70:71], v[134:135]
  v_cvt_pk_bf16_f32 v52, v52, v53
  v_cvt_pk_bf16_f32 v53, v54, v55
  v_cvt_pk_bf16_f32 v54, v68, v69
  v_cvt_pk_bf16_f32 v55, v70, v71
  s_add_u32 s34, s33, 41984
  s_cbranch_vccnz L_hl_45
  buffer_store_dwordx4 v[52:55], v117, s[8:11], s34 offen sc1
  s_branch L_hn_46
L_hl_45:
  buffer_store_dwordx4 v[52:55], v117, s[8:11], s34 offen
L_hn_46:
  v_pk_mul_f32 v[128:129], v[84:85], s[50:51]
  v_pk_mul_f32 v[130:131], v[86:87], s[50:51]
  v_pk_mul_f32 v[132:133], v[100:101], s[50:51]
  v_pk_mul_f32 v[134:135], v[102:103], s[50:51]
  v_exp_f32 v128, v128
  v_exp_f32 v129, v129
  v_exp_f32 v130, v130
  v_exp_f32 v131, v131
  v_exp_f32 v132, v132
  v_exp_f32 v133, v133
  v_exp_f32 v134, v134
  v_exp_f32 v135, v135
  v_pk_add_f32 v[128:129], v[128:129], s[52:53]
  v_pk_add_f32 v[130:131], v[130:131], s[52:53]
  v_pk_add_f32 v[132:133], v[132:133], s[52:53]
  v_pk_add_f32 v[134:135], v[134:135], s[52:53]
  v_rcp_f32 v128, v128
  v_rcp_f32 v129, v129
  v_rcp_f32 v130, v130
  v_rcp_f32 v131, v131
  v_rcp_f32 v132, v132
  v_rcp_f32 v133, v133
  v_rcp_f32 v134, v134
  v_rcp_f32 v135, v135
  v_pk_mul_f32 v[84:85], v[84:85], v[128:129]
  v_pk_mul_f32 v[86:87], v[86:87], v[130:131]
  v_pk_mul_f32 v[100:101], v[100:101], v[132:133]
  v_pk_mul_f32 v[102:103], v[102:103], v[134:135]
  v_cvt_pk_bf16_f32 v84, v84, v85
  v_cvt_pk_bf16_f32 v85, v86, v87
  v_cvt_pk_bf16_f32 v86, v100, v101
  v_cvt_pk_bf16_f32 v87, v102, v103
  s_add_u32 s34, s33, 50176
  s_cbranch_vccnz L_hl_47
  buffer_store_dwordx4 v[84:87], v117, s[8:11], s34 offen sc1
  s_branch L_hn_48
L_hl_47:
  buffer_store_dwordx4 v[84:87], v117, s[8:11], s34 offen
L_hn_48:
  v_pk_mul_f32 v[128:129], v[8:9], s[50:51]
  v_pk_mul_f32 v[130:131], v[10:11], s[50:51]
  v_exp_f32 v128, v128
  v_exp_f32 v129, v129
  v_exp_f32 v130, v130
  v_exp_f32 v131, v131
  v_pk_add_f32 v[128:129], v[128:129], s[52:53]
  v_pk_add_f32 v[130:131], v[130:131], s[52:53]
  v_rcp_f32 v128, v128
  v_rcp_f32 v129, v129
  v_rcp_f32 v130, v130
  v_rcp_f32 v131, v131
  s_nop 0
  v_pk_mul_f32 v[8:9], v[8:9], v[128:129]
  v_pk_mul_f32 v[10:11], v[10:11], v[130:131]
  v_cvt_pk_bf16_f32 v8, v8, v9
  v_cvt_pk_bf16_f32 v9, v10, v11
  s_add_u32 s34, s33, 26624
  s_cbranch_vccnz L_hl_49
  buffer_store_dwordx2 v[8:9], v118, s[8:11], s34 offen sc1
  s_branch L_hn_50
L_hl_49:
  buffer_store_dwordx2 v[8:9], v118, s[8:11], s34 offen
L_hn_50:
  v_pk_mul_f32 v[128:129], v[24:25], s[50:51]
  v_pk_mul_f32 v[130:131], v[26:27], s[50:51]
  v_pk_mul_f32 v[132:133], v[40:41], s[50:51]
  v_pk_mul_f32 v[134:135], v[42:43], s[50:51]
  v_exp_f32 v128, v128
  v_exp_f32 v129, v129
  v_exp_f32 v130, v130
  v_exp_f32 v131, v131
  v_exp_f32 v132, v132
  v_exp_f32 v133, v133
  v_exp_f32 v134, v134
  v_exp_f32 v135, v135
  v_pk_add_f32 v[128:129], v[128:129], s[52:53]
  v_pk_add_f32 v[130:131], v[130:131], s[52:53]
  v_pk_add_f32 v[132:133], v[132:133], s[52:53]
  v_pk_add_f32 v[134:135], v[134:135], s[52:53]
  v_rcp_f32 v128, v128
  v_rcp_f32 v129, v129
  v_rcp_f32 v130, v130
  v_rcp_f32 v131, v131
  v_rcp_f32 v132, v132
  v_rcp_f32 v133, v133
  v_rcp_f32 v134, v134
  v_rcp_f32 v135, v135
  v_pk_mul_f32 v[24:25], v[24:25], v[128:129]
  v_pk_mul_f32 v[26:27], v[26:27], v[130:131]
  v_pk_mul_f32 v[40:41], v[40:41], v[132:133]
  v_pk_mul_f32 v[42:43], v[42:43], v[134:135]
  v_cvt_pk_bf16_f32 v24, v24, v25
  v_cvt_pk_bf16_f32 v25, v26, v27
  v_cvt_pk_bf16_f32 v26, v40, v41
  v_cvt_pk_bf16_f32 v27, v42, v43
  s_add_u32 s34, s33, 34816
  s_cbranch_vccnz L_hl_51
  buffer_store_dwordx4 v[24:27], v117, s[8:11], s34 offen sc1
  s_branch L_hn_52
L_hl_51:
  buffer_store_dwordx4 v[24:27], v117, s[8:11], s34 offen
L_hn_52:
  v_pk_mul_f32 v[128:129], v[56:57], s[50:51]
  v_pk_mul_f32 v[130:131], v[58:59], s[50:51]
  v_pk_mul_f32 v[132:133], v[72:73], s[50:51]
  v_pk_mul_f32 v[134:135], v[74:75], s[50:51]
  v_exp_f32 v128, v128
  v_exp_f32 v129, v129
  v_exp_f32 v130, v130
  v_exp_f32 v131, v131
  v_exp_f32 v132, v132
  v_exp_f32 v133, v133
  v_exp_f32 v134, v134
  v_exp_f32 v135, v135
  v_pk_add_f32 v[128:129], v[128:129], s[52:53]
  v_pk_add_f32 v[130:131], v[130:131], s[52:53]
  v_pk_add_f32 v[132:133], v[132:133], s[52:53]
  v_pk_add_f32 v[134:135], v[134:135], s[52:53]
  v_rcp_f32 v128, v128
  v_rcp_f32 v129, v129
  v_rcp_f32 v130, v130
  v_rcp_f32 v131, v131
  v_rcp_f32 v132, v132
  v_rcp_f32 v133, v133
  v_rcp_f32 v134, v134
  v_rcp_f32 v135, v135
  v_pk_mul_f32 v[56:57], v[56:57], v[128:129]
  v_pk_mul_f32 v[58:59], v[58:59], v[130:131]
  v_pk_mul_f32 v[72:73], v[72:73], v[132:133]
  v_pk_mul_f32 v[74:75], v[74:75], v[134:135]
  v_cvt_pk_bf16_f32 v56, v56, v57
  v_cvt_pk_bf16_f32 v57, v58, v59
  v_cvt_pk_bf16_f32 v58, v72, v73
  v_cvt_pk_bf16_f32 v59, v74, v75
  s_add_u32 s34, s33, 43008
  s_cbranch_vccnz L_hl_53
  buffer_store_dwordx4 v[56:59], v117, s[8:11], s34 offen sc1
  s_branch L_hn_54
L_hl_53:
  buffer_store_dwordx4 v[56:59], v117, s[8:11], s34 offen
L_hn_54:
  v_pk_mul_f32 v[128:129], v[88:89], s[50:51]
  v_pk_mul_f32 v[130:131], v[90:91], s[50:51]
  v_pk_mul_f32 v[132:133], v[104:105], s[50:51]
  v_pk_mul_f32 v[134:135], v[106:107], s[50:51]
  v_exp_f32 v128, v128
  v_exp_f32 v129, v129
  v_exp_f32 v130, v130
  v_exp_f32 v131, v131
  v_exp_f32 v132, v132
  v_exp_f32 v133, v133
  v_exp_f32 v134, v134
  v_exp_f32 v135, v135
  v_pk_add_f32 v[128:129], v[128:129], s[52:53]
  v_pk_add_f32 v[130:131], v[130:131], s[52:53]
  v_pk_add_f32 v[132:133], v[132:133], s[52:53]
  v_pk_add_f32 v[134:135], v[134:135], s[52:53]
  v_rcp_f32 v128, v128
  v_rcp_f32 v129, v129
  v_rcp_f32 v130, v130
  v_rcp_f32 v131, v131
  v_rcp_f32 v132, v132
  v_rcp_f32 v133, v133
  v_rcp_f32 v134, v134
  v_rcp_f32 v135, v135
  v_pk_mul_f32 v[88:89], v[88:89], v[128:129]
  v_pk_mul_f32 v[90:91], v[90:91], v[130:131]
  v_pk_mul_f32 v[104:105], v[104:105], v[132:133]
  v_pk_mul_f32 v[106:107], v[106:107], v[134:135]
  v_cvt_pk_bf16_f32 v88, v88, v89
  v_cvt_pk_bf16_f32 v89, v90, v91
  v_cvt_pk_bf16_f32 v90, v104, v105
  v_cvt_pk_bf16_f32 v91, v106, v107
  s_add_u32 s34, s33, 51200
  s_cbranch_vccnz L_hl_55
  buffer_store_dwordx4 v[88:91], v117, s[8:11], s34 offen sc1
  s_branch L_hn_56
L_hl_55:
  buffer_store_dwordx4 v[88:91], v117, s[8:11], s34 offen
L_hn_56:
  v_pk_mul_f32 v[128:129], v[12:13], s[50:51]
  v_pk_mul_f32 v[130:131], v[14:15], s[50:51]
  v_exp_f32 v128, v128
  v_exp_f32 v129, v129
  v_exp_f32 v130, v130
  v_exp_f32 v131, v131
  v_pk_add_f32 v[128:129], v[128:129], s[52:53]
  v_pk_add_f32 v[130:131], v[130:131], s[52:53]
  v_rcp_f32 v128, v128
  v_rcp_f32 v129, v129
  v_rcp_f32 v130, v130
  v_rcp_f32 v131, v131
  s_nop 0
  v_pk_mul_f32 v[12:13], v[12:13], v[128:129]
  v_pk_mul_f32 v[14:15], v[14:15], v[130:131]
  v_cvt_pk_bf16_f32 v12, v12, v13
  v_cvt_pk_bf16_f32 v13, v14, v15
  s_add_u32 s34, s33, 27648
  s_cbranch_vccnz L_hl_57
  buffer_store_dwordx2 v[12:13], v118, s[8:11], s34 offen sc1
  s_branch L_hn_58
L_hl_57:
  buffer_store_dwordx2 v[12:13], v118, s[8:11], s34 offen
L_hn_58:
  v_pk_mul_f32 v[128:129], v[28:29], s[50:51]
  v_pk_mul_f32 v[130:131], v[30:31], s[50:51]
  v_pk_mul_f32 v[132:133], v[44:45], s[50:51]
  v_pk_mul_f32 v[134:135], v[46:47], s[50:51]
  v_exp_f32 v128, v128
  v_exp_f32 v129, v129
  v_exp_f32 v130, v130
  v_exp_f32 v131, v131
  v_exp_f32 v132, v132
  v_exp_f32 v133, v133
  v_exp_f32 v134, v134
  v_exp_f32 v135, v135
  v_pk_add_f32 v[128:129], v[128:129], s[52:53]
  v_pk_add_f32 v[130:131], v[130:131], s[52:53]
  v_pk_add_f32 v[132:133], v[132:133], s[52:53]
  v_pk_add_f32 v[134:135], v[134:135], s[52:53]
  v_rcp_f32 v128, v128
  v_rcp_f32 v129, v129
  v_rcp_f32 v130, v130
  v_rcp_f32 v131, v131
  v_rcp_f32 v132, v132
  v_rcp_f32 v133, v133
  v_rcp_f32 v134, v134
  v_rcp_f32 v135, v135
  v_pk_mul_f32 v[28:29], v[28:29], v[128:129]
  v_pk_mul_f32 v[30:31], v[30:31], v[130:131]
  v_pk_mul_f32 v[44:45], v[44:45], v[132:133]
  v_pk_mul_f32 v[46:47], v[46:47], v[134:135]
  v_cvt_pk_bf16_f32 v28, v28, v29
  v_cvt_pk_bf16_f32 v29, v30, v31
  v_cvt_pk_bf16_f32 v30, v44, v45
  v_cvt_pk_bf16_f32 v31, v46, v47
  s_add_u32 s34, s33, 35840
  s_cbranch_vccnz L_hl_59
  buffer_store_dwordx4 v[28:31], v117, s[8:11], s34 offen sc1
  s_branch L_hn_60
L_hl_59:
  buffer_store_dwordx4 v[28:31], v117, s[8:11], s34 offen
L_hn_60:
  v_pk_mul_f32 v[128:129], v[60:61], s[50:51]
  v_pk_mul_f32 v[130:131], v[62:63], s[50:51]
  v_pk_mul_f32 v[132:133], v[76:77], s[50:51]
  v_pk_mul_f32 v[134:135], v[78:79], s[50:51]
  v_exp_f32 v128, v128
  v_exp_f32 v129, v129
  v_exp_f32 v130, v130
  v_exp_f32 v131, v131
  v_exp_f32 v132, v132
  v_exp_f32 v133, v133
  v_exp_f32 v134, v134
  v_exp_f32 v135, v135
  v_pk_add_f32 v[128:129], v[128:129], s[52:53]
  v_pk_add_f32 v[130:131], v[130:131], s[52:53]
  v_pk_add_f32 v[132:133], v[132:133], s[52:53]
  v_pk_add_f32 v[134:135], v[134:135], s[52:53]
  v_rcp_f32 v128, v128
  v_rcp_f32 v129, v129
  v_rcp_f32 v130, v130
  v_rcp_f32 v131, v131
  v_rcp_f32 v132, v132
  v_rcp_f32 v133, v133
  v_rcp_f32 v134, v134
  v_rcp_f32 v135, v135
  v_pk_mul_f32 v[60:61], v[60:61], v[128:129]
  v_pk_mul_f32 v[62:63], v[62:63], v[130:131]
  v_pk_mul_f32 v[76:77], v[76:77], v[132:133]
  v_pk_mul_f32 v[78:79], v[78:79], v[134:135]
  v_cvt_pk_bf16_f32 v60, v60, v61
  v_cvt_pk_bf16_f32 v61, v62, v63
  v_cvt_pk_bf16_f32 v62, v76, v77
  v_cvt_pk_bf16_f32 v63, v78, v79
  s_add_u32 s34, s33, 44032
  s_cbranch_vccnz L_hl_61
  buffer_store_dwordx4 v[60:63], v117, s[8:11], s34 offen sc1
  s_branch L_hn_62
L_hl_61:
  buffer_store_dwordx4 v[60:63], v117, s[8:11], s34 offen
L_hn_62:
  v_pk_mul_f32 v[128:129], v[92:93], s[50:51]
  v_pk_mul_f32 v[130:131], v[94:95], s[50:51]
  v_pk_mul_f32 v[132:133], v[108:109], s[50:51]
  v_pk_mul_f32 v[134:135], v[110:111], s[50:51]
  v_exp_f32 v128, v128
  v_exp_f32 v129, v129
  v_exp_f32 v130, v130
  v_exp_f32 v131, v131
  v_exp_f32 v132, v132
  v_exp_f32 v133, v133
  v_exp_f32 v134, v134
  v_exp_f32 v135, v135
  v_pk_add_f32 v[128:129], v[128:129], s[52:53]
  v_pk_add_f32 v[130:131], v[130:131], s[52:53]
  v_pk_add_f32 v[132:133], v[132:133], s[52:53]
  v_pk_add_f32 v[134:135], v[134:135], s[52:53]
  v_rcp_f32 v128, v128
  v_rcp_f32 v129, v129
  v_rcp_f32 v130, v130
  v_rcp_f32 v131, v131
  v_rcp_f32 v132, v132
  v_rcp_f32 v133, v133
  v_rcp_f32 v134, v134
  v_rcp_f32 v135, v135
  v_pk_mul_f32 v[92:93], v[92:93], v[128:129]
  v_pk_mul_f32 v[94:95], v[94:95], v[130:131]
  v_pk_mul_f32 v[108:109], v[108:109], v[132:133]
  v_pk_mul_f32 v[110:111], v[110:111], v[134:135]
  v_cvt_pk_bf16_f32 v92, v92, v93
  v_cvt_pk_bf16_f32 v93, v94, v95
  v_cvt_pk_bf16_f32 v94, v108, v109
  v_cvt_pk_bf16_f32 v95, v110, v111
  s_add_u32 s34, s33, 52224
  s_cbranch_vccnz L_hl_63
  buffer_store_dwordx4 v[92:95], v117, s[8:11], s34 offen sc1
  s_branch L_hn_64
L_hl_63:
  buffer_store_dwordx4 v[92:95], v117, s[8:11], s34 offen
L_hn_64:
  s_branch C1_stored
C1_stored:
  s_waitcnt vmcnt(0)
  v_mov_b32 v128, 163588
  v_mov_b32 v129, 1
  s_mov_b64 exec, 1
  ds_add_rtn_u32 v130, v128, v129
  s_waitcnt lgkmcnt(0)
  s_mov_b64 exec, -1
  v_readfirstlane_b32 s34, v130
  s_cmp_eq_u32 s34, 3
  s_cbranch_scc0 C1_noflag
  s_lshl_b32 s33, s24, 4
  s_lshl_b32 s34, s23, 3
  s_add_u32 s33, s33, s34
  s_lshl_b32 s33, s33, 7
  s_and_b32 s34, s25, 7
  s_lshl_b32 s34, s34, 2
  s_add_u32 s33, s33, s34
  v_lshlrev_b32 v128, 7, v112
  v_mov_b32 v129, s1
  s_mov_b64 exec, 0xff
  s_cbranch_vccnz L_hl_65
  buffer_store_dword v129, v128, s[12:15], s33 offen sc1
  s_branch L_hn_66
L_hl_65:
  buffer_store_dword v129, v128, s[12:15], s33 offen
L_hn_66:
  s_mov_b64 exec, -1
C1_noflag:
  v_mov_b32 v106, v112
  s_mov_b32 s25, s30
  s_mov_b32 s16, s90
  s_mov_b32 s17, s91
  s_mov_b32 s18, 0x700000
  s_mov_b32 s19, 0x20000
  s_lshr_b32 s33, s20, 1
  s_add_u32 s33, s33, s27
  s_cmp_ge_u32 s33, 7
  s_cselect_b32 s34, 7, 0
  s_sub_u32 s33, s33, s34
  s_lshl_b32 s33, s33, 8
  s_mul_i32 s34, s23, 1792
  s_add_u32 s33, s33, s34
  s_lshl_b32 s34, s21, 6
  s_add_u32 s33, s33, s34
  s_and_b32 s34, s20, 1
  s_lshl_b32 s34, s34, 5
  s_add_u32 s33, s33, s34
  s_lshl_b32 s33, s33, 11
  s_lshl_b32 s34, s30, 8
  s_add_u32 s33, s33, s34
  v_lshrrev_b32 v112, 1, v106
  v_lshlrev_b32 v112, 11, v112
  v_and_b32 v113, 1, v106
  v_lshl_add_u32 v112, v113, 7, v112
  buffer_load_dword v132, v112, s[16:19], s33 offen
  s_and_b32 s31, s20, 1
  s_lshr_b32 s32, s20, 1
  s_add_u32 s8, s6, 25165824
  s_addc_u32 s9, s7, 0
  s_mov_b32 s10, 16384
  s_mov_b32 s11, 0x20000
  s_lshl_b32 s33, s24, 7
  s_lshl_b32 s36, s32, 6
  s_add_u32 s33, s33, s36
  s_lshl_b32 s36, s23, 5
  s_add_u32 s33, s33, s36
  s_lshl_b32 s33, s33, 2
  v_and_b32 v112, 15, v106
  v_lshlrev_b32 v112, 2, v112
  s_add_u32 s36, s33, 8192
  buffer_load_dword v108, v112, s[8:11], s36 offen offset:0 sc1
  buffer_load_dword v110, v112, s[8:11], s33 offen offset:0 sc1
  buffer_load_dword v109, v112, s[8:11], s36 offen offset:64 sc1
  buffer_load_dword v111, v112, s[8:11], s33 offen offset:64 sc1
  v_lshrrev_b32 v112, 4, v106
  v_bfe_u32 v113, v106, 2, 2
  v_and_b32 v114, 3, v106
  v_lshl_add_u32 v115, v112, 2, v113
  v_and_b32 v116, 7, v115
  s_lshl_b32 s33, s31, 2
  s_add_u32 s33, s33, 0
  v_xor_b32 v117, s33, v116
  v_lshlrev_b32 v117, 5, v117
  v_lshl_add_u32 v117, v115, 8, v117
  v_lshl_add_u32 v117, v114, 3, v117
  v_add_u32 v96, 16384, v117
  v_add_u32 v101, 81920, v117
  s_lshl_b32 s33, s31, 2
  s_add_u32 s33, s33, 1
  v_xor_b32 v117, s33, v116
  v_lshlrev_b32 v117, 5, v117
  v_lshl_add_u32 v117, v115, 8, v117
  v_lshl_add_u32 v117, v114, 3, v117
  v_add_u32 v97, 16384, v117
  v_add_u32 v102, 81920, v117
  s_lshl_b32 s33, s31, 2
  s_add_u32 s33, s33, 2
  v_xor_b32 v117, s33, v116
  v_lshlrev_b32 v117, 5, v117
  v_lshl_add_u32 v117, v115, 8, v117
  v_lshl_add_u32 v117, v114, 3, v117
  v_add_u32 v98, 16384, v117
  v_add_u32 v103, 81920, v117
  s_lshl_b32 s33, s31, 2
  s_add_u32 s33, s33, 3
  v_xor_b32 v117, s33, v116
  v_lshlrev_b32 v117, 5, v117
  v_lshl_add_u32 v117, v115, 8, v117
  v_lshl_add_u32 v117, v114, 3, v117
  v_add_u32 v99, 16384, v117
  v_add_u32 v104, 81920, v117
  s_lshl_b32 s33, s32, 12
  v_lshlrev_b32 v117, 4, v106
  v_add_u32 v117, s33, v117
  v_mov_b32 v100, v117
  v_add_u32 v105, 65536, v117
  s_lshl_b32 s33, s32, 11
  s_add_u32 s33, s33, 131072
  v_lshlrev_b32 v107, 4, v106
  v_add_u32 v107, s33, v107
  v_mov_b32 v0, 0
  v_mov_b32 v1, 0
  v_mov_b32 v2, 0
  v_mov_b32 v3, 0
  v_mov_b32 v4, 0
  v_mov_b32 v5, 0
  v_mov_b32 v6, 0
  v_mov_b32 v7, 0
  v_mov_b32 v8, 0
  v_mov_b32 v9, 0
  v_mov_b32 v10, 0
  v_mov_b32 v11, 0
  v_mov_b32 v12, 0
  v_mov_b32 v13, 0
  v_mov_b32 v14, 0
  v_mov_b32 v15, 0
  v_mov_b32 v16, 0
  v_mov_b32 v17, 0
  v_mov_b32 v18, 0
  v_mov_b32 v19, 0
  v_mov_b32 v20, 0
  v_mov_b32 v21, 0
  v_mov_b32 v22, 0
  v_mov_b32 v23, 0
  v_mov_b32 v24, 0
  v_mov_b32 v25, 0
  v_mov_b32 v26, 0
  v_mov_b32 v27, 0
  v_mov_b32 v28, 0
  v_mov_b32 v29, 0
  v_mov_b32 v30, 0
  v_mov_b32 v31, 0
  v_mov_b32 v32, 0
  v_mov_b32 v33, 0
  v_mov_b32 v34, 0
  v_mov_b32 v35, 0
  v_mov_b32 v36, 0
  v_mov_b32 v37, 0
  v_mov_b32 v38, 0
  v_mov_b32 v39, 0
  v_mov_b32 v40, 0
  v_mov_b32 v41, 0
  v_mov_b32 v42, 0
  v_mov_b32 v43, 0
  v_mov_b32 v44, 0
  v_mov_b32 v45, 0
  v_mov_b32 v46, 0
  v_mov_b32 v47, 0
  v_mov_b32 v48, 0
  v_mov_b32 v49, 0
  v_mov_b32 v50, 0
  v_mov_b32 v51, 0
  v_mov_b32 v52, 0
  v_mov_b32 v53, 0
  v_mov_b32 v54, 0
  v_mov_b32 v55, 0
  v_mov_b32 v56, 0
  v_mov_b32 v57, 0
  v_mov_b32 v58, 0
  v_mov_b32 v59, 0
  v_mov_b32 v60, 0
  v_mov_b32 v61, 0
  v_mov_b32 v62, 0
  v_mov_b32 v63, 0
  s_barrier
  ds_read_b64_tr_b16 a[0:1], v96 offset:0
  ds_read_b64_tr_b16 a[2:3], v96 offset:4096
  ds_read_b128 a[16:19], v100 offset:0
  ds_read_b64_tr_b16 a[4:5], v97 offset:0
  ds_read_b64_tr_b16 a[6:7], v97 offset:4096
  ds_read_b128 a[20:23], v100 offset:1024
  ds_read_b64_tr_b16 a[8:9], v98 offset:0
  ds_read_b64_tr_b16 a[10:11], v98 offset:4096
  ds_read_b128 a[24:27], v100 offset:2048
  ds_read_b64_tr_b16 a[12:13], v99 offset:0
  ds_read_b64_tr_b16 a[14:15], v99 offset:4096
  ds_read_b128 a[28:31], v100 offset:3072
  ds_read_b64_tr_b16 a[32:33], v96 offset:8192
  ds_read_b64_tr_b16 a[34:35], v96 offset:12288
  ds_read_b128 a[48:51], v100 offset:8192
  ds_read_b64_tr_b16 a[36:37], v97 offset:8192
  ds_read_b64_tr_b16 a[38:39], v97 offset:12288
  ds_read_b128 a[52:55], v100 offset:9216
  ds_read_b64_tr_b16 a[40:41], v98 offset:8192
  ds_read_b64_tr_b16 a[42:43], v98 offset:12288
  ds_read_b128 a[56:59], v100 offset:10240
  ds_read_b64_tr_b16 a[44:45], v99 offset:8192
  ds_read_b64_tr_b16 a[46:47], v99 offset:12288
  ds_read_b128 a[60:63], v100 offset:11264
  s_waitcnt lgkmcnt(0)
  s_barrier
  s_lshl_b32 s36, s20, 12
  s_add_u32 s36, s36, 131072
  v_lshlrev_b32 v112, 4, v106
  v_add_u32 v113, s36, v112
  ds_read_b128 v[116:119], v113 offset:0
  ds_read_b128 v[120:123], v113 offset:1024
  ds_read_b128 v[124:127], v113 offset:2048
  ds_read_b128 v[128:131], v113 offset:3072
  s_mov_b32 s35, 7
  s_mov_b32 s45, 224
.p2align 6
C2_c_loop:
  v_mfma_f32_16x16x32_bf16 v[0:3], a[0:3], a[16:19], v[0:3]
  ds_read_b64_tr_b16 a[64:65], v96 offset:32768
  v_mfma_f32_16x16x32_bf16 v[0:3], a[32:35], a[48:51], v[0:3]
  ds_read_b64_tr_b16 a[66:67], v96 offset:36864
  v_mfma_f32_16x16x32_bf16 v[4:7], a[0:3], a[20:23], v[4:7]
  ds_read_b128 a[80:83], v100 offset:32768
  v_mfma_f32_16x16x32_bf16 v[4:7], a[32:35], a[52:55], v[4:7]
  ds_read_b64_tr_b16 a[68:69], v97 offset:32768
  v_mfma_f32_16x16x32_bf16 v[8:11], a[0:3], a[24:27], v[8:11]
  ds_read_b64_tr_b16 a[70:71], v97 offset:36864
  v_mfma_f32_16x16x32_bf16 v[8:11], a[32:35], a[56:59], v[8:11]
  ds_read_b128 a[84:87], v100 offset:33792
  v_mfma_f32_16x16x32_bf16 v[12:15], a[0:3], a[28:31], v[12:15]
  ds_read_b64_tr_b16 a[72:73], v98 offset:32768
  v_mfma_f32_16x16x32_bf16 v[12:15], a[32:35], a[60:63], v[12:15]
  ds_read_b64_tr_b16 a[74:75], v98 offset:36864
  v_mfma_f32_16x16x32_bf16 v[16:19], a[4:7], a[16:19], v[16:19]
  ds_read_b128 a[88:91], v100 offset:34816
  v_mfma_f32_16x16x32_bf16 v[16:19], a[36:39], a[48:51], v[16:19]
  ds_read_b64_tr_b16 a[76:77], v99 offset:32768
  v_mfma_f32_16x16x32_bf16 v[20:23], a[4:7], a[20:23], v[20:23]
  ds_read_b64_tr_b16 a[78:79], v99 offset:36864
  v_mfma_f32_16x16x32_bf16 v[20:23], a[36:39], a[52:55], v[20:23]
  ds_read_b128 a[92:95], v100 offset:35840
  v_mfma_f32_16x16x32_bf16 v[24:27], a[4:7], a[24:27], v[24:27]
  ds_read_b64_tr_b16 v[64:65], v96 offset:40960
  v_mfma_f32_16x16x32_bf16 v[24:27], a[36:39], a[56:59], v[24:27]
  ds_read_b64_tr_b16 v[66:67], v96 offset:45056
  v_mfma_f32_16x16x32_bf16 v[28:31], a[4:7], a[28:31], v[28:31]
  ds_read_b128 v[80:83], v100 offset:40960
  v_mfma_f32_16x16x32_bf16 v[28:31], a[36:39], a[60:63], v[28:31]
  ds_read_b64_tr_b16 v[68:69], v97 offset:40960
  v_mfma_f32_16x16x32_bf16 v[32:35], a[8:11], a[16:19], v[32:35]
  ds_read_b64_tr_b16 v[70:71], v97 offset:45056
  v_mfma_f32_16x16x32_bf16 v[32:35], a[40:43], a[48:51], v[32:35]
  ds_read_b128 v[84:87], v100 offset:41984
  v_mfma_f32_16x16x32_bf16 v[36:39], a[8:11], a[20:23], v[36:39]
  ds_read_b64_tr_b16 v[72:73], v98 offset:40960
  v_mfma_f32_16x16x32_bf16 v[36:39], a[40:43], a[52:55], v[36:39]
  ds_read_b64_tr_b16 v[74:75], v98 offset:45056
  v_mfma_f32_16x16x32_bf16 v[40:43], a[8:11], a[24:27], v[40:43]
  ds_read_b128 v[88:91], v100 offset:43008
  v_mfma_f32_16x16x32_bf16 v[40:43], a[40:43], a[56:59], v[40:43]
  ds_read_b64_tr_b16 v[76:77], v99 offset:40960
  v_mfma_f32_16x16x32_bf16 v[44:47], a[8:11], a[28:31], v[44:47]
  ds_read_b64_tr_b16 v[78:79], v99 offset:45056
  v_mfma_f32_16x16x32_bf16 v[44:47], a[40:43], a[60:63], v[44:47]
  ds_read_b128 v[92:95], v100 offset:44032
  v_mfma_f32_16x16x32_bf16 v[48:51], a[12:15], a[16:19], v[48:51]
  v_mfma_f32_16x16x32_bf16 v[48:51], a[44:47], a[48:51], v[48:51]
  v_mfma_f32_16x16x32_bf16 v[52:55], a[12:15], a[20:23], v[52:55]
  v_mfma_f32_16x16x32_bf16 v[52:55], a[44:47], a[52:55], v[52:55]
  v_mfma_f32_16x16x32_bf16 v[56:59], a[12:15], a[24:27], v[56:59]
  v_mfma_f32_16x16x32_bf16 v[56:59], a[44:47], a[56:59], v[56:59]
  v_mfma_f32_16x16x32_bf16 v[60:63], a[12:15], a[28:31], v[60:63]
  v_mfma_f32_16x16x32_bf16 v[60:63], a[44:47], a[60:63], v[60:63]
  s_waitcnt lgkmcnt(0)
  s_barrier
  v_mfma_f32_16x16x32_bf16 v[0:3], a[64:67], a[80:83], v[0:3]
  ds_read_b64_tr_b16 a[0:1], v101 offset:0
  v_mfma_f32_16x16x32_bf16 v[0:3], v[64:67], v[80:83], v[0:3]
  ds_read_b64_tr_b16 a[2:3], v101 offset:4096
  v_mfma_f32_16x16x32_bf16 v[4:7], a[64:67], a[84:87], v[4:7]
  ds_read_b128 a[16:19], v105 offset:0
  v_mfma_f32_16x16x32_bf16 v[4:7], v[64:67], v[84:87], v[4:7]
  ds_read_b64_tr_b16 a[4:5], v102 offset:0
  v_mfma_f32_16x16x32_bf16 v[8:11], a[64:67], a[88:91], v[8:11]
  ds_read_b64_tr_b16 a[6:7], v102 offset:4096
  v_mfma_f32_16x16x32_bf16 v[8:11], v[64:67], v[88:91], v[8:11]
  ds_read_b128 a[20:23], v105 offset:1024
  v_mfma_f32_16x16x32_bf16 v[12:15], a[64:67], a[92:95], v[12:15]
  ds_read_b64_tr_b16 a[8:9], v103 offset:0
  v_mfma_f32_16x16x32_bf16 v[12:15], v[64:67], v[92:95], v[12:15]
  ds_read_b64_tr_b16 a[10:11], v103 offset:4096
  v_mfma_f32_16x16x32_bf16 v[16:19], a[68:71], a[80:83], v[16:19]
  ds_read_b128 a[24:27], v105 offset:2048
  v_mfma_f32_16x16x32_bf16 v[16:19], v[68:71], v[80:83], v[16:19]
  ds_read_b64_tr_b16 a[12:13], v104 offset:0
  v_mfma_f32_16x16x32_bf16 v[20:23], a[68:71], a[84:87], v[20:23]
  ds_read_b64_tr_b16 a[14:15], v104 offset:4096
  v_mfma_f32_16x16x32_bf16 v[20:23], v[68:71], v[84:87], v[20:23]
  ds_read_b128 a[28:31], v105 offset:3072
  v_mfma_f32_16x16x32_bf16 v[24:27], a[68:71], a[88:91], v[24:27]
  ds_read_b64_tr_b16 a[32:33], v101 offset:8192
  v_mfma_f32_16x16x32_bf16 v[24:27], v[68:71], v[88:91], v[24:27]
  ds_read_b64_tr_b16 a[34:35], v101 offset:12288
  v_mfma_f32_16x16x32_bf16 v[28:31], a[68:71], a[92:95], v[28:31]
  ds_read_b128 a[48:51], v105 offset:8192
  v_mfma_f32_16x16x32_bf16 v[28:31], v[68:71], v[92:95], v[28:31]
  ds_read_b64_tr_b16 a[36:37], v102 offset:8192
  v_mfma_f32_16x16x32_bf16 v[32:35], a[72:75], a[80:83], v[32:35]
  ds_read_b64_tr_b16 a[38:39], v102 offset:12288
  v_mfma_f32_16x16x32_bf16 v[32:35], v[72:75], v[80:83], v[32:35]
  ds_read_b128 a[52:55], v105 offset:9216
  v_mfma_f32_16x16x32_bf16 v[36:39], a[72:75], a[84:87], v[36:39]
  ds_read_b64_tr_b16 a[40:41], v103 offset:8192
  v_mfma_f32_16x16x32_bf16 v[36:39], v[72:75], v[84:87], v[36:39]
  ds_read_b64_tr_b16 a[42:43], v103 offset:12288
  v_mfma_f32_16x16x32_bf16 v[40:43], a[72:75], a[88:91], v[40:43]
  ds_read_b128 a[56:59], v105 offset:10240
  v_mfma_f32_16x16x32_bf16 v[40:43], v[72:75], v[88:91], v[40:43]
  ds_read_b64_tr_b16 a[44:45], v104 offset:8192
  v_mfma_f32_16x16x32_bf16 v[44:47], a[72:75], a[92:95], v[44:47]
  ds_read_b64_tr_b16 a[46:47], v104 offset:12288
  v_mfma_f32_16x16x32_bf16 v[44:47], v[72:75], v[92:95], v[44:47]
  ds_read_b128 a[60:63], v105 offset:11264
  v_mfma_f32_16x16x32_bf16 v[48:51], a[76:79], a[80:83], v[48:51]
  v_mfma_f32_16x16x32_bf16 v[48:51], v[76:79], v[80:83], v[48:51]
  v_mfma_f32_16x16x32_bf16 v[52:55], a[76:79], a[84:87], v[52:55]
  v_mfma_f32_16x16x32_bf16 v[52:55], v[76:79], v[84:87], v[52:55]
  v_mfma_f32_16x16x32_bf16 v[56:59], a[76:79], a[88:91], v[56:59]
  v_mfma_f32_16x16x32_bf16 v[56:59], v[76:79], v[88:91], v[56:59]
  v_mfma_f32_16x16x32_bf16 v[60:63], a[76:79], a[92:95], v[60:63]
  v_mfma_f32_16x16x32_bf16 v[60:63], v[76:79], v[92:95], v[60:63]
  s_waitcnt lgkmcnt(0)
  s_barrier
  v_mfma_f32_16x16x32_bf16 v[0:3], a[0:3], a[16:19], v[0:3]
  ds_read_b64_tr_b16 a[64:65], v101 offset:32768
  v_mfma_f32_16x16x32_bf16 v[0:3], a[32:35], a[48:51], v[0:3]
  ds_read_b64_tr_b16 a[66:67], v101 offset:36864
  v_mfma_f32_16x16x32_bf16 v[4:7], a[0:3], a[20:23], v[4:7]
  ds_read_b128 a[80:83], v105 offset:32768
  v_mfma_f32_16x16x32_bf16 v[4:7], a[32:35], a[52:55], v[4:7]
  ds_read_b64_tr_b16 a[68:69], v102 offset:32768
  v_mfma_f32_16x16x32_bf16 v[8:11], a[0:3], a[24:27], v[8:11]
  ds_read_b64_tr_b16 a[70:71], v102 offset:36864
  v_mfma_f32_16x16x32_bf16 v[8:11], a[32:35], a[56:59], v[8:11]
  ds_read_b128 a[84:87], v105 offset:33792
  v_mfma_f32_16x16x32_bf16 v[12:15], a[0:3], a[28:31], v[12:15]
  ds_read_b64_tr_b16 a[72:73], v103 offset:32768
  v_mfma_f32_16x16x32_bf16 v[12:15], a[32:35], a[60:63], v[12:15]
  ds_read_b64_tr_b16 a[74:75], v103 offset:36864
  v_mfma_f32_16x16x32_bf16 v[16:19], a[4:7], a[16:19], v[16:19]
  ds_read_b128 a[88:91], v105 offset:34816
  v_mfma_f32_16x16x32_bf16 v[16:19], a[36:39], a[48:51], v[16:19]
  ds_read_b64_tr_b16 a[76:77], v104 offset:32768
  v_mfma_f32_16x16x32_bf16 v[20:23], a[4:7], a[20:23], v[20:23]
  ds_read_b64_tr_b16 a[78:79], v104 offset:36864
  v_mfma_f32_16x16x32_bf16 v[20:23], a[36:39], a[52:55], v[20:23]
  ds_read_b128 a[92:95], v105 offset:35840
  v_mfma_f32_16x16x32_bf16 v[24:27], a[4:7], a[24:27], v[24:27]
  ds_read_b64_tr_b16 v[64:65], v101 offset:40960
  v_mfma_f32_16x16x32_bf16 v[24:27], a[36:39], a[56:59], v[24:27]
  ds_read_b64_tr_b16 v[66:67], v101 offset:45056
  v_mfma_f32_16x16x32_bf16 v[28:31], a[4:7], a[28:31], v[28:31]
  ds_read_b128 v[80:83], v105 offset:40960
  v_mfma_f32_16x16x32_bf16 v[28:31], a[36:39], a[60:63], v[28:31]
  ds_read_b64_tr_b16 v[68:69], v102 offset:40960
  v_mfma_f32_16x16x32_bf16 v[32:35], a[8:11], a[16:19], v[32:35]
  ds_read_b64_tr_b16 v[70:71], v102 offset:45056
  v_mfma_f32_16x16x32_bf16 v[32:35], a[40:43], a[48:51], v[32:35]
  ds_read_b128 v[84:87], v105 offset:41984
  v_mfma_f32_16x16x32_bf16 v[36:39], a[8:11], a[20:23], v[36:39]
  ds_read_b64_tr_b16 v[72:73], v103 offset:40960
  v_mfma_f32_16x16x32_bf16 v[36:39], a[40:43], a[52:55], v[36:39]
  ds_read_b64_tr_b16 v[74:75], v103 offset:45056
  v_mfma_f32_16x16x32_bf16 v[40:43], a[8:11], a[24:27], v[40:43]
  ds_read_b128 v[88:91], v105 offset:43008
  v_mfma_f32_16x16x32_bf16 v[40:43], a[40:43], a[56:59], v[40:43]
  ds_read_b64_tr_b16 v[76:77], v104 offset:40960
  v_mfma_f32_16x16x32_bf16 v[44:47], a[8:11], a[28:31], v[44:47]
  ds_read_b64_tr_b16 v[78:79], v104 offset:45056
  v_mfma_f32_16x16x32_bf16 v[44:47], a[40:43], a[60:63], v[44:47]
  ds_read_b128 v[92:95], v105 offset:44032
  v_mfma_f32_16x16x32_bf16 v[48:51], a[12:15], a[16:19], v[48:51]
  v_mfma_f32_16x16x32_bf16 v[48:51], a[44:47], a[48:51], v[48:51]
  v_mfma_f32_16x16x32_bf16 v[52:55], a[12:15], a[20:23], v[52:55]
  v_mfma_f32_16x16x32_bf16 v[52:55], a[44:47], a[52:55], v[52:55]
  v_mfma_f32_16x16x32_bf16 v[56:59], a[12:15], a[24:27], v[56:59]
  v_mfma_f32_16x16x32_bf16 v[56:59], a[44:47], a[56:59], v[56:59]
  v_mfma_f32_16x16x32_bf16 v[60:63], a[12:15], a[28:31], v[60:63]
  v_mfma_f32_16x16x32_bf16 v[60:63], a[44:47], a[60:63], v[60:63]
  s_waitcnt lgkmcnt(0)
  s_barrier
  v_mfma_f32_16x16x32_bf16 v[0:3], a[64:67], a[80:83], v[0:3]
  ds_read_b64_tr_b16 a[0:1], v96 offset:0
  v_mfma_f32_16x16x32_bf16 v[0:3], v[64:67], v[80:83], v[0:3]
  ds_read_b64_tr_b16 a[2:3], v96 offset:4096
  v_mfma_f32_16x16x32_bf16 v[4:7], a[64:67], a[84:87], v[4:7]
  ds_read_b128 a[16:19], v100 offset:0
  v_mfma_f32_16x16x32_bf16 v[4:7], v[64:67], v[84:87], v[4:7]
  ds_read_b64_tr_b16 a[4:5], v97 offset:0
  v_mfma_f32_16x16x32_bf16 v[8:11], a[64:67], a[88:91], v[8:11]
  ds_read_b64_tr_b16 a[6:7], v97 offset:4096
  v_mfma_f32_16x16x32_bf16 v[8:11], v[64:67], v[88:91], v[8:11]
  ds_read_b128 a[20:23], v100 offset:1024
  v_mfma_f32_16x16x32_bf16 v[12:15], a[64:67], a[92:95], v[12:15]
  ds_read_b64_tr_b16 a[8:9], v98 offset:0
  v_mfma_f32_16x16x32_bf16 v[12:15], v[64:67], v[92:95], v[12:15]
  ds_read_b64_tr_b16 a[10:11], v98 offset:4096
  v_mfma_f32_16x16x32_bf16 v[16:19], a[68:71], a[80:83], v[16:19]
  ds_read_b128 a[24:27], v100 offset:2048
  v_mfma_f32_16x16x32_bf16 v[16:19], v[68:71], v[80:83], v[16:19]
  ds_read_b64_tr_b16 a[12:13], v99 offset:0
  v_mfma_f32_16x16x32_bf16 v[20:23], a[68:71], a[84:87], v[20:23]
  ds_read_b64_tr_b16 a[14:15], v99 offset:4096
  v_mfma_f32_16x16x32_bf16 v[20:23], v[68:71], v[84:87], v[20:23]
  ds_read_b128 a[28:31], v100 offset:3072
  v_mfma_f32_16x16x32_bf16 v[24:27], a[68:71], a[88:91], v[24:27]
  ds_read_b64_tr_b16 a[32:33], v96 offset:8192
  v_mfma_f32_16x16x32_bf16 v[24:27], v[68:71], v[88:91], v[24:27]
  ds_read_b64_tr_b16 a[34:35], v96 offset:12288
  v_mfma_f32_16x16x32_bf16 v[28:31], a[68:71], a[92:95], v[28:31]
  ds_read_b128 a[48:51], v100 offset:8192
  v_mfma_f32_16x16x32_bf16 v[28:31], v[68:71], v[92:95], v[28:31]
  ds_read_b64_tr_b16 a[36:37], v97 offset:8192
  v_mfma_f32_16x16x32_bf16 v[32:35], a[72:75], a[80:83], v[32:35]
  ds_read_b64_tr_b16 a[38:39], v97 offset:12288
  v_mfma_f32_16x16x32_bf16 v[32:35], v[72:75], v[80:83], v[32:35]
  ds_read_b128 a[52:55], v100 offset:9216
  v_mfma_f32_16x16x32_bf16 v[36:39], a[72:75], a[84:87], v[36:39]
  ds_read_b64_tr_b16 a[40:41], v98 offset:8192
  v_mfma_f32_16x16x32_bf16 v[36:39], v[72:75], v[84:87], v[36:39]
  ds_read_b64_tr_b16 a[42:43], v98 offset:12288
  v_mfma_f32_16x16x32_bf16 v[40:43], a[72:75], a[88:91], v[40:43]
  ds_read_b128 a[56:59], v100 offset:10240
  v_mfma_f32_16x16x32_bf16 v[40:43], v[72:75], v[88:91], v[40:43]
  ds_read_b64_tr_b16 a[44:45], v99 offset:8192
  v_mfma_f32_16x16x32_bf16 v[44:47], a[72:75], a[92:95], v[44:47]
  ds_read_b64_tr_b16 a[46:47], v99 offset:12288
  v_mfma_f32_16x16x32_bf16 v[44:47], v[72:75], v[92:95], v[44:47]
  ds_read_b128 a[60:63], v100 offset:11264
  v_mfma_f32_16x16x32_bf16 v[48:51], a[76:79], a[80:83], v[48:51]
  v_mfma_f32_16x16x32_bf16 v[48:51], v[76:79], v[80:83], v[48:51]
  v_mfma_f32_16x16x32_bf16 v[52:55], a[76:79], a[84:87], v[52:55]
  v_mfma_f32_16x16x32_bf16 v[52:55], v[76:79], v[84:87], v[52:55]
  v_mfma_f32_16x16x32_bf16 v[56:59], a[76:79], a[88:91], v[56:59]
  v_mfma_f32_16x16x32_bf16 v[56:59], v[76:79], v[88:91], v[56:59]
  v_mfma_f32_16x16x32_bf16 v[60:63], a[76:79], a[92:95], v[60:63]
  v_mfma_f32_16x16x32_bf16 v[60:63], v[76:79], v[92:95], v[60:63]
  s_waitcnt lgkmcnt(0)
  s_barrier
  s_bitcmp1_b32 s45, s35
  s_cbranch_scc1 C2_rare
C2_back:
  s_sub_u32 s35, s35, 1
  s_cmp_lg_u32 s35, 0
  s_cbranch_scc1 C2_c_loop
  s_branch C2_done
C2_rare:
  s_cmp_eq_u32 s35, 7
  s_cbranch_scc0 C2_r2
  s_add_u32 s16, s6, 20971520
  s_addc_u32 s17, s7, 0
  s_mov_b32 s18, 0x400000
  s_mov_b32 s19, 0x20000
  s_lshl_b32 s36, s20, 20
  s_lshl_b32 s37, s0, 12
  s_add_u32 s36, s36, s37
  buffer_store_dwordx4 v[116:119], v112, s[16:19], s36 offen offset:0 sc1
  buffer_store_dwordx4 v[120:123], v112, s[16:19], s36 offen offset:1024 sc1
  buffer_store_dwordx4 v[124:127], v112, s[16:19], s36 offen offset:2048 sc1
  buffer_store_dwordx4 v[128:131], v112, s[16:19], s36 offen offset:3072 sc1
  s_branch C2_nt
C2_r2:
  s_cmp_eq_u32 s35, 6
  s_cbranch_scc0 C2_r3
  s_waitcnt vmcnt(0)
  s_branch C2_nt
C2_r3:
  s_cmp_eq_u32 s20, 0
  s_cbranch_scc0 C2_nt
  s_add_u32 s16, s6, 25231360
  s_addc_u32 s17, s7, 0
  s_mov_b32 s18, 0xa000
  s_mov_b32 s19, 0x20000
  s_add_u32 s36, s47, 34816
  v_mov_b32 v112, s36
  v_mov_b32 v113, s1
  s_mov_b64 exec, 1
  buffer_store_dword v113, v112, s[16:19], 0 offen sc1
  s_mov_b64 exec, -1
C2_nt:
  s_branch C2_back
C2_done:
  s_lshl_b32 s33, s24, 3
  s_add_u32 s33, s33, s25
  s_add_u32 s8, s6, 26214400
  s_addc_u32 s9, s7, 0
  s_mov_b32 s10, 8388608
  s_mov_b32 s11, 0x20000
  s_add_u32 s12, s6, 25231360
  s_addc_u32 s13, s7, 0
  s_mov_b32 s14, 32768
  s_mov_b32 s15, 0x20000
  s_lshl_b32 s36, s33, 1
  s_add_u32 s37, s36, s23
  s_lshl_b32 s37, s37, 2
  s_add_u32 s37, s37, s20
  s_xor_b32 s38, s23, 1
  s_add_u32 s38, s36, s38
  s_lshl_b32 s38, s38, 2
  s_add_u32 s38, s38, s20
  s_lshl_b32 s39, s37, 13
  s_lshl_b32 s40, s38, 13
  s_lshl_b32 s36, s24, 4
  s_add_u32 s37, s36, s22
  s_xor_b32 s38, s22, 8
  s_add_u32 s38, s36, s38
  s_lshl_b32 s36, s20, 2
  s_add_u32 s36, s36, 64
  s_lshl_b32 s41, s38, 7
  s_add_u32 s41, s41, s36
  s_lshl_b32 s42, s37, 7
  s_add_u32 s42, s42, s36
  v_lshlrev_b32 v112, 4, v106
  v_add_u32 v113, 4096, v112
  s_mov_b32 s16, s28
  s_mov_b32 s17, s29
  s_mov_b32 s18, 4194304
  s_mov_b32 s19, 0x20000
  v_subrev_u32 v96, 16384, v96
  v_subrev_u32 v97, 16384, v97
  v_subrev_u32 v98, 16384, v98
  v_subrev_u32 v99, 16384, v99
  v_subrev_u32 v101, 16384, v101
  v_subrev_u32 v102, 16384, v102
  v_subrev_u32 v103, 16384, v103
  v_subrev_u32 v104, 16384, v104
  ds_read_b128 a[16:19], v107 offset:0
  ds_read_b128 a[20:23], v107 offset:1024
  ds_read_b128 a[48:51], v107 offset:4096
  ds_read_b128 a[52:55], v107 offset:5120
  s_cmp_lg_u32 s23, 0
  s_cbranch_scc1 C2_x1
  buffer_store_dwordx4 v[8:11], v112, s[8:11], s39 offen offset:0 sc1
  buffer_store_dwordx4 v[24:27], v112, s[8:11], s39 offen offset:1024 sc1
  buffer_store_dwordx4 v[40:43], v112, s[8:11], s39 offen offset:2048 sc1
  buffer_store_dwordx4 v[56:59], v112, s[8:11], s39 offen offset:3072 sc1
  buffer_store_dwordx4 v[12:15], v113, s[8:11], s39 offen offset:0 sc1
  buffer_store_dwordx4 v[28:31], v113, s[8:11], s39 offen offset:1024 sc1
  buffer_store_dwordx4 v[44:47], v113, s[8:11], s39 offen offset:2048 sc1
  buffer_store_dwordx4 v[60:63], v113, s[8:11], s39 offen offset:3072 sc1
  s_nop 1
  v_mov_b32 v8, 0
  v_mov_b32 v9, 0
  v_mov_b32 v10, 0
  v_mov_b32 v11, 0
  v_mov_b32 v24, 0
  v_mov_b32 v25, 0
  v_mov_b32 v26, 0
  v_mov_b32 v27, 0
  v_mov_b32 v40, 0
  v_mov_b32 v41, 0
  v_mov_b32 v42, 0
  v_mov_b32 v43, 0
  v_mov_b32 v56, 0
  v_mov_b32 v57, 0
  v_mov_b32 v58, 0
  v_mov_b32 v59, 0
  v_mov_b32 v12, 0
  v_mov_b32 v13, 0
  v_mov_b32 v14, 0
  v_mov_b32 v15, 0
  v_mov_b32 v28, 0
  v_mov_b32 v29, 0
  v_mov_b32 v30, 0
  v_mov_b32 v31, 0
  v_mov_b32 v44, 0
  v_mov_b32 v45, 0
  v_mov_b32 v46, 0
  v_mov_b32 v47, 0
  v_mov_b32 v60, 0
  v_mov_b32 v61, 0
  v_mov_b32 v62, 0
  v_mov_b32 v63, 0
  s_waitcnt lgkmcnt(0)
  v_mfma_f32_16x16x32_bf16 v[8:11], a[0:3], a[16:19], v[8:11]
  ds_read_b64_tr_b16 a[64:65], v96 offset:0
  ds_read_b64_tr_b16 a[66:67], v96 offset:4096
  v_mfma_f32_16x16x32_bf16 v[8:11], a[32:35], a[48:51], v[8:11]
  ds_read_b128 a[80:83], v107 offset:8192
  ds_read_b64_tr_b16 a[68:69], v97 offset:0
  v_mfma_f32_16x16x32_bf16 v[12:15], a[0:3], a[20:23], v[12:15]
  ds_read_b64_tr_b16 a[70:71], v97 offset:4096
  ds_read_b128 a[84:87], v107 offset:9216
  v_mfma_f32_16x16x32_bf16 v[12:15], a[32:35], a[52:55], v[12:15]
  ds_read_b64_tr_b16 a[72:73], v98 offset:0
  ds_read_b64_tr_b16 a[74:75], v98 offset:4096
  v_mfma_f32_16x16x32_bf16 v[24:27], a[4:7], a[16:19], v[24:27]
  ds_read_b64_tr_b16 a[76:77], v99 offset:0
  ds_read_b64_tr_b16 a[78:79], v99 offset:4096
  v_mfma_f32_16x16x32_bf16 v[24:27], a[36:39], a[48:51], v[24:27]
  ds_read_b64_tr_b16 v[64:65], v96 offset:8192
  ds_read_b64_tr_b16 v[66:67], v96 offset:12288
  v_mfma_f32_16x16x32_bf16 v[28:31], a[4:7], a[20:23], v[28:31]
  ds_read_b128 v[80:83], v107 offset:12288
  ds_read_b64_tr_b16 v[68:69], v97 offset:8192
  v_mfma_f32_16x16x32_bf16 v[28:31], a[36:39], a[52:55], v[28:31]
  ds_read_b64_tr_b16 v[70:71], v97 offset:12288
  ds_read_b128 v[84:87], v107 offset:13312
  v_mfma_f32_16x16x32_bf16 v[40:43], a[8:11], a[16:19], v[40:43]
  ds_read_b64_tr_b16 v[72:73], v98 offset:8192
  ds_read_b64_tr_b16 v[74:75], v98 offset:12288
  v_mfma_f32_16x16x32_bf16 v[40:43], a[40:43], a[48:51], v[40:43]
  ds_read_b64_tr_b16 v[76:77], v99 offset:8192
  ds_read_b64_tr_b16 v[78:79], v99 offset:12288
  v_mfma_f32_16x16x32_bf16 v[44:47], a[8:11], a[20:23], v[44:47]
  v_mfma_f32_16x16x32_bf16 v[44:47], a[40:43], a[52:55], v[44:47]
  v_mfma_f32_16x16x32_bf16 v[56:59], a[12:15], a[16:19], v[56:59]
  v_mfma_f32_16x16x32_bf16 v[56:59], a[44:47], a[48:51], v[56:59]
  v_mfma_f32_16x16x32_bf16 v[60:63], a[12:15], a[20:23], v[60:63]
  v_mfma_f32_16x16x32_bf16 v[60:63], a[44:47], a[52:55], v[60:63]
  s_waitcnt lgkmcnt(0)
  s_barrier
  v_mfma_f32_16x16x32_bf16 v[8:11], a[64:67], a[80:83], v[8:11]
  ds_read_b64_tr_b16 a[0:1], v96 offset:49152
  ds_read_b64_tr_b16 a[2:3], v96 offset:53248
  v_mfma_f32_16x16x32_bf16 v[8:11], v[64:67], v[80:83], v[8:11]
  ds_read_b128 a[16:19], v107 offset:16384
  ds_read_b64_tr_b16 a[4:5], v97 offset:49152
  v_mfma_f32_16x16x32_bf16 v[12:15], a[64:67], a[84:87], v[12:15]
  ds_read_b64_tr_b16 a[6:7], v97 offset:53248
  ds_read_b128 a[20:23], v107 offset:17408
  v_mfma_f32_16x16x32_bf16 v[12:15], v[64:67], v[84:87], v[12:15]
  ds_read_b64_tr_b16 a[8:9], v98 offset:49152
  ds_read_b64_tr_b16 a[10:11], v98 offset:53248
  v_mfma_f32_16x16x32_bf16 v[24:27], a[68:71], a[80:83], v[24:27]
  ds_read_b64_tr_b16 a[12:13], v99 offset:49152
  ds_read_b64_tr_b16 a[14:15], v99 offset:53248
  v_mfma_f32_16x16x32_bf16 v[24:27], v[68:71], v[80:83], v[24:27]
  ds_read_b64_tr_b16 a[32:33], v96 offset:57344
  ds_read_b64_tr_b16 a[34:35], v96 offset:61440
  v_mfma_f32_16x16x32_bf16 v[28:31], a[68:71], a[84:87], v[28:31]
  ds_read_b128 a[48:51], v107 offset:20480
  ds_read_b64_tr_b16 a[36:37], v97 offset:57344
  v_mfma_f32_16x16x32_bf16 v[28:31], v[68:71], v[84:87], v[28:31]
  ds_read_b64_tr_b16 a[38:39], v97 offset:61440
  ds_read_b128 a[52:55], v107 offset:21504
  v_mfma_f32_16x16x32_bf16 v[40:43], a[72:75], a[80:83], v[40:43]
  ds_read_b64_tr_b16 a[40:41], v98 offset:57344
  ds_read_b64_tr_b16 a[42:43], v98 offset:61440
  v_mfma_f32_16x16x32_bf16 v[40:43], v[72:75], v[80:83], v[40:43]
  ds_read_b64_tr_b16 a[44:45], v99 offset:57344
  ds_read_b64_tr_b16 a[46:47], v99 offset:61440
  v_mfma_f32_16x16x32_bf16 v[44:47], a[72:75], a[84:87], v[44:47]
  v_mfma_f32_16x16x32_bf16 v[44:47], v[72:75], v[84:87], v[44:47]
  v_mfma_f32_16x16x32_bf16 v[56:59], a[76:79], a[80:83], v[56:59]
  v_mfma_f32_16x16x32_bf16 v[56:59], v[76:79], v[80:83], v[56:59]
  v_mfma_f32_16x16x32_bf16 v[60:63], a[76:79], a[84:87], v[60:63]
  v_mfma_f32_16x16x32_bf16 v[60:63], v[76:79], v[84:87], v[60:63]
  s_waitcnt lgkmcnt(0)
  s_barrier
  v_mfma_f32_16x16x32_bf16 v[8:11], a[0:3], a[16:19], v[8:11]
  ds_read_b64_tr_b16 a[64:65], v96 offset:32768
  ds_read_b64_tr_b16 a[66:67], v96 offset:36864
  v_mfma_f32_16x16x32_bf16 v[8:11], a[32:35], a[48:51], v[8:11]
  ds_read_b128 a[80:83], v107 offset:24576
  ds_read_b64_tr_b16 a[68:69], v97 offset:32768
  v_mfma_f32_16x16x32_bf16 v[12:15], a[0:3], a[20:23], v[12:15]
  ds_read_b64_tr_b16 a[70:71], v97 offset:36864
  ds_read_b128 a[84:87], v107 offset:25600
  v_mfma_f32_16x16x32_bf16 v[12:15], a[32:35], a[52:55], v[12:15]
  ds_read_b64_tr_b16 a[72:73], v98 offset:32768
  ds_read_b64_tr_b16 a[74:75], v98 offset:36864
  v_mfma_f32_16x16x32_bf16 v[24:27], a[4:7], a[16:19], v[24:27]
  ds_read_b64_tr_b16 a[76:77], v99 offset:32768
  ds_read_b64_tr_b16 a[78:79], v99 offset:36864
  v_mfma_f32_16x16x32_bf16 v[24:27], a[36:39], a[48:51], v[24:27]
  ds_read_b64_tr_b16 v[64:65], v96 offset:40960
  ds_read_b64_tr_b16 v[66:67], v96 offset:45056
  v_mfma_f32_16x16x32_bf16 v[28:31], a[4:7], a[20:23], v[28:31]
  ds_read_b128 v[80:83], v107 offset:28672
  ds_read_b64_tr_b16 v[68:69], v97 offset:40960
  v_mfma_f32_16x16x32_bf16 v[28:31], a[36:39], a[52:55], v[28:31]
  ds_read_b64_tr_b16 v[70:71], v97 offset:45056
  ds_read_b128 v[84:87], v107 offset:29696
  v_mfma_f32_16x16x32_bf16 v[40:43], a[8:11], a[16:19], v[40:43]
  ds_read_b64_tr_b16 v[72:73], v98 offset:40960
  ds_read_b64_tr_b16 v[74:75], v98 offset:45056
  v_mfma_f32_16x16x32_bf16 v[40:43], a[40:43], a[48:51], v[40:43]
  ds_read_b64_tr_b16 v[76:77], v99 offset:40960
  ds_read_b64_tr_b16 v[78:79], v99 offset:45056
  v_mfma_f32_16x16x32_bf16 v[44:47], a[8:11], a[20:23], v[44:47]
  v_mfma_f32_16x16x32_bf16 v[44:47], a[40:43], a[52:55], v[44:47]
  v_mfma_f32_16x16x32_bf16 v[56:59], a[12:15], a[16:19], v[56:59]
  v_mfma_f32_16x16x32_bf16 v[56:59], a[44:47], a[48:51], v[56:59]
  v_mfma_f32_16x16x32_bf16 v[60:63], a[12:15], a[20:23], v[60:63]
  v_mfma_f32_16x16x32_bf16 v[60:63], a[44:47], a[52:55], v[60:63]
  s_waitcnt lgkmcnt(0)
  s_barrier
  v_mfma_f32_16x16x32_bf16 v[8:11], a[64:67], a[80:83], v[8:11]
  ds_read_b64_tr_b16 a[0:1], v101 offset:16384
  ds_read_b64_tr_b16 a[2:3], v101 offset:20480
  v_mfma_f32_16x16x32_bf16 v[8:11], v[64:67], v[80:83], v[8:11]
  ds_read_b128 a[16:19], v107 offset:0
  ds_read_b64_tr_b16 a[4:5], v102 offset:16384
  v_mfma_f32_16x16x32_bf16 v[12:15], a[64:67], a[84:87], v[12:15]
  ds_read_b64_tr_b16 a[6:7], v102 offset:20480
  ds_read_b128 a[20:23], v107 offset:1024
  v_mfma_f32_16x16x32_bf16 v[12:15], v[64:67], v[84:87], v[12:15]
  ds_read_b64_tr_b16 a[8:9], v103 offset:16384
  ds_read_b64_tr_b16 a[10:11], v103 offset:20480
  v_mfma_f32_16x16x32_bf16 v[24:27], a[68:71], a[80:83], v[24:27]
  ds_read_b64_tr_b16 a[12:13], v104 offset:16384
  ds_read_b64_tr_b16 a[14:15], v104 offset:20480
  v_mfma_f32_16x16x32_bf16 v[24:27], v[68:71], v[80:83], v[24:27]
  ds_read_b64_tr_b16 a[32:33], v101 offset:24576
  ds_read_b64_tr_b16 a[34:35], v101 offset:28672
  v_mfma_f32_16x16x32_bf16 v[28:31], a[68:71], a[84:87], v[28:31]
  ds_read_b128 a[48:51], v107 offset:4096
  ds_read_b64_tr_b16 a[36:37], v102 offset:24576
  v_mfma_f32_16x16x32_bf16 v[28:31], v[68:71], v[84:87], v[28:31]
  ds_read_b64_tr_b16 a[38:39], v102 offset:28672
  ds_read_b128 a[52:55], v107 offset:5120
  v_mfma_f32_16x16x32_bf16 v[40:43], a[72:75], a[80:83], v[40:43]
  ds_read_b64_tr_b16 a[40:41], v103 offset:24576
  ds_read_b64_tr_b16 a[42:43], v103 offset:28672
  v_mfma_f32_16x16x32_bf16 v[40:43], v[72:75], v[80:83], v[40:43]
  ds_read_b64_tr_b16 a[44:45], v104 offset:24576
  ds_read_b64_tr_b16 a[46:47], v104 offset:28672
  v_mfma_f32_16x16x32_bf16 v[44:47], a[72:75], a[84:87], v[44:47]
  v_mfma_f32_16x16x32_bf16 v[44:47], v[72:75], v[84:87], v[44:47]
  v_mfma_f32_16x16x32_bf16 v[56:59], a[76:79], a[80:83], v[56:59]
  v_mfma_f32_16x16x32_bf16 v[56:59], v[76:79], v[80:83], v[56:59]
  v_mfma_f32_16x16x32_bf16 v[60:63], a[76:79], a[84:87], v[60:63]
  v_mfma_f32_16x16x32_bf16 v[60:63], v[76:79], v[84:87], v[60:63]
  s_waitcnt vmcnt(0)
  v_mov_b32 v114, s1
  v_mov_b32 v115, s41
  s_mov_b64 exec, 1
  buffer_store_dword v114, v115, s[12:15], 0 offen sc1
  s_mov_b64 exec, -1
  s_waitcnt lgkmcnt(0)
  s_barrier
  v_mfma_f32_16x16x32_bf16 v[8:11], a[0:3], a[16:19], v[8:11]
  ds_read_b64_tr_b16 a[64:65], v101 offset:0
  ds_read_b64_tr_b16 a[66:67], v101 offset:4096
  v_mfma_f32_16x16x32_bf16 v[8:11], a[32:35], a[48:51], v[8:11]
  ds_read_b128 a[80:83], v107 offset:8192
  ds_read_b64_tr_b16 a[68:69], v102 offset:0
  v_mfma_f32_16x16x32_bf16 v[12:15], a[0:3], a[20:23], v[12:15]
  ds_read_b64_tr_b16 a[70:71], v102 offset:4096
  ds_read_b128 a[84:87], v107 offset:9216
  v_mfma_f32_16x16x32_bf16 v[12:15], a[32:35], a[52:55], v[12:15]
  ds_read_b64_tr_b16 a[72:73], v103 offset:0
  ds_read_b64_tr_b16 a[74:75], v103 offset:4096
  v_mfma_f32_16x16x32_bf16 v[24:27], a[4:7], a[16:19], v[24:27]
  ds_read_b64_tr_b16 a[76:77], v104 offset:0
  ds_read_b64_tr_b16 a[78:79], v104 offset:4096
  v_mfma_f32_16x16x32_bf16 v[24:27], a[36:39], a[48:51], v[24:27]
  ds_read_b64_tr_b16 v[64:65], v101 offset:8192
  ds_read_b64_tr_b16 v[66:67], v101 offset:12288
  v_mfma_f32_16x16x32_bf16 v[28:31], a[4:7], a[20:23], v[28:31]
  ds_read_b128 v[80:83], v107 offset:12288
  ds_read_b64_tr_b16 v[68:69], v102 offset:8192
  v_mfma_f32_16x16x32_bf16 v[28:31], a[36:39], a[52:55], v[28:31]
  ds_read_b64_tr_b16 v[70:71], v102 offset:12288
  ds_read_b128 v[84:87], v107 offset:13312
  v_mfma_f32_16x16x32_bf16 v[40:43], a[8:11], a[16:19], v[40:43]
  ds_read_b64_tr_b16 v[72:73], v103 offset:8192
  ds_read_b64_tr_b16 v[74:75], v103 offset:12288
  v_mfma_f32_16x16x32_bf16 v[40:43], a[40:43], a[48:51], v[40:43]
  ds_read_b64_tr_b16 v[76:77], v104 offset:8192
  ds_read_b64_tr_b16 v[78:79], v104 offset:12288
  v_mfma_f32_16x16x32_bf16 v[44:47], a[8:11], a[20:23], v[44:47]
  v_mfma_f32_16x16x32_bf16 v[44:47], a[40:43], a[52:55], v[44:47]
  v_mfma_f32_16x16x32_bf16 v[56:59], a[12:15], a[16:19], v[56:59]
  v_mfma_f32_16x16x32_bf16 v[56:59], a[44:47], a[48:51], v[56:59]
  v_mfma_f32_16x16x32_bf16 v[60:63], a[12:15], a[20:23], v[60:63]
  v_mfma_f32_16x16x32_bf16 v[60:63], a[44:47], a[52:55], v[60:63]
  s_waitcnt lgkmcnt(0)
  s_barrier
  v_mfma_f32_16x16x32_bf16 v[8:11], a[64:67], a[80:83], v[8:11]
  ds_read_b64_tr_b16 a[0:1], v101 offset:49152
  ds_read_b64_tr_b16 a[2:3], v101 offset:53248
  v_mfma_f32_16x16x32_bf16 v[8:11], v[64:67], v[80:83], v[8:11]
  ds_read_b128 a[16:19], v107 offset:16384
  ds_read_b64_tr_b16 a[4:5], v102 offset:49152
  v_mfma_f32_16x16x32_bf16 v[12:15], a[64:67], a[84:87], v[12:15]
  ds_read_b64_tr_b16 a[6:7], v102 offset:53248
  ds_read_b128 a[20:23], v107 offset:17408
  v_mfma_f32_16x16x32_bf16 v[12:15], v[64:67], v[84:87], v[12:15]
  ds_read_b64_tr_b16 a[8:9], v103 offset:49152
  ds_read_b64_tr_b16 a[10:11], v103 offset:53248
  v_mfma_f32_16x16x32_bf16 v[24:27], a[68:71], a[80:83], v[24:27]
  ds_read_b64_tr_b16 a[12:13], v104 offset:49152
  ds_read_b64_tr_b16 a[14:15], v104 offset:53248
  v_mfma_f32_16x16x32_bf16 v[24:27], v[68:71], v[80:83], v[24:27]
  ds_read_b64_tr_b16 a[32:33], v101 offset:57344
  ds_read_b64_tr_b16 a[34:35], v101 offset:61440
  v_mfma_f32_16x16x32_bf16 v[28:31], a[68:71], a[84:87], v[28:31]
  ds_read_b128 a[48:51], v107 offset:20480
  ds_read_b64_tr_b16 a[36:37], v102 offset:57344
  v_mfma_f32_16x16x32_bf16 v[28:31], v[68:71], v[84:87], v[28:31]
  ds_read_b64_tr_b16 a[38:39], v102 offset:61440
  ds_read_b128 a[52:55], v107 offset:21504
  v_mfma_f32_16x16x32_bf16 v[40:43], a[72:75], a[80:83], v[40:43]
  ds_read_b64_tr_b16 a[40:41], v103 offset:57344
  ds_read_b64_tr_b16 a[42:43], v103 offset:61440
  v_mfma_f32_16x16x32_bf16 v[40:43], v[72:75], v[80:83], v[40:43]
  ds_read_b64_tr_b16 a[44:45], v104 offset:57344
  ds_read_b64_tr_b16 a[46:47], v104 offset:61440
  v_mfma_f32_16x16x32_bf16 v[44:47], a[72:75], a[84:87], v[44:47]
  v_mfma_f32_16x16x32_bf16 v[44:47], v[72:75], v[84:87], v[44:47]
  v_mfma_f32_16x16x32_bf16 v[56:59], a[76:79], a[80:83], v[56:59]
  v_mfma_f32_16x16x32_bf16 v[56:59], v[76:79], v[80:83], v[56:59]
  v_mfma_f32_16x16x32_bf16 v[60:63], a[76:79], a[84:87], v[60:63]
  v_mfma_f32_16x16x32_bf16 v[60:63], v[76:79], v[84:87], v[60:63]
  s_waitcnt lgkmcnt(0)
  s_barrier
  v_mfma_f32_16x16x32_bf16 v[8:11], a[0:3], a[16:19], v[8:11]
  ds_read_b64_tr_b16 a[64:65], v101 offset:32768
  ds_read_b64_tr_b16 a[66:67], v101 offset:36864
  v_mfma_f32_16x16x32_bf16 v[8:11], a[32:35], a[48:51], v[8:11]
  ds_read_b128 a[80:83], v107 offset:24576
  ds_read_b64_tr_b16 a[68:69], v102 offset:32768
  v_mfma_f32_16x16x32_bf16 v[12:15], a[0:3], a[20:23], v[12:15]
  ds_read_b64_tr_b16 a[70:71], v102 offset:36864
  ds_read_b128 a[84:87], v107 offset:25600
  v_mfma_f32_16x16x32_bf16 v[12:15], a[32:35], a[52:55], v[12:15]
  ds_read_b64_tr_b16 a[72:73], v103 offset:32768
  ds_read_b64_tr_b16 a[74:75], v103 offset:36864
  v_mfma_f32_16x16x32_bf16 v[24:27], a[4:7], a[16:19], v[24:27]
  ds_read_b64_tr_b16 a[76:77], v104 offset:32768
  ds_read_b64_tr_b16 a[78:79], v104 offset:36864
  v_mfma_f32_16x16x32_bf16 v[24:27], a[36:39], a[48:51], v[24:27]
  ds_read_b64_tr_b16 v[64:65], v101 offset:40960
  ds_read_b64_tr_b16 v[66:67], v101 offset:45056
  v_mfma_f32_16x16x32_bf16 v[28:31], a[4:7], a[20:23], v[28:31]
  ds_read_b128 v[80:83], v107 offset:28672
  ds_read_b64_tr_b16 v[68:69], v102 offset:40960
  v_mfma_f32_16x16x32_bf16 v[28:31], a[36:39], a[52:55], v[28:31]
  ds_read_b64_tr_b16 v[70:71], v102 offset:45056
  ds_read_b128 v[84:87], v107 offset:29696
  v_mfma_f32_16x16x32_bf16 v[40:43], a[8:11], a[16:19], v[40:43]
  ds_read_b64_tr_b16 v[72:73], v103 offset:40960
  ds_read_b64_tr_b16 v[74:75], v103 offset:45056
  v_mfma_f32_16x16x32_bf16 v[40:43], a[40:43], a[48:51], v[40:43]
  ds_read_b64_tr_b16 v[76:77], v104 offset:40960
  ds_read_b64_tr_b16 v[78:79], v104 offset:45056
  v_mfma_f32_16x16x32_bf16 v[44:47], a[8:11], a[20:23], v[44:47]
  v_mfma_f32_16x16x32_bf16 v[44:47], a[40:43], a[52:55], v[44:47]
  v_mfma_f32_16x16x32_bf16 v[56:59], a[12:15], a[16:19], v[56:59]
  v_mfma_f32_16x16x32_bf16 v[56:59], a[44:47], a[48:51], v[56:59]
  v_mfma_f32_16x16x32_bf16 v[60:63], a[12:15], a[20:23], v[60:63]
  v_mfma_f32_16x16x32_bf16 v[60:63], a[44:47], a[52:55], v[60:63]
  s_waitcnt lgkmcnt(0)
  s_barrier
  v_mfma_f32_16x16x32_bf16 v[8:11], a[64:67], a[80:83], v[8:11]
  v_mfma_f32_16x16x32_bf16 v[8:11], v[64:67], v[80:83], v[8:11]
  v_mfma_f32_16x16x32_bf16 v[12:15], a[64:67], a[84:87], v[12:15]
  v_mfma_f32_16x16x32_bf16 v[12:15], v[64:67], v[84:87], v[12:15]
  v_mfma_f32_16x16x32_bf16 v[24:27], a[68:71], a[80:83], v[24:27]
  v_mfma_f32_16x16x32_bf16 v[24:27], v[68:71], v[80:83], v[24:27]
  v_mfma_f32_16x16x32_bf16 v[28:31], a[68:71], a[84:87], v[28:31]
  v_mfma_f32_16x16x32_bf16 v[28:31], v[68:71], v[84:87], v[28:31]
  v_mfma_f32_16x16x32_bf16 v[40:43], a[72:75], a[80:83], v[40:43]
  v_mfma_f32_16x16x32_bf16 v[40:43], v[72:75], v[80:83], v[40:43]
  v_mfma_f32_16x16x32_bf16 v[44:47], a[72:75], a[84:87], v[44:47]
  v_mfma_f32_16x16x32_bf16 v[44:47], v[72:75], v[84:87], v[44:47]
  v_mfma_f32_16x16x32_bf16 v[56:59], a[76:79], a[80:83], v[56:59]
  v_mfma_f32_16x16x32_bf16 v[56:59], v[76:79], v[80:83], v[56:59]
  v_mfma_f32_16x16x32_bf16 v[60:63], a[76:79], a[84:87], v[60:63]
  v_mfma_f32_16x16x32_bf16 v[60:63], v[76:79], v[84:87], v[60:63]
  v_mov_b32 v115, s42
  s_mov_b32 s48, 0
C2_poll0:
  buffer_load_dword v114, v115, s[12:15], 0 offen sc1
  s_waitcnt vmcnt(0)
  v_readfirstlane_b32 s43, v114
  s_cmp_eq_u32 s43, s1
  s_cbranch_scc1 C2_poll0_ok
  s_add_u32 s48, s48, 1
  s_cmp_lt_u32 s48, 0x100000
  s_cbranch_scc0 C2_poll0_ok
  s_sleep 1
  s_branch C2_poll0
C2_poll0_ok:
  buffer_load_dwordx4 v[64:67], v112, s[8:11], s40 offen offset:0 sc1
  buffer_load_dwordx4 v[68:71], v112, s[8:11], s40 offen offset:1024 sc1
  buffer_load_dwordx4 v[72:75], v112, s[8:11], s40 offen offset:2048 sc1
  buffer_load_dwordx4 v[76:79], v112, s[8:11], s40 offen offset:3072 sc1
  buffer_load_dwordx4 v[80:83], v113, s[8:11], s40 offen offset:0 sc1
  buffer_load_dwordx4 v[84:87], v113, s[8:11], s40 offen offset:1024 sc1
  buffer_load_dwordx4 v[88:91], v113, s[8:11], s40 offen offset:2048 sc1
  buffer_load_dwordx4 v[92:95], v113, s[8:11], s40 offen offset:3072 sc1
  v_and_b32 v116, 15, v106
  v_lshrrev_b32 v117, 4, v106
  s_lshl_b32 s33, s32, 6
  v_add_u32 v116, s33, v116
  v_lshlrev_b32 v116, 4, v116
  v_add_u32 v116, s24, v116
  v_lshlrev_b32 v116, 11, v116
  v_and_b32 v118, 1, v117
  v_lshlrev_b32 v118, 4, v118
  v_lshrrev_b32 v119, 1, v117
  v_lshl_add_u32 v118, v119, 3, v118
  s_lshl_b32 s33, s25, 7
  s_lshl_b32 s36, s31, 6
  s_add_u32 s33, s33, s36
  v_add_u32 v118, s33, v118
  v_lshl_add_u32 v116, v118, 1, v116
  v_cvt_pk_bf16_f32 v120, v8, v9
  v_cvt_pk_bf16_f32 v121, v10, v11
  v_lshlrev_b32 v8, 16, v120
  v_and_b32 v9, 0xffff0000, v120
  v_lshlrev_b32 v10, 16, v121
  v_and_b32 v11, 0xffff0000, v121
  v_mul_f32 v8, v8, v108
  v_mul_f32 v9, v9, v108
  v_mul_f32 v10, v10, v108
  v_mul_f32 v11, v11, v108
  v_cvt_pk_bf16_f32 v120, v8, v9
  v_cvt_pk_bf16_f32 v121, v10, v11
  v_lshlrev_b32 v8, 16, v120
  v_and_b32 v9, 0xffff0000, v120
  v_lshlrev_b32 v10, 16, v121
  v_and_b32 v11, 0xffff0000, v121
  v_cvt_pk_bf16_f32 v120, v24, v25
  v_cvt_pk_bf16_f32 v121, v26, v27
  v_lshlrev_b32 v24, 16, v120
  v_and_b32 v25, 0xffff0000, v120
  v_lshlrev_b32 v26, 16, v121
  v_and_b32 v27, 0xffff0000, v121
  v_mul_f32 v24, v24, v108
  v_mul_f32 v25, v25, v108
  v_mul_f32 v26, v26, v108
  v_mul_f32 v27, v27, v108
  v_cvt_pk_bf16_f32 v120, v24, v25
  v_cvt_pk_bf16_f32 v121, v26, v27
  v_lshlrev_b32 v24, 16, v120
  v_and_b32 v25, 0xffff0000, v120
  v_lshlrev_b32 v26, 16, v121
  v_and_b32 v27, 0xffff0000, v121
  v_cvt_pk_bf16_f32 v120, v40, v41
  v_cvt_pk_bf16_f32 v121, v42, v43
  v_lshlrev_b32 v40, 16, v120
  v_and_b32 v41, 0xffff0000, v120
  v_lshlrev_b32 v42, 16, v121
  v_and_b32 v43, 0xffff0000, v121
  v_mul_f32 v40, v40, v108
  v_mul_f32 v41, v41, v108
  v_mul_f32 v42, v42, v108
  v_mul_f32 v43, v43, v108
  v_cvt_pk_bf16_f32 v120, v40, v41
  v_cvt_pk_bf16_f32 v121, v42, v43
  v_lshlrev_b32 v40, 16, v120
  v_and_b32 v41, 0xffff0000, v120
  v_lshlrev_b32 v42, 16, v121
  v_and_b32 v43, 0xffff0000, v121
  v_cvt_pk_bf16_f32 v120, v56, v57
  v_cvt_pk_bf16_f32 v121, v58, v59
  v_lshlrev_b32 v56, 16, v120
  v_and_b32 v57, 0xffff0000, v120
  v_lshlrev_b32 v58, 16, v121
  v_and_b32 v59, 0xffff0000, v121
  v_mul_f32 v56, v56, v108
  v_mul_f32 v57, v57, v108
  v_mul_f32 v58, v58, v108
  v_mul_f32 v59, v59, v108
  v_cvt_pk_bf16_f32 v120, v56, v57
  v_cvt_pk_bf16_f32 v121, v58, v59
  v_lshlrev_b32 v56, 16, v120
  v_and_b32 v57, 0xffff0000, v120
  v_lshlrev_b32 v58, 16, v121
  v_and_b32 v59, 0xffff0000, v121
  v_cvt_pk_bf16_f32 v120, v12, v13
  v_cvt_pk_bf16_f32 v121, v14, v15
  v_lshlrev_b32 v12, 16, v120
  v_and_b32 v13, 0xffff0000, v120
  v_lshlrev_b32 v14, 16, v121
  v_and_b32 v15, 0xffff0000, v121
  v_mul_f32 v12, v12, v109
  v_mul_f32 v13, v13, v109
  v_mul_f32 v14, v14, v109
  v_mul_f32 v15, v15, v109
  v_cvt_pk_bf16_f32 v120, v12, v13
  v_cvt_pk_bf16_f32 v121, v14, v15
  v_lshlrev_b32 v12, 16, v120
  v_and_b32 v13, 0xffff0000, v120
  v_lshlrev_b32 v14, 16, v121
  v_and_b32 v15, 0xffff0000, v121
  v_cvt_pk_bf16_f32 v120, v28, v29
  v_cvt_pk_bf16_f32 v121, v30, v31
  v_lshlrev_b32 v28, 16, v120
  v_and_b32 v29, 0xffff0000, v120
  v_lshlrev_b32 v30, 16, v121
  v_and_b32 v31, 0xffff0000, v121
  v_mul_f32 v28, v28, v109
  v_mul_f32 v29, v29, v109
  v_mul_f32 v30, v30, v109
  v_mul_f32 v31, v31, v109
  v_cvt_pk_bf16_f32 v120, v28, v29
  v_cvt_pk_bf16_f32 v121, v30, v31
  v_lshlrev_b32 v28, 16, v120
  v_and_b32 v29, 0xffff0000, v120
  v_lshlrev_b32 v30, 16, v121
  v_and_b32 v31, 0xffff0000, v121
  v_cvt_pk_bf16_f32 v120, v44, v45
  v_cvt_pk_bf16_f32 v121, v46, v47
  v_lshlrev_b32 v44, 16, v120
  v_and_b32 v45, 0xffff0000, v120
  v_lshlrev_b32 v46, 16, v121
  v_and_b32 v47, 0xffff0000, v121
  v_mul_f32 v44, v44, v109
  v_mul_f32 v45, v45, v109
  v_mul_f32 v46, v46, v109
  v_mul_f32 v47, v47, v109
  v_cvt_pk_bf16_f32 v120, v44, v45
  v_cvt_pk_bf16_f32 v121, v46, v47
  v_lshlrev_b32 v44, 16, v120
  v_and_b32 v45, 0xffff0000, v120
  v_lshlrev_b32 v46, 16, v121
  v_and_b32 v47, 0xffff0000, v121
  v_cvt_pk_bf16_f32 v120, v60, v61
  v_cvt_pk_bf16_f32 v121, v62, v63
  v_lshlrev_b32 v60, 16, v120
  v_and_b32 v61, 0xffff0000, v120
  v_lshlrev_b32 v62, 16, v121
  v_and_b32 v63, 0xffff0000, v121
  v_mul_f32 v60, v60, v109
  v_mul_f32 v61, v61, v109
  v_mul_f32 v62, v62, v109
  v_mul_f32 v63, v63, v109
  v_cvt_pk_bf16_f32 v120, v60, v61
  v_cvt_pk_bf16_f32 v121, v62, v63
  v_lshlrev_b32 v60, 16, v120
  v_and_b32 v61, 0xffff0000, v120
  v_lshlrev_b32 v62, 16, v121
  v_and_b32 v63, 0xffff0000, v121
  s_waitcnt vmcnt(4)
  v_add_f32 v0, v0, v64
  v_add_f32 v1, v1, v65
  v_add_f32 v2, v2, v66
  v_add_f32 v3, v3, v67
  v_cvt_pk_bf16_f32 v120, v0, v1
  v_cvt_pk_bf16_f32 v121, v2, v3
  v_lshlrev_b32 v0, 16, v120
  v_and_b32 v1, 0xffff0000, v120
  v_lshlrev_b32 v2, 16, v121
  v_and_b32 v3, 0xffff0000, v121
  v_mul_f32 v0, v0, v110
  v_mul_f32 v1, v1, v110
  v_mul_f32 v2, v2, v110
  v_mul_f32 v3, v3, v110
  v_cvt_pk_bf16_f32 v120, v0, v1
  v_cvt_pk_bf16_f32 v121, v2, v3
  v_lshlrev_b32 v0, 16, v120
  v_and_b32 v1, 0xffff0000, v120
  v_lshlrev_b32 v2, 16, v121
  v_and_b32 v3, 0xffff0000, v121
  v_add_f32 v0, v0, v8
  v_add_f32 v1, v1, v9
  v_add_f32 v2, v2, v10
  v_add_f32 v3, v3, v11
  v_add_f32 v16, v16, v68
  v_add_f32 v17, v17, v69
  v_add_f32 v18, v18, v70
  v_add_f32 v19, v19, v71
  v_cvt_pk_bf16_f32 v120, v16, v17
  v_cvt_pk_bf16_f32 v121, v18, v19
  v_lshlrev_b32 v16, 16, v120
  v_and_b32 v17, 0xffff0000, v120
  v_lshlrev_b32 v18, 16, v121
  v_and_b32 v19, 0xffff0000, v121
  v_mul_f32 v16, v16, v110
  v_mul_f32 v17, v17, v110
  v_mul_f32 v18, v18, v110
  v_mul_f32 v19, v19, v110
  v_cvt_pk_bf16_f32 v120, v16, v17
  v_cvt_pk_bf16_f32 v121, v18, v19
  v_lshlrev_b32 v16, 16, v120
  v_and_b32 v17, 0xffff0000, v120
  v_lshlrev_b32 v18, 16, v121
  v_and_b32 v19, 0xffff0000, v121
  v_add_f32 v16, v16, v24
  v_add_f32 v17, v17, v25
  v_add_f32 v18, v18, v26
  v_add_f32 v19, v19, v27
  v_add_f32 v32, v32, v72
  v_add_f32 v33, v33, v73
  v_add_f32 v34, v34, v74
  v_add_f32 v35, v35, v75
  v_cvt_pk_bf16_f32 v120, v32, v33
  v_cvt_pk_bf16_f32 v121, v34, v35
  v_lshlrev_b32 v32, 16, v120
  v_and_b32 v33, 0xffff0000, v120
  v_lshlrev_b32 v34, 16, v121
  v_and_b32 v35, 0xffff0000, v121
  v_mul_f32 v32, v32, v110
  v_mul_f32 v33, v33, v110
  v_mul_f32 v34, v34, v110
  v_mul_f32 v35, v35, v110
  v_cvt_pk_bf16_f32 v120, v32, v33
  v_cvt_pk_bf16_f32 v121, v34, v35
  v_lshlrev_b32 v32, 16, v120
  v_and_b32 v33, 0xffff0000, v120
  v_lshlrev_b32 v34, 16, v121
  v_and_b32 v35, 0xffff0000, v121
  v_add_f32 v32, v32, v40
  v_add_f32 v33, v33, v41
  v_add_f32 v34, v34, v42
  v_add_f32 v35, v35, v43
  v_add_f32 v48, v48, v76
  v_add_f32 v49, v49, v77
  v_add_f32 v50, v50, v78
  v_add_f32 v51, v51, v79
  v_cvt_pk_bf16_f32 v120, v48, v49
  v_cvt_pk_bf16_f32 v121, v50, v51
  v_lshlrev_b32 v48, 16, v120
  v_and_b32 v49, 0xffff0000, v120
  v_lshlrev_b32 v50, 16, v121
  v_and_b32 v51, 0xffff0000, v121
  v_mul_f32 v48, v48, v110
  v_mul_f32 v49, v49, v110
  v_mul_f32 v50, v50, v110
  v_mul_f32 v51, v51, v110
  v_cvt_pk_bf16_f32 v120, v48, v49
  v_cvt_pk_bf16_f32 v121, v50, v51
  v_lshlrev_b32 v48, 16, v120
  v_and_b32 v49, 0xffff0000, v120
  v_lshlrev_b32 v50, 16, v121
  v_and_b32 v51, 0xffff0000, v121
  v_add_f32 v48, v48, v56
  v_add_f32 v49, v49, v57
  v_add_f32 v50, v50, v58
  v_add_f32 v51, v51, v59
  v_cvt_pk_bf16_f32 v128, v0, v1
  v_cvt_pk_bf16_f32 v129, v2, v3
  v_cvt_pk_bf16_f32 v130, v16, v17
  v_cvt_pk_bf16_f32 v131, v18, v19
  s_nop 1
  v_permlane16_swap_b32 v128, v130
  v_permlane16_swap_b32 v129, v131
  s_mov_b32 s33, 0
  buffer_store_dwordx4 v[128:131], v116, s[16:19], s33 offen offset:0 nt
  v_cvt_pk_bf16_f32 v132, v32, v33
  v_cvt_pk_bf16_f32 v133, v34, v35
  v_cvt_pk_bf16_f32 v134, v48, v49
  v_cvt_pk_bf16_f32 v135, v50, v51
  s_nop 1
  v_permlane16_swap_b32 v132, v134
  v_permlane16_swap_b32 v133, v135
  s_mov_b32 s33, 0
  buffer_store_dwordx4 v[132:135], v116, s[16:19], s33 offen offset:64 nt
  s_waitcnt vmcnt(0)
  v_add_f32 v4, v4, v80
  v_add_f32 v5, v5, v81
  v_add_f32 v6, v6, v82
  v_add_f32 v7, v7, v83
  v_cvt_pk_bf16_f32 v120, v4, v5
  v_cvt_pk_bf16_f32 v121, v6, v7
  v_lshlrev_b32 v4, 16, v120
  v_and_b32 v5, 0xffff0000, v120
  v_lshlrev_b32 v6, 16, v121
  v_and_b32 v7, 0xffff0000, v121
  v_mul_f32 v4, v4, v111
  v_mul_f32 v5, v5, v111
  v_mul_f32 v6, v6, v111
  v_mul_f32 v7, v7, v111
  v_cvt_pk_bf16_f32 v120, v4, v5
  v_cvt_pk_bf16_f32 v121, v6, v7
  v_lshlrev_b32 v4, 16, v120
  v_and_b32 v5, 0xffff0000, v120
  v_lshlrev_b32 v6, 16, v121
  v_and_b32 v7, 0xffff0000, v121
  v_add_f32 v4, v4, v12
  v_add_f32 v5, v5, v13
  v_add_f32 v6, v6, v14
  v_add_f32 v7, v7, v15
  v_add_f32 v20, v20, v84
  v_add_f32 v21, v21, v85
  v_add_f32 v22, v22, v86
  v_add_f32 v23, v23, v87
  v_cvt_pk_bf16_f32 v120, v20, v21
  v_cvt_pk_bf16_f32 v121, v22, v23
  v_lshlrev_b32 v20, 16, v120
  v_and_b32 v21, 0xffff0000, v120
  v_lshlrev_b32 v22, 16, v121
  v_and_b32 v23, 0xffff0000, v121
  v_mul_f32 v20, v20, v111
  v_mul_f32 v21, v21, v111
  v_mul_f32 v22, v22, v111
  v_mul_f32 v23, v23, v111
  v_cvt_pk_bf16_f32 v120, v20, v21
  v_cvt_pk_bf16_f32 v121, v22, v23
  v_lshlrev_b32 v20, 16, v120
  v_and_b32 v21, 0xffff0000, v120
  v_lshlrev_b32 v22, 16, v121
  v_and_b32 v23, 0xffff0000, v121
  v_add_f32 v20, v20, v28
  v_add_f32 v21, v21, v29
  v_add_f32 v22, v22, v30
  v_add_f32 v23, v23, v31
  v_add_f32 v36, v36, v88
  v_add_f32 v37, v37, v89
  v_add_f32 v38, v38, v90
  v_add_f32 v39, v39, v91
  v_cvt_pk_bf16_f32 v120, v36, v37
  v_cvt_pk_bf16_f32 v121, v38, v39
  v_lshlrev_b32 v36, 16, v120
  v_and_b32 v37, 0xffff0000, v120
  v_lshlrev_b32 v38, 16, v121
  v_and_b32 v39, 0xffff0000, v121
  v_mul_f32 v36, v36, v111
  v_mul_f32 v37, v37, v111
  v_mul_f32 v38, v38, v111
  v_mul_f32 v39, v39, v111
  v_cvt_pk_bf16_f32 v120, v36, v37
  v_cvt_pk_bf16_f32 v121, v38, v39
  v_lshlrev_b32 v36, 16, v120
  v_and_b32 v37, 0xffff0000, v120
  v_lshlrev_b32 v38, 16, v121
  v_and_b32 v39, 0xffff0000, v121
  v_add_f32 v36, v36, v44
  v_add_f32 v37, v37, v45
  v_add_f32 v38, v38, v46
  v_add_f32 v39, v39, v47
  v_add_f32 v52, v52, v92
  v_add_f32 v53, v53, v93
  v_add_f32 v54, v54, v94
  v_add_f32 v55, v55, v95
  v_cvt_pk_bf16_f32 v120, v52, v53
  v_cvt_pk_bf16_f32 v121, v54, v55
  v_lshlrev_b32 v52, 16, v120
  v_and_b32 v53, 0xffff0000, v120
  v_lshlrev_b32 v54, 16, v121
  v_and_b32 v55, 0xffff0000, v121
  v_mul_f32 v52, v52, v111
  v_mul_f32 v53, v53, v111
  v_mul_f32 v54, v54, v111
  v_mul_f32 v55, v55, v111
  v_cvt_pk_bf16_f32 v120, v52, v53
  v_cvt_pk_bf16_f32 v121, v54, v55
  v_lshlrev_b32 v52, 16, v120
  v_and_b32 v53, 0xffff0000, v120
  v_lshlrev_b32 v54, 16, v121
  v_and_b32 v55, 0xffff0000, v121
  v_add_f32 v52, v52, v60
  v_add_f32 v53, v53, v61
  v_add_f32 v54, v54, v62
  v_add_f32 v55, v55, v63
  v_cvt_pk_bf16_f32 v136, v4, v5
  v_cvt_pk_bf16_f32 v137, v6, v7
  v_cvt_pk_bf16_f32 v138, v20, v21
  v_cvt_pk_bf16_f32 v139, v22, v23
  s_nop 1
  v_permlane16_swap_b32 v136, v138
  v_permlane16_swap_b32 v137, v139
  s_mov_b32 s33, 524288
  buffer_store_dwordx4 v[136:139], v116, s[16:19], s33 offen offset:0 nt
  v_cvt_pk_bf16_f32 v140, v36, v37
  v_cvt_pk_bf16_f32 v141, v38, v39
  v_cvt_pk_bf16_f32 v142, v52, v53
  v_cvt_pk_bf16_f32 v143, v54, v55
  s_nop 1
  v_permlane16_swap_b32 v140, v142
  v_permlane16_swap_b32 v141, v143
  s_mov_b32 s33, 524288
  buffer_store_dwordx4 v[140:143], v116, s[16:19], s33 offen offset:64 nt
  s_branch C2_fin
C2_x1:
  buffer_store_dwordx4 v[0:3], v112, s[8:11], s39 offen offset:0 sc1
  buffer_store_dwordx4 v[16:19], v112, s[8:11], s39 offen offset:1024 sc1
  buffer_store_dwordx4 v[32:35], v112, s[8:11], s39 offen offset:2048 sc1
  buffer_store_dwordx4 v[48:51], v112, s[8:11], s39 offen offset:3072 sc1
  buffer_store_dwordx4 v[4:7], v113, s[8:11], s39 offen offset:0 sc1
  buffer_store_dwordx4 v[20:23], v113, s[8:11], s39 offen offset:1024 sc1
  buffer_store_dwordx4 v[36:39], v113, s[8:11], s39 offen offset:2048 sc1
  buffer_store_dwordx4 v[52:55], v113, s[8:11], s39 offen offset:3072 sc1
  s_nop 1
  v_mov_b32 v0, 0
  v_mov_b32 v1, 0
  v_mov_b32 v2, 0
  v_mov_b32 v3, 0
  v_mov_b32 v16, 0
  v_mov_b32 v17, 0
  v_mov_b32 v18, 0
  v_mov_b32 v19, 0
  v_mov_b32 v32, 0
  v_mov_b32 v33, 0
  v_mov_b32 v34, 0
  v_mov_b32 v35, 0
  v_mov_b32 v48, 0
  v_mov_b32 v49, 0
  v_mov_b32 v50, 0
  v_mov_b32 v51, 0
  v_mov_b32 v4, 0
  v_mov_b32 v5, 0
  v_mov_b32 v6, 0
  v_mov_b32 v7, 0
  v_mov_b32 v20, 0
  v_mov_b32 v21, 0
  v_mov_b32 v22, 0
  v_mov_b32 v23, 0
  v_mov_b32 v36, 0
  v_mov_b32 v37, 0
  v_mov_b32 v38, 0
  v_mov_b32 v39, 0
  v_mov_b32 v52, 0
  v_mov_b32 v53, 0
  v_mov_b32 v54, 0
  v_mov_b32 v55, 0
  s_waitcnt lgkmcnt(0)
  v_mfma_f32_16x16x32_bf16 v[0:3], a[0:3], a[16:19], v[0:3]
  ds_read_b64_tr_b16 a[64:65], v96 offset:0
  ds_read_b64_tr_b16 a[66:67], v96 offset:4096
  v_mfma_f32_16x16x32_bf16 v[0:3], a[32:35], a[48:51], v[0:3]
  ds_read_b128 a[80:83], v107 offset:8192
  ds_read_b64_tr_b16 a[68:69], v97 offset:0
  v_mfma_f32_16x16x32_bf16 v[4:7], a[0:3], a[20:23], v[4:7]
  ds_read_b64_tr_b16 a[70:71], v97 offset:4096
  ds_read_b128 a[84:87], v107 offset:9216
  v_mfma_f32_16x16x32_bf16 v[4:7], a[32:35], a[52:55], v[4:7]
  ds_read_b64_tr_b16 a[72:73], v98 offset:0
  ds_read_b64_tr_b16 a[74:75], v98 offset:4096
  v_mfma_f32_16x16x32_bf16 v[16:19], a[4:7], a[16:19], v[16:19]
  ds_read_b64_tr_b16 a[76:77], v99 offset:0
  ds_read_b64_tr_b16 a[78:79], v99 offset:4096
  v_mfma_f32_16x16x32_bf16 v[16:19], a[36:39], a[48:51], v[16:19]
  ds_read_b64_tr_b16 v[64:65], v96 offset:8192
  ds_read_b64_tr_b16 v[66:67], v96 offset:12288
  v_mfma_f32_16x16x32_bf16 v[20:23], a[4:7], a[20:23], v[20:23]
  ds_read_b128 v[80:83], v107 offset:12288
  ds_read_b64_tr_b16 v[68:69], v97 offset:8192
  v_mfma_f32_16x16x32_bf16 v[20:23], a[36:39], a[52:55], v[20:23]
  ds_read_b64_tr_b16 v[70:71], v97 offset:12288
  ds_read_b128 v[84:87], v107 offset:13312
  v_mfma_f32_16x16x32_bf16 v[32:35], a[8:11], a[16:19], v[32:35]
  ds_read_b64_tr_b16 v[72:73], v98 offset:8192
  ds_read_b64_tr_b16 v[74:75], v98 offset:12288
  v_mfma_f32_16x16x32_bf16 v[32:35], a[40:43], a[48:51], v[32:35]
  ds_read_b64_tr_b16 v[76:77], v99 offset:8192
  ds_read_b64_tr_b16 v[78:79], v99 offset:12288
  v_mfma_f32_16x16x32_bf16 v[36:39], a[8:11], a[20:23], v[36:39]
  v_mfma_f32_16x16x32_bf16 v[36:39], a[40:43], a[52:55], v[36:39]
  v_mfma_f32_16x16x32_bf16 v[48:51], a[12:15], a[16:19], v[48:51]
  v_mfma_f32_16x16x32_bf16 v[48:51], a[44:47], a[48:51], v[48:51]
  v_mfma_f32_16x16x32_bf16 v[52:55], a[12:15], a[20:23], v[52:55]
  v_mfma_f32_16x16x32_bf16 v[52:55], a[44:47], a[52:55], v[52:55]
  s_waitcnt lgkmcnt(0)
  s_barrier
  v_mfma_f32_16x16x32_bf16 v[0:3], a[64:67], a[80:83], v[0:3]
  ds_read_b64_tr_b16 a[0:1], v96 offset:49152
  ds_read_b64_tr_b16 a[2:3], v96 offset:53248
  v_mfma_f32_16x16x32_bf16 v[0:3], v[64:67], v[80:83], v[0:3]
  ds_read_b128 a[16:19], v107 offset:16384
  ds_read_b64_tr_b16 a[4:5], v97 offset:49152
  v_mfma_f32_16x16x32_bf16 v[4:7], a[64:67], a[84:87], v[4:7]
  ds_read_b64_tr_b16 a[6:7], v97 offset:53248
  ds_read_b128 a[20:23], v107 offset:17408
  v_mfma_f32_16x16x32_bf16 v[4:7], v[64:67], v[84:87], v[4:7]
  ds_read_b64_tr_b16 a[8:9], v98 offset:49152
  ds_read_b64_tr_b16 a[10:11], v98 offset:53248
  v_mfma_f32_16x16x32_bf16 v[16:19], a[68:71], a[80:83], v[16:19]
  ds_read_b64_tr_b16 a[12:13], v99 offset:49152
  ds_read_b64_tr_b16 a[14:15], v99 offset:53248
  v_mfma_f32_16x16x32_bf16 v[16:19], v[68:71], v[80:83], v[16:19]
  ds_read_b64_tr_b16 a[32:33], v96 offset:57344
  ds_read_b64_tr_b16 a[34:35], v96 offset:61440
  v_mfma_f32_16x16x32_bf16 v[20:23], a[68:71], a[84:87], v[20:23]
  ds_read_b128 a[48:51], v107 offset:20480
  ds_read_b64_tr_b16 a[36:37], v97 offset:57344
  v_mfma_f32_16x16x32_bf16 v[20:23], v[68:71], v[84:87], v[20:23]
  ds_read_b64_tr_b16 a[38:39], v97 offset:61440
  ds_read_b128 a[52:55], v107 offset:21504
  v_mfma_f32_16x16x32_bf16 v[32:35], a[72:75], a[80:83], v[32:35]
  ds_read_b64_tr_b16 a[40:41], v98 offset:57344
  ds_read_b64_tr_b16 a[42:43], v98 offset:61440
  v_mfma_f32_16x16x32_bf16 v[32:35], v[72:75], v[80:83], v[32:35]
  ds_read_b64_tr_b16 a[44:45], v99 offset:57344
  ds_read_b64_tr_b16 a[46:47], v99 offset:61440
  v_mfma_f32_16x16x32_bf16 v[36:39], a[72:75], a[84:87], v[36:39]
  v_mfma_f32_16x16x32_bf16 v[36:39], v[72:75], v[84:87], v[36:39]
  v_mfma_f32_16x16x32_bf16 v[48:51], a[76:79], a[80:83], v[48:51]
  v_mfma_f32_16x16x32_bf16 v[48:51], v[76:79], v[80:83], v[48:51]
  v_mfma_f32_16x16x32_bf16 v[52:55], a[76:79], a[84:87], v[52:55]
  v_mfma_f32_16x16x32_bf16 v[52:55], v[76:79], v[84:87], v[52:55]
  s_waitcnt lgkmcnt(0)
  s_barrier
  v_mfma_f32_16x16x32_bf16 v[0:3], a[0:3], a[16:19], v[0:3]
  ds_read_b64_tr_b16 a[64:65], v96 offset:32768
  ds_read_b64_tr_b16 a[66:67], v96 offset:36864
  v_mfma_f32_16x16x32_bf16 v[0:3], a[32:35], a[48:51], v[0:3]
  ds_read_b128 a[80:83], v107 offset:24576
  ds_read_b64_tr_b16 a[68:69], v97 offset:32768
  v_mfma_f32_16x16x32_bf16 v[4:7], a[0:3], a[20:23], v[4:7]
  ds_read_b64_tr_b16 a[70:71], v97 offset:36864
  ds_read_b128 a[84:87], v107 offset:25600
  v_mfma_f32_16x16x32_bf16 v[4:7], a[32:35], a[52:55], v[4:7]
  ds_read_b64_tr_b16 a[72:73], v98 offset:32768
  ds_read_b64_tr_b16 a[74:75], v98 offset:36864
  v_mfma_f32_16x16x32_bf16 v[16:19], a[4:7], a[16:19], v[16:19]
  ds_read_b64_tr_b16 a[76:77], v99 offset:32768
  ds_read_b64_tr_b16 a[78:79], v99 offset:36864
  v_mfma_f32_16x16x32_bf16 v[16:19], a[36:39], a[48:51], v[16:19]
  ds_read_b64_tr_b16 v[64:65], v96 offset:40960
  ds_read_b64_tr_b16 v[66:67], v96 offset:45056
  v_mfma_f32_16x16x32_bf16 v[20:23], a[4:7], a[20:23], v[20:23]
  ds_read_b128 v[80:83], v107 offset:28672
  ds_read_b64_tr_b16 v[68:69], v97 offset:40960
  v_mfma_f32_16x16x32_bf16 v[20:23], a[36:39], a[52:55], v[20:23]
  ds_read_b64_tr_b16 v[70:71], v97 offset:45056
  ds_read_b128 v[84:87], v107 offset:29696
  v_mfma_f32_16x16x32_bf16 v[32:35], a[8:11], a[16:19], v[32:35]
  ds_read_b64_tr_b16 v[72:73], v98 offset:40960
  ds_read_b64_tr_b16 v[74:75], v98 offset:45056
  v_mfma_f32_16x16x32_bf16 v[32:35], a[40:43], a[48:51], v[32:35]
  ds_read_b64_tr_b16 v[76:77], v99 offset:40960
  ds_read_b64_tr_b16 v[78:79], v99 offset:45056
  v_mfma_f32_16x16x32_bf16 v[36:39], a[8:11], a[20:23], v[36:39]
  v_mfma_f32_16x16x32_bf16 v[36:39], a[40:43], a[52:55], v[36:39]
  v_mfma_f32_16x16x32_bf16 v[48:51], a[12:15], a[16:19], v[48:51]
  v_mfma_f32_16x16x32_bf16 v[48:51], a[44:47], a[48:51], v[48:51]
  v_mfma_f32_16x16x32_bf16 v[52:55], a[12:15], a[20:23], v[52:55]
  v_mfma_f32_16x16x32_bf16 v[52:55], a[44:47], a[52:55], v[52:55]
  s_waitcnt lgkmcnt(0)
  s_barrier
  v_mfma_f32_16x16x32_bf16 v[0:3], a[64:67], a[80:83], v[0:3]
  ds_read_b64_tr_b16 a[0:1], v101 offset:16384
  ds_read_b64_tr_b16 a[2:3], v101 offset:20480
  v_mfma_f32_16x16x32_bf16 v[0:3], v[64:67], v[80:83], v[0:3]
  ds_read_b128 a[16:19], v107 offset:0
  ds_read_b64_tr_b16 a[4:5], v102 offset:16384
  v_mfma_f32_16x16x32_bf16 v[4:7], a[64:67], a[84:87], v[4:7]
  ds_read_b64_tr_b16 a[6:7], v102 offset:20480
  ds_read_b128 a[20:23], v107 offset:1024
  v_mfma_f32_16x16x32_bf16 v[4:7], v[64:67], v[84:87], v[4:7]
  ds_read_b64_tr_b16 a[8:9], v103 offset:16384
  ds_read_b64_tr_b16 a[10:11], v103 offset:20480
  v_mfma_f32_16x16x32_bf16 v[16:19], a[68:71], a[80:83], v[16:19]
  ds_read_b64_tr_b16 a[12:13], v104 offset:16384
  ds_read_b64_tr_b16 a[14:15], v104 offset:20480
  v_mfma_f32_16x16x32_bf16 v[16:19], v[68:71], v[80:83], v[16:19]
  ds_read_b64_tr_b16 a[32:33], v101 offset:24576
  ds_read_b64_tr_b16 a[34:35], v101 offset:28672
  v_mfma_f32_16x16x32_bf16 v[20:23], a[68:71], a[84:87], v[20:23]
  ds_read_b128 a[48:51], v107 offset:4096
  ds_read_b64_tr_b16 a[36:37], v102 offset:24576
  v_mfma_f32_16x16x32_bf16 v[20:23], v[68:71], v[84:87], v[20:23]
  ds_read_b64_tr_b16 a[38:39], v102 offset:28672
  ds_read_b128 a[52:55], v107 offset:5120
  v_mfma_f32_16x16x32_bf16 v[32:35], a[72:75], a[80:83], v[32:35]
  ds_read_b64_tr_b16 a[40:41], v103 offset:24576
  ds_read_b64_tr_b16 a[42:43], v103 offset:28672
  v_mfma_f32_16x16x32_bf16 v[32:35], v[72:75], v[80:83], v[32:35]
  ds_read_b64_tr_b16 a[44:45], v104 offset:24576
  ds_read_b64_tr_b16 a[46:47], v104 offset:28672
  v_mfma_f32_16x16x32_bf16 v[36:39], a[72:75], a[84:87], v[36:39]
  v_mfma_f32_16x16x32_bf16 v[36:39], v[72:75], v[84:87], v[36:39]
  v_mfma_f32_16x16x32_bf16 v[48:51], a[76:79], a[80:83], v[48:51]
  v_mfma_f32_16x16x32_bf16 v[48:51], v[76:79], v[80:83], v[48:51]
  v_mfma_f32_16x16x32_bf16 v[52:55], a[76:79], a[84:87], v[52:55]
  v_mfma_f32_16x16x32_bf16 v[52:55], v[76:79], v[84:87], v[52:55]
  s_waitcnt vmcnt(0)
  v_mov_b32 v114, s1
  v_mov_b32 v115, s41
  s_mov_b64 exec, 1
  buffer_store_dword v114, v115, s[12:15], 0 offen sc1
  s_mov_b64 exec, -1
  s_waitcnt lgkmcnt(0)
  s_barrier
  v_mfma_f32_16x16x32_bf16 v[0:3], a[0:3], a[16:19], v[0:3]
  ds_read_b64_tr_b16 a[64:65], v101 offset:0
  ds_read_b64_tr_b16 a[66:67], v101 offset:4096
  v_mfma_f32_16x16x32_bf16 v[0:3], a[32:35], a[48:51], v[0:3]
  ds_read_b128 a[80:83], v107 offset:8192
  ds_read_b64_tr_b16 a[68:69], v102 offset:0
  v_mfma_f32_16x16x32_bf16 v[4:7], a[0:3], a[20:23], v[4:7]
  ds_read_b64_tr_b16 a[70:71], v102 offset:4096
  ds_read_b128 a[84:87], v107 offset:9216
  v_mfma_f32_16x16x32_bf16 v[4:7], a[32:35], a[52:55], v[4:7]
  ds_read_b64_tr_b16 a[72:73], v103 offset:0
  ds_read_b64_tr_b16 a[74:75], v103 offset:4096
  v_mfma_f32_16x16x32_bf16 v[16:19], a[4:7], a[16:19], v[16:19]
  ds_read_b64_tr_b16 a[76:77], v104 offset:0
  ds_read_b64_tr_b16 a[78:79], v104 offset:4096
  v_mfma_f32_16x16x32_bf16 v[16:19], a[36:39], a[48:51], v[16:19]
  ds_read_b64_tr_b16 v[64:65], v101 offset:8192
  ds_read_b64_tr_b16 v[66:67], v101 offset:12288
  v_mfma_f32_16x16x32_bf16 v[20:23], a[4:7], a[20:23], v[20:23]
  ds_read_b128 v[80:83], v107 offset:12288
  ds_read_b64_tr_b16 v[68:69], v102 offset:8192
  v_mfma_f32_16x16x32_bf16 v[20:23], a[36:39], a[52:55], v[20:23]
  ds_read_b64_tr_b16 v[70:71], v102 offset:12288
  ds_read_b128 v[84:87], v107 offset:13312
  v_mfma_f32_16x16x32_bf16 v[32:35], a[8:11], a[16:19], v[32:35]
  ds_read_b64_tr_b16 v[72:73], v103 offset:8192
  ds_read_b64_tr_b16 v[74:75], v103 offset:12288
  v_mfma_f32_16x16x32_bf16 v[32:35], a[40:43], a[48:51], v[32:35]
  ds_read_b64_tr_b16 v[76:77], v104 offset:8192
  ds_read_b64_tr_b16 v[78:79], v104 offset:12288
  v_mfma_f32_16x16x32_bf16 v[36:39], a[8:11], a[20:23], v[36:39]
  v_mfma_f32_16x16x32_bf16 v[36:39], a[40:43], a[52:55], v[36:39]
  v_mfma_f32_16x16x32_bf16 v[48:51], a[12:15], a[16:19], v[48:51]
  v_mfma_f32_16x16x32_bf16 v[48:51], a[44:47], a[48:51], v[48:51]
  v_mfma_f32_16x16x32_bf16 v[52:55], a[12:15], a[20:23], v[52:55]
  v_mfma_f32_16x16x32_bf16 v[52:55], a[44:47], a[52:55], v[52:55]
  s_waitcnt lgkmcnt(0)
  s_barrier
  v_mfma_f32_16x16x32_bf16 v[0:3], a[64:67], a[80:83], v[0:3]
  ds_read_b64_tr_b16 a[0:1], v101 offset:49152
  ds_read_b64_tr_b16 a[2:3], v101 offset:53248
  v_mfma_f32_16x16x32_bf16 v[0:3], v[64:67], v[80:83], v[0:3]
  ds_read_b128 a[16:19], v107 offset:16384
  ds_read_b64_tr_b16 a[4:5], v102 offset:49152
  v_mfma_f32_16x16x32_bf16 v[4:7], a[64:67], a[84:87], v[4:7]
  ds_read_b64_tr_b16 a[6:7], v102 offset:53248
  ds_read_b128 a[20:23], v107 offset:17408
  v_mfma_f32_16x16x32_bf16 v[4:7], v[64:67], v[84:87], v[4:7]
  ds_read_b64_tr_b16 a[8:9], v103 offset:49152
  ds_read_b64_tr_b16 a[10:11], v103 offset:53248
  v_mfma_f32_16x16x32_bf16 v[16:19], a[68:71], a[80:83], v[16:19]
  ds_read_b64_tr_b16 a[12:13], v104 offset:49152
  ds_read_b64_tr_b16 a[14:15], v104 offset:53248
  v_mfma_f32_16x16x32_bf16 v[16:19], v[68:71], v[80:83], v[16:19]
  ds_read_b64_tr_b16 a[32:33], v101 offset:57344
  ds_read_b64_tr_b16 a[34:35], v101 offset:61440
  v_mfma_f32_16x16x32_bf16 v[20:23], a[68:71], a[84:87], v[20:23]
  ds_read_b128 a[48:51], v107 offset:20480
  ds_read_b64_tr_b16 a[36:37], v102 offset:57344
  v_mfma_f32_16x16x32_bf16 v[20:23], v[68:71], v[84:87], v[20:23]
  ds_read_b64_tr_b16 a[38:39], v102 offset:61440
  ds_read_b128 a[52:55], v107 offset:21504
  v_mfma_f32_16x16x32_bf16 v[32:35], a[72:75], a[80:83], v[32:35]
  ds_read_b64_tr_b16 a[40:41], v103 offset:57344
  ds_read_b64_tr_b16 a[42:43], v103 offset:61440
  v_mfma_f32_16x16x32_bf16 v[32:35], v[72:75], v[80:83], v[32:35]
  ds_read_b64_tr_b16 a[44:45], v104 offset:57344
  ds_read_b64_tr_b16 a[46:47], v104 offset:61440
  v_mfma_f32_16x16x32_bf16 v[36:39], a[72:75], a[84:87], v[36:39]
  v_mfma_f32_16x16x32_bf16 v[36:39], v[72:75], v[84:87], v[36:39]
  v_mfma_f32_16x16x32_bf16 v[48:51], a[76:79], a[80:83], v[48:51]
  v_mfma_f32_16x16x32_bf16 v[48:51], v[76:79], v[80:83], v[48:51]
  v_mfma_f32_16x16x32_bf16 v[52:55], a[76:79], a[84:87], v[52:55]
  v_mfma_f32_16x16x32_bf16 v[52:55], v[76:79], v[84:87], v[52:55]
  s_waitcnt lgkmcnt(0)
  s_barrier
  v_mfma_f32_16x16x32_bf16 v[0:3], a[0:3], a[16:19], v[0:3]
  ds_read_b64_tr_b16 a[64:65], v101 offset:32768
  ds_read_b64_tr_b16 a[66:67], v101 offset:36864
  v_mfma_f32_16x16x32_bf16 v[0:3], a[32:35], a[48:51], v[0:3]
  ds_read_b128 a[80:83], v107 offset:24576
  ds_read_b64_tr_b16 a[68:69], v102 offset:32768
  v_mfma_f32_16x16x32_bf16 v[4:7], a[0:3], a[20:23], v[4:7]
  ds_read_b64_tr_b16 a[70:71], v102 offset:36864
  ds_read_b128 a[84:87], v107 offset:25600
  v_mfma_f32_16x16x32_bf16 v[4:7], a[32:35], a[52:55], v[4:7]
  ds_read_b64_tr_b16 a[72:73], v103 offset:32768
  ds_read_b64_tr_b16 a[74:75], v103 offset:36864
  v_mfma_f32_16x16x32_bf16 v[16:19], a[4:7], a[16:19], v[16:19]
  ds_read_b64_tr_b16 a[76:77], v104 offset:32768
  ds_read_b64_tr_b16 a[78:79], v104 offset:36864
  v_mfma_f32_16x16x32_bf16 v[16:19], a[36:39], a[48:51], v[16:19]
  ds_read_b64_tr_b16 v[64:65], v101 offset:40960
  ds_read_b64_tr_b16 v[66:67], v101 offset:45056
  v_mfma_f32_16x16x32_bf16 v[20:23], a[4:7], a[20:23], v[20:23]
  ds_read_b128 v[80:83], v107 offset:28672
  ds_read_b64_tr_b16 v[68:69], v102 offset:40960
  v_mfma_f32_16x16x32_bf16 v[20:23], a[36:39], a[52:55], v[20:23]
  ds_read_b64_tr_b16 v[70:71], v102 offset:45056
  ds_read_b128 v[84:87], v107 offset:29696
  v_mfma_f32_16x16x32_bf16 v[32:35], a[8:11], a[16:19], v[32:35]
  ds_read_b64_tr_b16 v[72:73], v103 offset:40960
  ds_read_b64_tr_b16 v[74:75], v103 offset:45056
  v_mfma_f32_16x16x32_bf16 v[32:35], a[40:43], a[48:51], v[32:35]
  ds_read_b64_tr_b16 v[76:77], v104 offset:40960
  ds_read_b64_tr_b16 v[78:79], v104 offset:45056
  v_mfma_f32_16x16x32_bf16 v[36:39], a[8:11], a[20:23], v[36:39]
  v_mfma_f32_16x16x32_bf16 v[36:39], a[40:43], a[52:55], v[36:39]
  v_mfma_f32_16x16x32_bf16 v[48:51], a[12:15], a[16:19], v[48:51]
  v_mfma_f32_16x16x32_bf16 v[48:51], a[44:47], a[48:51], v[48:51]
  v_mfma_f32_16x16x32_bf16 v[52:55], a[12:15], a[20:23], v[52:55]
  v_mfma_f32_16x16x32_bf16 v[52:55], a[44:47], a[52:55], v[52:55]
  s_waitcnt lgkmcnt(0)
  s_barrier
  v_mfma_f32_16x16x32_bf16 v[0:3], a[64:67], a[80:83], v[0:3]
  v_mfma_f32_16x16x32_bf16 v[0:3], v[64:67], v[80:83], v[0:3]
  v_mfma_f32_16x16x32_bf16 v[4:7], a[64:67], a[84:87], v[4:7]
  v_mfma_f32_16x16x32_bf16 v[4:7], v[64:67], v[84:87], v[4:7]
  v_mfma_f32_16x16x32_bf16 v[16:19], a[68:71], a[80:83], v[16:19]
  v_mfma_f32_16x16x32_bf16 v[16:19], v[68:71], v[80:83], v[16:19]
  v_mfma_f32_16x16x32_bf16 v[20:23], a[68:71], a[84:87], v[20:23]
  v_mfma_f32_16x16x32_bf16 v[20:23], v[68:71], v[84:87], v[20:23]
  v_mfma_f32_16x16x32_bf16 v[32:35], a[72:75], a[80:83], v[32:35]
  v_mfma_f32_16x16x32_bf16 v[32:35], v[72:75], v[80:83], v[32:35]
  v_mfma_f32_16x16x32_bf16 v[36:39], a[72:75], a[84:87], v[36:39]
  v_mfma_f32_16x16x32_bf16 v[36:39], v[72:75], v[84:87], v[36:39]
  v_mfma_f32_16x16x32_bf16 v[48:51], a[76:79], a[80:83], v[48:51]
  v_mfma_f32_16x16x32_bf16 v[48:51], v[76:79], v[80:83], v[48:51]
  v_mfma_f32_16x16x32_bf16 v[52:55], a[76:79], a[84:87], v[52:55]
  v_mfma_f32_16x16x32_bf16 v[52:55], v[76:79], v[84:87], v[52:55]
  v_mov_b32 v115, s42
  s_mov_b32 s48, 0
C2_poll1:
  buffer_load_dword v114, v115, s[12:15], 0 offen sc1
  s_waitcnt vmcnt(0)
  v_readfirstlane_b32 s43, v114
  s_cmp_eq_u32 s43, s1
  s_cbranch_scc1 C2_poll1_ok
  s_add_u32 s48, s48, 1
  s_cmp_lt_u32 s48, 0x100000
  s_cbranch_scc0 C2_poll1_ok
  s_sleep 1
  s_branch C2_poll1
C2_poll1_ok:
  buffer_load_dwordx4 v[64:67], v112, s[8:11], s40 offen offset:0 sc1
  buffer_load_dwordx4 v[68:71], v112, s[8:11], s40 offen offset:1024 sc1
  buffer_load_dwordx4 v[72:75], v112, s[8:11], s40 offen offset:2048 sc1
  buffer_load_dwordx4 v[76:79], v112, s[8:11], s40 offen offset:3072 sc1
  buffer_load_dwordx4 v[80:83], v113, s[8:11], s40 offen offset:0 sc1
  buffer_load_dwordx4 v[84:87], v113, s[8:11], s40 offen offset:1024 sc1
  buffer_load_dwordx4 v[88:91], v113, s[8:11], s40 offen offset:2048 sc1
  buffer_load_dwordx4 v[92:95], v113, s[8:11], s40 offen offset:3072 sc1
  v_and_b32 v116, 15, v106
  v_lshrrev_b32 v117, 4, v106
  s_lshl_b32 s33, s32, 6
  v_add_u32 v116, s33, v116
  v_lshlrev_b32 v116, 4, v116
  v_add_u32 v116, s24, v116
  v_lshlrev_b32 v116, 11, v116
  v_and_b32 v118, 1, v117
  v_lshlrev_b32 v118, 4, v118
  v_lshrrev_b32 v119, 1, v117
  v_lshl_add_u32 v118, v119, 3, v118
  s_lshl_b32 s33, s25, 7
  s_lshl_b32 s36, s31, 6
  s_add_u32 s33, s33, s36
  v_add_u32 v118, s33, v118
  v_lshl_add_u32 v116, v118, 1, v116
  v_cvt_pk_bf16_f32 v120, v0, v1
  v_cvt_pk_bf16_f32 v121, v2, v3
  v_lshlrev_b32 v0, 16, v120
  v_and_b32 v1, 0xffff0000, v120
  v_lshlrev_b32 v2, 16, v121
  v_and_b32 v3, 0xffff0000, v121
  v_mul_f32 v0, v0, v108
  v_mul_f32 v1, v1, v108
  v_mul_f32 v2, v2, v108
  v_mul_f32 v3, v3, v108
  v_cvt_pk_bf16_f32 v120, v0, v1
  v_cvt_pk_bf16_f32 v121, v2, v3
  v_lshlrev_b32 v0, 16, v120
  v_and_b32 v1, 0xffff0000, v120
  v_lshlrev_b32 v2, 16, v121
  v_and_b32 v3, 0xffff0000, v121
  v_cvt_pk_bf16_f32 v120, v16, v17
  v_cvt_pk_bf16_f32 v121, v18, v19
  v_lshlrev_b32 v16, 16, v120
  v_and_b32 v17, 0xffff0000, v120
  v_lshlrev_b32 v18, 16, v121
  v_and_b32 v19, 0xffff0000, v121
  v_mul_f32 v16, v16, v108
  v_mul_f32 v17, v17, v108
  v_mul_f32 v18, v18, v108
  v_mul_f32 v19, v19, v108
  v_cvt_pk_bf16_f32 v120, v16, v17
  v_cvt_pk_bf16_f32 v121, v18, v19
  v_lshlrev_b32 v16, 16, v120
  v_and_b32 v17, 0xffff0000, v120
  v_lshlrev_b32 v18, 16, v121
  v_and_b32 v19, 0xffff0000, v121
  v_cvt_pk_bf16_f32 v120, v32, v33
  v_cvt_pk_bf16_f32 v121, v34, v35
  v_lshlrev_b32 v32, 16, v120
  v_and_b32 v33, 0xffff0000, v120
  v_lshlrev_b32 v34, 16, v121
  v_and_b32 v35, 0xffff0000, v121
  v_mul_f32 v32, v32, v108
  v_mul_f32 v33, v33, v108
  v_mul_f32 v34, v34, v108
  v_mul_f32 v35, v35, v108
  v_cvt_pk_bf16_f32 v120, v32, v33
  v_cvt_pk_bf16_f32 v121, v34, v35
  v_lshlrev_b32 v32, 16, v120
  v_and_b32 v33, 0xffff0000, v120
  v_lshlrev_b32 v34, 16, v121
  v_and_b32 v35, 0xffff0000, v121
  v_cvt_pk_bf16_f32 v120, v48, v49
  v_cvt_pk_bf16_f32 v121, v50, v51
  v_lshlrev_b32 v48, 16, v120
  v_and_b32 v49, 0xffff0000, v120
  v_lshlrev_b32 v50, 16, v121
  v_and_b32 v51, 0xffff0000, v121
  v_mul_f32 v48, v48, v108
  v_mul_f32 v49, v49, v108
  v_mul_f32 v50, v50, v108
  v_mul_f32 v51, v51, v108
  v_cvt_pk_bf16_f32 v120, v48, v49
  v_cvt_pk_bf16_f32 v121, v50, v51
  v_lshlrev_b32 v48, 16, v120
  v_and_b32 v49, 0xffff0000, v120
  v_lshlrev_b32 v50, 16, v121
  v_and_b32 v51, 0xffff0000, v121
  v_cvt_pk_bf16_f32 v120, v4, v5
  v_cvt_pk_bf16_f32 v121, v6, v7
  v_lshlrev_b32 v4, 16, v120
  v_and_b32 v5, 0xffff0000, v120
  v_lshlrev_b32 v6, 16, v121
  v_and_b32 v7, 0xffff0000, v121
  v_mul_f32 v4, v4, v109
  v_mul_f32 v5, v5, v109
  v_mul_f32 v6, v6, v109
  v_mul_f32 v7, v7, v109
  v_cvt_pk_bf16_f32 v120, v4, v5
  v_cvt_pk_bf16_f32 v121, v6, v7
  v_lshlrev_b32 v4, 16, v120
  v_and_b32 v5, 0xffff0000, v120
  v_lshlrev_b32 v6, 16, v121
  v_and_b32 v7, 0xffff0000, v121
  v_cvt_pk_bf16_f32 v120, v20, v21
  v_cvt_pk_bf16_f32 v121, v22, v23
  v_lshlrev_b32 v20, 16, v120
  v_and_b32 v21, 0xffff0000, v120
  v_lshlrev_b32 v22, 16, v121
  v_and_b32 v23, 0xffff0000, v121
  v_mul_f32 v20, v20, v109
  v_mul_f32 v21, v21, v109
  v_mul_f32 v22, v22, v109
  v_mul_f32 v23, v23, v109
  v_cvt_pk_bf16_f32 v120, v20, v21
  v_cvt_pk_bf16_f32 v121, v22, v23
  v_lshlrev_b32 v20, 16, v120
  v_and_b32 v21, 0xffff0000, v120
  v_lshlrev_b32 v22, 16, v121
  v_and_b32 v23, 0xffff0000, v121
  v_cvt_pk_bf16_f32 v120, v36, v37
  v_cvt_pk_bf16_f32 v121, v38, v39
  v_lshlrev_b32 v36, 16, v120
  v_and_b32 v37, 0xffff0000, v120
  v_lshlrev_b32 v38, 16, v121
  v_and_b32 v39, 0xffff0000, v121
  v_mul_f32 v36, v36, v109
  v_mul_f32 v37, v37, v109
  v_mul_f32 v38, v38, v109
  v_mul_f32 v39, v39, v109
  v_cvt_pk_bf16_f32 v120, v36, v37
  v_cvt_pk_bf16_f32 v121, v38, v39
  v_lshlrev_b32 v36, 16, v120
  v_and_b32 v37, 0xffff0000, v120
  v_lshlrev_b32 v38, 16, v121
  v_and_b32 v39, 0xffff0000, v121
  v_cvt_pk_bf16_f32 v120, v52, v53
  v_cvt_pk_bf16_f32 v121, v54, v55
  v_lshlrev_b32 v52, 16, v120
  v_and_b32 v53, 0xffff0000, v120
  v_lshlrev_b32 v54, 16, v121
  v_and_b32 v55, 0xffff0000, v121
  v_mul_f32 v52, v52, v109
  v_mul_f32 v53, v53, v109
  v_mul_f32 v54, v54, v109
  v_mul_f32 v55, v55, v109
  v_cvt_pk_bf16_f32 v120, v52, v53
  v_cvt_pk_bf16_f32 v121, v54, v55
  v_lshlrev_b32 v52, 16, v120
  v_and_b32 v53, 0xffff0000, v120
  v_lshlrev_b32 v54, 16, v121
  v_and_b32 v55, 0xffff0000, v121
  s_waitcnt vmcnt(4)
  v_add_f32 v8, v8, v64
  v_add_f32 v9, v9, v65
  v_add_f32 v10, v10, v66
  v_add_f32 v11, v11, v67
  v_cvt_pk_bf16_f32 v120, v8, v9
  v_cvt_pk_bf16_f32 v121, v10, v11
  v_lshlrev_b32 v8, 16, v120
  v_and_b32 v9, 0xffff0000, v120
  v_lshlrev_b32 v10, 16, v121
  v_and_b32 v11, 0xffff0000, v121
  v_mul_f32 v8, v8, v110
  v_mul_f32 v9, v9, v110
  v_mul_f32 v10, v10, v110
  v_mul_f32 v11, v11, v110
  v_cvt_pk_bf16_f32 v120, v8, v9
  v_cvt_pk_bf16_f32 v121, v10, v11
  v_lshlrev_b32 v8, 16, v120
  v_and_b32 v9, 0xffff0000, v120
  v_lshlrev_b32 v10, 16, v121
  v_and_b32 v11, 0xffff0000, v121
  v_add_f32 v8, v8, v0
  v_add_f32 v9, v9, v1
  v_add_f32 v10, v10, v2
  v_add_f32 v11, v11, v3
  v_add_f32 v24, v24, v68
  v_add_f32 v25, v25, v69
  v_add_f32 v26, v26, v70
  v_add_f32 v27, v27, v71
  v_cvt_pk_bf16_f32 v120, v24, v25
  v_cvt_pk_bf16_f32 v121, v26, v27
  v_lshlrev_b32 v24, 16, v120
  v_and_b32 v25, 0xffff0000, v120
  v_lshlrev_b32 v26, 16, v121
  v_and_b32 v27, 0xffff0000, v121
  v_mul_f32 v24, v24, v110
  v_mul_f32 v25, v25, v110
  v_mul_f32 v26, v26, v110
  v_mul_f32 v27, v27, v110
  v_cvt_pk_bf16_f32 v120, v24, v25
  v_cvt_pk_bf16_f32 v121, v26, v27
  v_lshlrev_b32 v24, 16, v120
  v_and_b32 v25, 0xffff0000, v120
  v_lshlrev_b32 v26, 16, v121
  v_and_b32 v27, 0xffff0000, v121
  v_add_f32 v24, v24, v16
  v_add_f32 v25, v25, v17
  v_add_f32 v26, v26, v18
  v_add_f32 v27, v27, v19
  v_add_f32 v40, v40, v72
  v_add_f32 v41, v41, v73
  v_add_f32 v42, v42, v74
  v_add_f32 v43, v43, v75
  v_cvt_pk_bf16_f32 v120, v40, v41
  v_cvt_pk_bf16_f32 v121, v42, v43
  v_lshlrev_b32 v40, 16, v120
  v_and_b32 v41, 0xffff0000, v120
  v_lshlrev_b32 v42, 16, v121
  v_and_b32 v43, 0xffff0000, v121
  v_mul_f32 v40, v40, v110
  v_mul_f32 v41, v41, v110
  v_mul_f32 v42, v42, v110
  v_mul_f32 v43, v43, v110
  v_cvt_pk_bf16_f32 v120, v40, v41
  v_cvt_pk_bf16_f32 v121, v42, v43
  v_lshlrev_b32 v40, 16, v120
  v_and_b32 v41, 0xffff0000, v120
  v_lshlrev_b32 v42, 16, v121
  v_and_b32 v43, 0xffff0000, v121
  v_add_f32 v40, v40, v32
  v_add_f32 v41, v41, v33
  v_add_f32 v42, v42, v34
  v_add_f32 v43, v43, v35
  v_add_f32 v56, v56, v76
  v_add_f32 v57, v57, v77
  v_add_f32 v58, v58, v78
  v_add_f32 v59, v59, v79
  v_cvt_pk_bf16_f32 v120, v56, v57
  v_cvt_pk_bf16_f32 v121, v58, v59
  v_lshlrev_b32 v56, 16, v120
  v_and_b32 v57, 0xffff0000, v120
  v_lshlrev_b32 v58, 16, v121
  v_and_b32 v59, 0xffff0000, v121
  v_mul_f32 v56, v56, v110
  v_mul_f32 v57, v57, v110
  v_mul_f32 v58, v58, v110
  v_mul_f32 v59, v59, v110
  v_cvt_pk_bf16_f32 v120, v56, v57
  v_cvt_pk_bf16_f32 v121, v58, v59
  v_lshlrev_b32 v56, 16, v120
  v_and_b32 v57, 0xffff0000, v120
  v_lshlrev_b32 v58, 16, v121
  v_and_b32 v59, 0xffff0000, v121
  v_add_f32 v56, v56, v48
  v_add_f32 v57, v57, v49
  v_add_f32 v58, v58, v50
  v_add_f32 v59, v59, v51
  v_cvt_pk_bf16_f32 v128, v8, v9
  v_cvt_pk_bf16_f32 v129, v10, v11
  v_cvt_pk_bf16_f32 v130, v24, v25
  v_cvt_pk_bf16_f32 v131, v26, v27
  s_nop 1
  v_permlane16_swap_b32 v128, v130
  v_permlane16_swap_b32 v129, v131
  s_mov_b32 s33, 1048576
  buffer_store_dwordx4 v[128:131], v116, s[16:19], s33 offen offset:0 nt
  v_cvt_pk_bf16_f32 v132, v40, v41
  v_cvt_pk_bf16_f32 v133, v42, v43
  v_cvt_pk_bf16_f32 v134, v56, v57
  v_cvt_pk_bf16_f32 v135, v58, v59
  s_nop 1
  v_permlane16_swap_b32 v132, v134
  v_permlane16_swap_b32 v133, v135
  s_mov_b32 s33, 1048576
  buffer_store_dwordx4 v[132:135], v116, s[16:19], s33 offen offset:64 nt
  s_waitcnt vmcnt(0)
  v_add_f32 v12, v12, v80
  v_add_f32 v13, v13, v81
  v_add_f32 v14, v14, v82
  v_add_f32 v15, v15, v83
  v_cvt_pk_bf16_f32 v120, v12, v13
  v_cvt_pk_bf16_f32 v121, v14, v15
  v_lshlrev_b32 v12, 16, v120
  v_and_b32 v13, 0xffff0000, v120
  v_lshlrev_b32 v14, 16, v121
  v_and_b32 v15, 0xffff0000, v121
  v_mul_f32 v12, v12, v111
  v_mul_f32 v13, v13, v111
  v_mul_f32 v14, v14, v111
  v_mul_f32 v15, v15, v111
  v_cvt_pk_bf16_f32 v120, v12, v13
  v_cvt_pk_bf16_f32 v121, v14, v15
  v_lshlrev_b32 v12, 16, v120
  v_and_b32 v13, 0xffff0000, v120
  v_lshlrev_b32 v14, 16, v121
  v_and_b32 v15, 0xffff0000, v121
  v_add_f32 v12, v12, v4
  v_add_f32 v13, v13, v5
  v_add_f32 v14, v14, v6
  v_add_f32 v15, v15, v7
  v_add_f32 v28, v28, v84
  v_add_f32 v29, v29, v85
  v_add_f32 v30, v30, v86
  v_add_f32 v31, v31, v87
  v_cvt_pk_bf16_f32 v120, v28, v29
  v_cvt_pk_bf16_f32 v121, v30, v31
  v_lshlrev_b32 v28, 16, v120
  v_and_b32 v29, 0xffff0000, v120
  v_lshlrev_b32 v30, 16, v121
  v_and_b32 v31, 0xffff0000, v121
  v_mul_f32 v28, v28, v111
  v_mul_f32 v29, v29, v111
  v_mul_f32 v30, v30, v111
  v_mul_f32 v31, v31, v111
  v_cvt_pk_bf16_f32 v120, v28, v29
  v_cvt_pk_bf16_f32 v121, v30, v31
  v_lshlrev_b32 v28, 16, v120
  v_and_b32 v29, 0xffff0000, v120
  v_lshlrev_b32 v30, 16, v121
  v_and_b32 v31, 0xffff0000, v121
  v_add_f32 v28, v28, v20
  v_add_f32 v29, v29, v21
  v_add_f32 v30, v30, v22
  v_add_f32 v31, v31, v23
  v_add_f32 v44, v44, v88
  v_add_f32 v45, v45, v89
  v_add_f32 v46, v46, v90
  v_add_f32 v47, v47, v91
  v_cvt_pk_bf16_f32 v120, v44, v45
  v_cvt_pk_bf16_f32 v121, v46, v47
  v_lshlrev_b32 v44, 16, v120
  v_and_b32 v45, 0xffff0000, v120
  v_lshlrev_b32 v46, 16, v121
  v_and_b32 v47, 0xffff0000, v121
  v_mul_f32 v44, v44, v111
  v_mul_f32 v45, v45, v111
  v_mul_f32 v46, v46, v111
  v_mul_f32 v47, v47, v111
  v_cvt_pk_bf16_f32 v120, v44, v45
  v_cvt_pk_bf16_f32 v121, v46, v47
  v_lshlrev_b32 v44, 16, v120
  v_and_b32 v45, 0xffff0000, v120
  v_lshlrev_b32 v46, 16, v121
  v_and_b32 v47, 0xffff0000, v121
  v_add_f32 v44, v44, v36
  v_add_f32 v45, v45, v37
  v_add_f32 v46, v46, v38
  v_add_f32 v47, v47, v39
  v_add_f32 v60, v60, v92
  v_add_f32 v61, v61, v93
  v_add_f32 v62, v62, v94
  v_add_f32 v63, v63, v95
  v_cvt_pk_bf16_f32 v120, v60, v61
  v_cvt_pk_bf16_f32 v121, v62, v63
  v_lshlrev_b32 v60, 16, v120
  v_and_b32 v61, 0xffff0000, v120
  v_lshlrev_b32 v62, 16, v121
  v_and_b32 v63, 0xffff0000, v121
  v_mul_f32 v60, v60, v111
  v_mul_f32 v61, v61, v111
  v_mul_f32 v62, v62, v111
  v_mul_f32 v63, v63, v111
  v_cvt_pk_bf16_f32 v120, v60, v61
  v_cvt_pk_bf16_f32 v121, v62, v63
  v_lshlrev_b32 v60, 16, v120
  v_and_b32 v61, 0xffff0000, v120
  v_lshlrev_b32 v62, 16, v121
  v_and_b32 v63, 0xffff0000, v121
  v_add_f32 v60, v60, v52
  v_add_f32 v61, v61, v53
  v_add_f32 v62, v62, v54
  v_add_f32 v63, v63, v55
  v_cvt_pk_bf16_f32 v136, v12, v13
  v_cvt_pk_bf16_f32 v137, v14, v15
  v_cvt_pk_bf16_f32 v138, v28, v29
  v_cvt_pk_bf16_f32 v139, v30, v31
  s_nop 1
  v_permlane16_swap_b32 v136, v138
  v_permlane16_swap_b32 v137, v139
  s_mov_b32 s33, 1572864
  buffer_store_dwordx4 v[136:139], v116, s[16:19], s33 offen offset:0 nt
  v_cvt_pk_bf16_f32 v140, v44, v45
  v_cvt_pk_bf16_f32 v141, v46, v47
  v_cvt_pk_bf16_f32 v142, v60, v61
  v_cvt_pk_bf16_f32 v143, v62, v63
  s_nop 1
  v_permlane16_swap_b32 v140, v142
  v_permlane16_swap_b32 v141, v143
  s_mov_b32 s33, 1572864
  buffer_store_dwordx4 v[140:143], v116, s[16:19], s33 offen offset:64 nt
  s_branch C2_fin
C2_fin:
  s_branch MG_end
MG_producer:
  v_and_b32 v0, 63, v0
  s_setprio 3
  s_sub_u32 s31, s20, 4
  s_mov_b32 s8, s4
  s_mov_b32 s9, s5
  s_mov_b32 s10, 0x400000
  s_mov_b32 s11, 0x20000
  s_mov_b32 s12, s88
  s_mov_b32 s13, s89
  s_mov_b32 s14, 0x700000
  s_mov_b32 s15, 0x20000
  s_lshl_b32 s33, s24, 11
  s_mul_i32 s34, s31, 114688
  s_mul_i32 s35, s22, 448
  s_add_u32 s34, s34, s35
  s_add_u32 s36, s3, 0
  s_and_b32 s36, s36, 3
  s_lshl_b32 s36, s36, 2
  s_add_u32 s37, s26, 0
  s_and_b32 s37, s37, 3
  s_add_u32 s36, s36, s37
  s_lshl_b32 s37, s36, 7
  s_add_u32 s40, s37, s33
  s_mul_i32 s37, s36, 458752
  s_add_u32 s56, s37, s34
  s_add_u32 s36, s3, 0
  s_and_b32 s36, s36, 3
  s_lshl_b32 s36, s36, 2
  s_add_u32 s37, s26, 1
  s_and_b32 s37, s37, 3
  s_add_u32 s36, s36, s37
  s_lshl_b32 s37, s36, 7
  s_add_u32 s41, s37, s33
  s_mul_i32 s37, s36, 458752
  s_add_u32 s57, s37, s34
  s_lshl_b32 s35, s31, 12
  s_mul_i32 s39, s31, 7168
  s_add_u32 s72, s35, 0
  s_add_u32 s73, s39, 16384
  s_add_u32 s74, s39, 20480
  s_add_u32 s75, s35, 45056
  s_add_u32 s76, s39, 61440
  s_add_u32 s77, s39, 65536
  s_add_u32 s78, s35, 90112
  s_add_u32 s79, s39, 106496
  s_add_u32 s80, s39, 110592
  v_lshrrev_b32 v13, 3, v0
  v_and_b32 v14, 7, v0
  v_lshrrev_b32 v15, 4, v0
  v_add_u32 v16, 0, v15
  v_xor_b32 v16, v16, v14
  v_lshlrev_b32 v16, 4, v16
  s_lshl_b32 s35, s31, 5
  s_add_u32 s35, s35, 0
  v_add_u32 v17, s35, v13
  v_lshlrev_b32 v17, 15, v17
  v_add_u32 v16, v16, v17
  v_subrev_u32 v2, 0, v16
  v_add_u32 v16, 4, v15
  v_xor_b32 v16, v16, v14
  v_lshlrev_b32 v16, 4, v16
  s_lshl_b32 s35, s31, 5
  s_add_u32 s35, s35, 8
  v_add_u32 v17, s35, v13
  v_lshlrev_b32 v17, 15, v17
  v_add_u32 v16, v16, v17
  v_subrev_u32 v3, 1024, v16
  v_add_u32 v16, 0, v15
  v_xor_b32 v16, v16, v14
  v_lshlrev_b32 v16, 4, v16
  s_lshl_b32 s35, s31, 5
  s_add_u32 s35, s35, 16
  v_add_u32 v17, s35, v13
  v_lshlrev_b32 v17, 15, v17
  v_add_u32 v16, v16, v17
  v_subrev_u32 v4, 2048, v16
  v_add_u32 v16, 4, v15
  v_xor_b32 v16, v16, v14
  v_lshlrev_b32 v16, 4, v16
  s_lshl_b32 s35, s31, 5
  s_add_u32 s35, s35, 24
  v_add_u32 v17, s35, v13
  v_lshlrev_b32 v17, 15, v17
  v_add_u32 v16, v16, v17
  v_subrev_u32 v5, 3072, v16
  s_mov_b32 m0, s72
  s_nop 0
  buffer_load_dwordx4 v2, s[8:11], s40 offen offset:0 lds
  buffer_load_dwordx4 v3, s[8:11], s40 offen offset:1024 lds
  buffer_load_dwordx4 v4, s[8:11], s40 offen offset:2048 lds
  buffer_load_dwordx4 v5, s[8:11], s40 offen offset:3072 lds
  v_add_u32 v13, 0, v0
  v_mul_u32_u24 v14, 2341, v13
  v_lshrrev_b32 v14, 16, v14
  v_mul_u32_u24 v15, 28, v14
  v_sub_u32 v15, v13, v15
  v_lshrrev_b32 v16, 3, v14
  v_lshrrev_b32 v17, 1, v15
  v_xor_b32 v17, v17, v16
  v_lshlrev_b32 v17, 5, v17
  v_and_b32 v15, 1, v15
  v_lshl_add_u32 v17, v15, 4, v17
  v_mul_u32_u24 v14, 7168, v14
  v_add_u32 v17, v17, v14
  v_subrev_u32 v6, 0, v17
  v_add_u32 v13, 64, v0
  v_mul_u32_u24 v14, 2341, v13
  v_lshrrev_b32 v14, 16, v14
  v_mul_u32_u24 v15, 28, v14
  v_sub_u32 v15, v13, v15
  v_lshrrev_b32 v16, 3, v14
  v_lshrrev_b32 v17, 1, v15
  v_xor_b32 v17, v17, v16
  v_lshlrev_b32 v17, 5, v17
  v_and_b32 v15, 1, v15
  v_lshl_add_u32 v17, v15, 4, v17
  v_mul_u32_u24 v14, 7168, v14
  v_add_u32 v17, v17, v14
  v_subrev_u32 v7, 1024, v17
  v_add_u32 v13, 128, v0
  v_mul_u32_u24 v14, 2341, v13
  v_lshrrev_b32 v14, 16, v14
  v_mul_u32_u24 v15, 28, v14
  v_sub_u32 v15, v13, v15
  v_lshrrev_b32 v16, 3, v14
  v_lshrrev_b32 v17, 1, v15
  v_xor_b32 v17, v17, v16
  v_lshlrev_b32 v17, 5, v17
  v_and_b32 v15, 1, v15
  v_lshl_add_u32 v17, v15, 4, v17
  v_mul_u32_u24 v14, 7168, v14
  v_add_u32 v17, v17, v14
  v_subrev_u32 v8, 2048, v17
  v_add_u32 v13, 192, v0
  v_mul_u32_u24 v14, 2341, v13
  v_lshrrev_b32 v14, 16, v14
  v_mul_u32_u24 v15, 28, v14
  v_sub_u32 v15, v13, v15
  v_lshrrev_b32 v16, 3, v14
  v_lshrrev_b32 v17, 1, v15
  v_xor_b32 v17, v17, v16
  v_lshlrev_b32 v17, 5, v17
  v_and_b32 v15, 1, v15
  v_lshl_add_u32 v17, v15, 4, v17
  v_mul_u32_u24 v14, 7168, v14
  v_add_u32 v17, v17, v14
  v_subrev_u32 v9, 3072, v17
  v_add_u32 v13, 256, v0
  v_mul_u32_u24 v14, 2341, v13
  v_lshrrev_b32 v14, 16, v14
  v_mul_u32_u24 v15, 28, v14
  v_sub_u32 v15, v13, v15
  v_lshrrev_b32 v16, 3, v14
  v_lshrrev_b32 v17, 1, v15
  v_xor_b32 v17, v17, v16
  v_lshlrev_b32 v17, 5, v17
  v_and_b32 v15, 1, v15
  v_lshl_add_u32 v17, v15, 4, v17
  v_mul_u32_u24 v14, 7168, v14
  v_add_u32 v17, v17, v14
  v_subrev_u32 v10, 0, v17
  v_add_u32 v13, 320, v0
  v_mul_u32_u24 v14, 2341, v13
  v_lshrrev_b32 v14, 16, v14
  v_mul_u32_u24 v15, 28, v14
  v_sub_u32 v15, v13, v15
  v_lshrrev_b32 v16, 3, v14
  v_lshrrev_b32 v17, 1, v15
  v_xor_b32 v17, v17, v16
  v_lshlrev_b32 v17, 5, v17
  v_and_b32 v15, 1, v15
  v_lshl_add_u32 v17, v15, 4, v17
  v_mul_u32_u24 v14, 7168, v14
  v_add_u32 v17, v17, v14
  v_subrev_u32 v11, 1024, v17
  v_add_u32 v13, 384, v0
  v_mul_u32_u24 v14, 2341, v13
  v_lshrrev_b32 v14, 16, v14
  v_mul_u32_u24 v15, 28, v14
  v_sub_u32 v15, v13, v15
  v_lshrrev_b32 v16, 3, v14
  v_lshrrev_b32 v17, 1, v15
  v_xor_b32 v17, v17, v16
  v_lshlrev_b32 v17, 5, v17
  v_and_b32 v15, 1, v15
  v_lshl_add_u32 v17, v15, 4, v17
  v_mul_u32_u24 v14, 7168, v14
  v_add_u32 v17, v17, v14
  v_subrev_u32 v12, 2048, v17
  s_mov_b32 m0, s73
  s_nop 0
  buffer_load_dwordx4 v6, s[12:15], s56 offen offset:0 lds
  buffer_load_dwordx4 v7, s[12:15], s56 offen offset:1024 lds
  buffer_load_dwordx4 v8, s[12:15], s56 offen offset:2048 lds
  buffer_load_dwordx4 v9, s[12:15], s56 offen offset:3072 lds
  s_mov_b32 m0, s74
  s_nop 0
  buffer_load_dwordx4 v10, s[12:15], s56 offen offset:0 lds
  buffer_load_dwordx4 v11, s[12:15], s56 offen offset:1024 lds
  buffer_load_dwordx4 v12, s[12:15], s56 offen offset:2048 lds
  s_mov_b32 m0, s75
  s_nop 0
  buffer_load_dwordx4 v2, s[8:11], s41 offen offset:0 lds
  buffer_load_dwordx4 v3, s[8:11], s41 offen offset:1024 lds
  buffer_load_dwordx4 v4, s[8:11], s41 offen offset:2048 lds
  buffer_load_dwordx4 v5, s[8:11], s41 offen offset:3072 lds
  s_mov_b32 m0, s76
  s_nop 0
  buffer_load_dwordx4 v6, s[12:15], s57 offen offset:0 lds
  buffer_load_dwordx4 v7, s[12:15], s57 offen offset:1024 lds
  buffer_load_dwordx4 v8, s[12:15], s57 offen offset:2048 lds
  buffer_load_dwordx4 v9, s[12:15], s57 offen offset:3072 lds
  s_mov_b32 m0, s77
  s_nop 0
  buffer_load_dwordx4 v10, s[12:15], s57 offen offset:0 lds
  buffer_load_dwordx4 v11, s[12:15], s57 offen offset:1024 lds
  buffer_load_dwordx4 v12, s[12:15], s57 offen offset:2048 lds
  s_add_u32 s36, s3, 0
  s_and_b32 s36, s36, 3
  s_lshl_b32 s36, s36, 2
  s_add_u32 s37, s26, 2
  s_and_b32 s37, s37, 3
  s_add_u32 s36, s36, s37
  s_lshl_b32 s37, s36, 7
  s_add_u32 s42, s37, s33
  s_mul_i32 s37, s36, 458752
  s_add_u32 s58, s37, s34
  s_add_u32 s36, s3, 0
  s_and_b32 s36, s36, 3
  s_lshl_b32 s36, s36, 2
  s_add_u32 s37, s26, 3
  s_and_b32 s37, s37, 3
  s_add_u32 s36, s36, s37
  s_lshl_b32 s37, s36, 7
  s_add_u32 s43, s37, s33
  s_mul_i32 s37, s36, 458752
  s_add_u32 s59, s37, s34
  s_waitcnt vmcnt(11) lgkmcnt(0)
  s_barrier
  s_waitcnt lgkmcnt(0)
  s_waitcnt vmcnt(0)
  s_barrier
  s_setprio 0
  s_mov_b32 m0, s78
  s_nop 0
  buffer_load_dwordx4 v2, s[8:11], s42 offen offset:0 lds
  buffer_load_dwordx4 v3, s[8:11], s42 offen offset:1024 lds
  buffer_load_dwordx4 v4, s[8:11], s42 offen offset:2048 lds
  buffer_load_dwordx4 v5, s[8:11], s42 offen offset:3072 lds
  s_mov_b32 m0, s79
  s_nop 0
  buffer_load_dwordx4 v6, s[12:15], s58 offen offset:0 lds
  buffer_load_dwordx4 v7, s[12:15], s58 offen offset:1024 lds
  buffer_load_dwordx4 v8, s[12:15], s58 offen offset:2048 lds
  buffer_load_dwordx4 v9, s[12:15], s58 offen offset:3072 lds
  s_mov_b32 m0, s80
  s_nop 0
  buffer_load_dwordx4 v10, s[12:15], s58 offen offset:0 lds
  buffer_load_dwordx4 v11, s[12:15], s58 offen offset:1024 lds
  buffer_load_dwordx4 v12, s[12:15], s58 offen offset:2048 lds
  s_mov_b32 m0, s72
  s_nop 0
  buffer_load_dwordx4 v2, s[8:11], s43 offen offset:0 lds
  s_add_u32 s36, s3, 1
  s_and_b32 s36, s36, 3
  s_lshl_b32 s36, s36, 2
  s_add_u32 s37, s26, 0
  s_and_b32 s37, s37, 3
  buffer_load_dwordx4 v3, s[8:11], s43 offen offset:1024 lds
  s_add_u32 s36, s36, s37
  s_lshl_b32 s37, s36, 7
  s_add_u32 s44, s37, s33
  s_mul_i32 s37, s36, 458752
  s_add_u32 s60, s37, s34
  buffer_load_dwordx4 v4, s[8:11], s43 offen offset:2048 lds
  s_add_u32 s36, s3, 1
  s_and_b32 s36, s36, 3
  s_lshl_b32 s36, s36, 2
  s_add_u32 s37, s26, 1
  buffer_load_dwordx4 v5, s[8:11], s43 offen offset:3072 lds
  s_and_b32 s37, s37, 3
  s_add_u32 s36, s36, s37
  s_lshl_b32 s37, s36, 7
  s_add_u32 s45, s37, s33
  s_mul_i32 s37, s36, 458752
  s_mov_b32 m0, s73
  s_nop 0
  buffer_load_dwordx4 v6, s[12:15], s59 offen offset:0 lds
  s_add_u32 s61, s37, s34
  s_add_u32 s36, s3, 1
  s_and_b32 s36, s36, 3
  s_lshl_b32 s36, s36, 2
  buffer_load_dwordx4 v7, s[12:15], s59 offen offset:1024 lds
  s_add_u32 s37, s26, 2
  s_and_b32 s37, s37, 3
  s_add_u32 s36, s36, s37
  s_lshl_b32 s37, s36, 7
  s_add_u32 s46, s37, s33
  buffer_load_dwordx4 v8, s[12:15], s59 offen offset:2048 lds
  s_mul_i32 s37, s36, 458752
  s_add_u32 s62, s37, s34
  s_add_u32 s36, s3, 1
  s_and_b32 s36, s36, 3
  buffer_load_dwordx4 v9, s[12:15], s59 offen offset:3072 lds
  s_lshl_b32 s36, s36, 2
  s_add_u32 s37, s26, 3
  s_and_b32 s37, s37, 3
  s_add_u32 s36, s36, s37
  s_lshl_b32 s37, s36, 7
  s_mov_b32 m0, s74
  s_nop 0
  buffer_load_dwordx4 v10, s[12:15], s59 offen offset:0 lds
  s_add_u32 s47, s37, s33
  s_mul_i32 s37, s36, 458752
  s_add_u32 s63, s37, s34
  s_add_u32 s36, s3, 2
  buffer_load_dwordx4 v11, s[12:15], s59 offen offset:1024 lds
  s_and_b32 s36, s36, 3
  s_lshl_b32 s36, s36, 2
  s_add_u32 s37, s26, 0
  s_and_b32 s37, s37, 3
  s_add_u32 s36, s36, s37
  buffer_load_dwordx4 v12, s[12:15], s59 offen offset:2048 lds
  s_lshl_b32 s37, s36, 7
  s_add_u32 s48, s37, s33
  s_mul_i32 s37, s36, 458752
  s_add_u32 s64, s37, s34
  s_waitcnt vmcnt(11)
  s_barrier
  s_mov_b32 m0, s75
  s_nop 0
  buffer_load_dwordx4 v2, s[8:11], s44 offen offset:0 lds
  s_add_u32 s36, s3, 2
  s_and_b32 s36, s36, 3
  s_lshl_b32 s36, s36, 2
  s_add_u32 s37, s26, 1
  s_and_b32 s37, s37, 3
  buffer_load_dwordx4 v3, s[8:11], s44 offen offset:1024 lds
  s_add_u32 s36, s36, s37
  s_lshl_b32 s37, s36, 7
  s_add_u32 s49, s37, s33
  s_mul_i32 s37, s36, 458752
  s_add_u32 s65, s37, s34
  buffer_load_dwordx4 v4, s[8:11], s44 offen offset:2048 lds
  s_add_u32 s36, s3, 2
  s_and_b32 s36, s36, 3
  s_lshl_b32 s36, s36, 2
  s_add_u32 s37, s26, 2
  buffer_load_dwordx4 v5, s[8:11], s44 offen offset:3072 lds
  s_and_b32 s37, s37, 3
  s_add_u32 s36, s36, s37
  s_lshl_b32 s37, s36, 7
  s_add_u32 s50, s37, s33
  s_mul_i32 s37, s36, 458752
  s_mov_b32 m0, s76
  s_nop 0
  buffer_load_dwordx4 v6, s[12:15], s60 offen offset:0 lds
  s_add_u32 s66, s37, s34
  s_add_u32 s36, s3, 2
  s_and_b32 s36, s36, 3
  s_lshl_b32 s36, s36, 2
  buffer_load_dwordx4 v7, s[12:15], s60 offen offset:1024 lds
  s_add_u32 s37, s26, 3
  s_and_b32 s37, s37, 3
  s_add_u32 s36, s36, s37
  s_lshl_b32 s37, s36, 7
  s_add_u32 s51, s37, s33
  buffer_load_dwordx4 v8, s[12:15], s60 offen offset:2048 lds
  s_mul_i32 s37, s36, 458752
  s_add_u32 s67, s37, s34
  s_add_u32 s36, s3, 3
  s_and_b32 s36, s36, 3
  buffer_load_dwordx4 v9, s[12:15], s60 offen offset:3072 lds
  s_lshl_b32 s36, s36, 2
  s_add_u32 s37, s26, 0
  s_and_b32 s37, s37, 3
  s_add_u32 s36, s36, s37
  s_lshl_b32 s37, s36, 7
  s_mov_b32 m0, s77
  s_nop 0
  buffer_load_dwordx4 v10, s[12:15], s60 offen offset:0 lds
  s_add_u32 s52, s37, s33
  s_mul_i32 s37, s36, 458752
  s_add_u32 s68, s37, s34
  s_add_u32 s36, s3, 3
  buffer_load_dwordx4 v11, s[12:15], s60 offen offset:1024 lds
  s_and_b32 s36, s36, 3
  s_lshl_b32 s36, s36, 2
  s_add_u32 s37, s26, 1
  s_and_b32 s37, s37, 3
  s_add_u32 s36, s36, s37
  buffer_load_dwordx4 v12, s[12:15], s60 offen offset:2048 lds
  s_lshl_b32 s37, s36, 7
  s_add_u32 s53, s37, s33
  s_mul_i32 s37, s36, 458752
  s_add_u32 s69, s37, s34
  s_waitcnt vmcnt(11)
  s_barrier
  s_mov_b32 m0, s78
  s_nop 0
  buffer_load_dwordx4 v2, s[8:11], s45 offen offset:0 lds
  s_add_u32 s36, s3, 3
  s_and_b32 s36, s36, 3
  s_lshl_b32 s36, s36, 2
  s_add_u32 s37, s26, 2
  s_and_b32 s37, s37, 3
  buffer_load_dwordx4 v3, s[8:11], s45 offen offset:1024 lds
  s_add_u32 s36, s36, s37
  s_lshl_b32 s37, s36, 7
  s_add_u32 s54, s37, s33
  s_mul_i32 s37, s36, 458752
  s_add_u32 s70, s37, s34
  buffer_load_dwordx4 v4, s[8:11], s45 offen offset:2048 lds
  s_add_u32 s36, s3, 3
  s_and_b32 s36, s36, 3
  s_lshl_b32 s36, s36, 2
  s_add_u32 s37, s26, 3
  buffer_load_dwordx4 v5, s[8:11], s45 offen offset:3072 lds
  s_and_b32 s37, s37, 3
  s_add_u32 s36, s36, s37
  s_lshl_b32 s37, s36, 7
  s_add_u32 s55, s37, s33
  s_mul_i32 s37, s36, 458752
  s_mov_b32 m0, s79
  s_nop 0
  buffer_load_dwordx4 v6, s[12:15], s61 offen offset:0 lds
  s_add_u32 s71, s37, s34
  s_and_b32 s81, s0, 127
  s_sub_u32 s82, 128, s81
  s_cmp_gt_u32 s81, 64
  s_cselect_b32 s82, s82, s81
  buffer_load_dwordx4 v7, s[12:15], s61 offen offset:1024 lds
  s_lshl_b32 s84, s82, 1
  s_mov_b32 s85, 2048
  s_cmp_eq_u32 s82, 64
  s_cselect_b32 s84, 1, s84
  s_and_b32 s81, s82, 63
  s_cmp_eq_u32 s81, 0
  s_cselect_b32 s85, 0, s85
  v_lshlrev_b32 v136, 4, v0
  buffer_load_dwordx4 v8, s[12:15], s61 offen offset:2048 lds
  v_add_u32 v136, 135168, v136
  ds_read_b128 a[0:3], v136 offset:0
  ds_read_b128 a[4:7], v136 offset:1024
  ds_read_b128 a[8:11], v136 offset:2048
  ds_read_b128 a[12:15], v136 offset:3072
  buffer_load_dwordx4 v9, s[12:15], s61 offen offset:3072 lds
  ds_read_b128 a[16:19], v136 offset:4096
  ds_read_b128 a[20:23], v136 offset:5120
  ds_read_b128 a[24:27], v136 offset:6144
  ds_read_b128 v[56:59], v136 offset:7168
  ds_read_b128 v[72:75], v136 offset:11264
  s_mov_b32 m0, s80
  s_nop 0
  buffer_load_dwordx4 v10, s[12:15], s61 offen offset:0 lds
  ds_read_b128 v[60:63], v136 offset:8192
  ds_read_b128 v[76:79], v136 offset:12288
  ds_read_b128 v[64:67], v136 offset:9216
  ds_read_b128 v[80:83], v136 offset:13312
  ds_read_b128 v[68:71], v136 offset:10240
  buffer_load_dwordx4 v11, s[12:15], s61 offen offset:1024 lds
  ds_read_b128 v[84:87], v136 offset:14336
  v_mov_b32 v20, 0
  v_mov_b32 v21, 0
  v_mov_b32 v22, 0
  v_mov_b32 v23, 0
  buffer_load_dwordx4 v12, s[12:15], s61 offen offset:2048 lds
  v_mov_b32 v24, 0
  v_mov_b32 v25, 0
  v_mov_b32 v26, 0
  v_mov_b32 v27, 0
  v_mov_b32 v28, 0
  s_waitcnt vmcnt(11)
  s_barrier
  s_mov_b32 m0, s72
  s_nop 0
  buffer_load_dwordx4 v2, s[8:11], s46 offen offset:0 lds
  v_mov_b32 v29, 0
  v_mov_b32 v30, 0
  v_mov_b32 v31, 0
  v_mov_b32 v32, 0
  v_mov_b32 v33, 0
  buffer_load_dwordx4 v3, s[8:11], s46 offen offset:1024 lds
  v_mov_b32 v34, 0
  v_mov_b32 v35, 0
  v_mov_b32 v36, 0
  v_mov_b32 v37, 0
  v_mov_b32 v38, 0
  buffer_load_dwordx4 v4, s[8:11], s46 offen offset:2048 lds
  v_mov_b32 v39, 0
  v_mov_b32 v40, 0
  v_mov_b32 v41, 0
  v_mov_b32 v42, 0
  v_mov_b32 v43, 0
  buffer_load_dwordx4 v5, s[8:11], s46 offen offset:3072 lds
  v_mov_b32 v44, 0
  v_mov_b32 v45, 0
  v_mov_b32 v46, 0
  v_mov_b32 v47, 0
  v_mov_b32 v48, 0
  s_mov_b32 m0, s73
  s_nop 0
  buffer_load_dwordx4 v6, s[12:15], s62 offen offset:0 lds
  v_mov_b32 v49, 0
  v_mov_b32 v50, 0
  v_mov_b32 v51, 0
  v_mov_b32 v52, 0
  v_mov_b32 v53, 0
  buffer_load_dwordx4 v7, s[12:15], s62 offen offset:1024 lds
  v_mov_b32 v54, 0
  v_mov_b32 v55, 0
  s_lshl_b32 s35, s31, 9
  s_add_u32 s33, s0, s35
  s_cmp_eq_u32 s0, 0
  s_cbranch_scc0 P2_fgen
  s_cmp_eq_u32 s31, 2
  s_cselect_b32 s33, 256, s33
  s_cmp_eq_u32 s31, 3
  s_cselect_b32 s33, 768, s33
P2_fgen:
  buffer_load_dwordx4 v8, s[12:15], s62 offen offset:2048 lds
  s_sub_u32 s34, 2048, s33
  s_and_b32 s34, s34, 2047
  s_mul_i32 s33, s33, 1026
  s_mul_i32 s34, s34, 1026
  v_and_b32 v13, 31, v0
  buffer_load_dwordx4 v9, s[12:15], s62 offen offset:3072 lds
  v_lshrrev_b32 v14, 5, v0
  v_lshl_add_u32 v15, v14, 7, v13
  v_lshlrev_b32 v16, 1, v15
  v_sub_u32 v17, 160, v15
  v_lshlrev_b32 v17, 1, v17
  s_mov_b32 m0, s74
  s_nop 0
  buffer_load_dwordx4 v10, s[12:15], s62 offen offset:0 lds
  v_mov_b32 v18, 0
  v_lshrrev_b32 v136, 5, v0
  v_and_b32 v137, 31, v0
  v_mul_lo_u32 v138, v136, s85
  v_add_u32 v139, 0, v136
  buffer_load_dwordx4 v11, s[12:15], s62 offen offset:1024 lds
  v_lshrrev_b32 v140, 1, v137
  v_xor_b32 v140, v140, v139
  v_lshlrev_b32 v140, 5, v140
  v_and_b32 v141, 1, v137
  v_lshl_add_u32 v140, v141, 4, v140
  buffer_load_dwordx4 v12, s[12:15], s62 offen offset:2048 lds
  v_add_u32 v140, v140, v138
  v_subrev_u32 v144, 0, v140
  v_add_u32 v139, 2, v136
  v_lshrrev_b32 v140, 1, v137
  v_xor_b32 v140, v140, v139
  s_waitcnt vmcnt(11)
  s_barrier
  s_mov_b32 m0, s75
  s_nop 0
  buffer_load_dwordx4 v2, s[8:11], s47 offen offset:0 lds
  v_lshlrev_b32 v140, 5, v140
  v_and_b32 v141, 1, v137
  v_lshl_add_u32 v140, v141, 4, v140
  v_add_u32 v140, v140, v138
  v_subrev_u32 v145, 1024, v140
  buffer_load_dwordx4 v3, s[8:11], s47 offen offset:1024 lds
  v_add_u32 v139, 4, v136
  v_lshrrev_b32 v140, 1, v137
  v_xor_b32 v140, v140, v139
  v_lshlrev_b32 v140, 5, v140
  v_and_b32 v141, 1, v137
  buffer_load_dwordx4 v4, s[8:11], s47 offen offset:2048 lds
  v_lshl_add_u32 v140, v141, 4, v140
  v_add_u32 v140, v140, v138
  v_subrev_u32 v146, 2048, v140
  v_add_u32 v139, 6, v136
  v_lshrrev_b32 v140, 1, v137
  buffer_load_dwordx4 v5, s[8:11], s47 offen offset:3072 lds
  v_xor_b32 v140, v140, v139
  v_lshlrev_b32 v140, 5, v140
  v_and_b32 v141, 1, v137
  v_lshl_add_u32 v140, v141, 4, v140
  v_add_u32 v140, v140, v138
  s_mov_b32 m0, s76
  s_nop 0
  buffer_load_dwordx4 v6, s[12:15], s63 offen offset:0 lds
  v_subrev_u32 v147, 3072, v140
  s_lshl_b32 s36, s84, 11
  s_lshl_b32 s37, s31, 9
  s_add_u32 s36, s36, s37
  s_mov_b32 s38, s84
  buffer_load_dwordx4 v7, s[12:15], s63 offen offset:1024 lds
  s_mov_b32 s39, s85
  s_lshl_b32 s37, s31, 14
  s_add_u32 s37, s37, 65536
  v_lshrrev_b32 v136, 4, v0
  v_bfe_u32 v137, v0, 2, 2
  buffer_load_dwordx4 v8, s[12:15], s63 offen offset:2048 lds
  v_and_b32 v138, 3, v0
  v_lshl_add_u32 v139, v136, 2, v137
  v_and_b32 v140, 7, v139
  v_lshlrev_b32 v141, 9, v139
  v_lshl_add_u32 v141, v138, 3, v141
  buffer_load_dwordx4 v9, s[12:15], s63 offen offset:3072 lds
  v_add_u32 v141, s37, v141
  v_xor_b32 v142, 0, v140
  v_lshl_add_u32 v148, v142, 5, v141
  v_xor_b32 v142, 1, v140
  v_lshl_add_u32 v149, v142, 5, v141
  s_mov_b32 m0, s77
  s_nop 0
  buffer_load_dwordx4 v10, s[12:15], s63 offen offset:0 lds
  v_xor_b32 v142, 2, v140
  v_lshl_add_u32 v150, v142, 5, v141
  v_xor_b32 v142, 3, v140
  v_lshl_add_u32 v151, v142, 5, v141
  v_xor_b32 v142, 4, v140
  buffer_load_dwordx4 v11, s[12:15], s63 offen offset:1024 lds
  v_lshl_add_u32 v152, v142, 5, v141
  v_xor_b32 v142, 5, v140
  v_lshl_add_u32 v153, v142, 5, v141
  v_xor_b32 v142, 6, v140
  v_lshl_add_u32 v154, v142, 5, v141
  buffer_load_dwordx4 v12, s[12:15], s63 offen offset:2048 lds
  v_xor_b32 v142, 7, v140
  v_lshl_add_u32 v155, v142, 5, v141
  v_and_b32 v142, 15, v0
  v_mul_u32_u24 v142, 2080, v142
  v_lshl_add_u32 v142, v136, 3, v142
  s_waitcnt vmcnt(11)
  s_barrier
  s_mov_b32 m0, s78
  s_nop 0
  buffer_load_dwordx4 v2, s[8:11], s48 offen offset:0 lds
  s_lshl_b32 s35, s31, 9
  s_add_u32 s35, s35, 131072
  v_add_u32 v156, s35, v142
  v_lshrrev_b32 v139, 1, v136
  v_and_b32 v140, 1, v136
  buffer_load_dwordx4 v3, s[8:11], s48 offen offset:1024 lds
  v_lshl_add_u32 v139, v139, 2, v137
  v_lshlrev_b32 v139, 6, v139
  v_lshl_add_u32 v139, v140, 5, v139
  v_lshl_add_u32 v139, v138, 3, v139
  s_mul_i32 s35, s31, 4160
  buffer_load_dwordx4 v4, s[8:11], s48 offen offset:2048 lds
  s_add_u32 s35, s35, 131072
  v_add_u32 v157, s35, v139
  v_lshrrev_b32 v136, 4, v0
  v_and_b32 v137, 15, v0
  v_add_u32 v138, 0, v136
  buffer_load_dwordx4 v5, s[8:11], s48 offen offset:3072 lds
  v_and_b32 v139, 7, v138
  v_lshrrev_b32 v140, 1, v137
  v_xor_b32 v139, v139, v140
  v_lshlrev_b32 v139, 5, v139
  v_and_b32 v140, 1, v137
  s_mov_b32 m0, s79
  s_nop 0
  buffer_load_dwordx4 v6, s[12:15], s64 offen offset:0 lds
  v_lshl_add_u32 v139, v140, 4, v139
  v_lshl_add_u32 v139, v138, 11, v139
  s_lshl_b32 s35, s31, 15
  s_sub_u32 s35, s35, 0
  v_add_u32 v139, s35, v139
  buffer_load_dwordx4 v7, s[12:15], s64 offen offset:1024 lds
  v_accvgpr_write_b32 a28, v139
  v_add_u32 v138, 4, v136
  v_and_b32 v139, 7, v138
  v_lshrrev_b32 v140, 1, v137
  v_xor_b32 v139, v139, v140
  buffer_load_dwordx4 v8, s[12:15], s64 offen offset:2048 lds
  v_lshlrev_b32 v139, 5, v139
  v_and_b32 v140, 1, v137
  v_lshl_add_u32 v139, v140, 4, v139
  v_lshl_add_u32 v139, v138, 11, v139
  s_lshl_b32 s35, s31, 15
  buffer_load_dwordx4 v9, s[12:15], s64 offen offset:3072 lds
  s_sub_u32 s35, s35, 1024
  v_add_u32 v139, s35, v139
  v_accvgpr_write_b32 a29, v139
  v_add_u32 v138, 8, v136
  v_and_b32 v139, 7, v138
  s_mov_b32 m0, s80
  s_nop 0
  buffer_load_dwordx4 v10, s[12:15], s64 offen offset:0 lds
  v_lshrrev_b32 v140, 1, v137
  v_xor_b32 v139, v139, v140
  v_lshlrev_b32 v139, 5, v139
  v_and_b32 v140, 1, v137
  v_lshl_add_u32 v139, v140, 4, v139
  buffer_load_dwordx4 v11, s[12:15], s64 offen offset:1024 lds
  v_lshl_add_u32 v139, v138, 11, v139
  s_lshl_b32 s35, s31, 15
  s_sub_u32 s35, s35, 2048
  v_add_u32 v139, s35, v139
  v_accvgpr_write_b32 a30, v139
  buffer_load_dwordx4 v12, s[12:15], s64 offen offset:2048 lds
  v_add_u32 v138, 12, v136
  v_and_b32 v139, 7, v138
  v_lshrrev_b32 v140, 1, v137
  v_xor_b32 v139, v139, v140
  v_lshlrev_b32 v139, 5, v139
  s_waitcnt vmcnt(11)
  s_barrier
  s_mov_b32 m0, s72
  s_nop 0
  buffer_load_dwordx4 v2, s[8:11], s49 offen offset:0 lds
  v_and_b32 v140, 1, v137
  v_lshl_add_u32 v139, v140, 4, v139
  v_lshl_add_u32 v139, v138, 11, v139
  s_lshl_b32 s35, s31, 15
  s_sub_u32 s35, s35, 3072
  buffer_load_dwordx4 v3, s[8:11], s49 offen offset:1024 lds
  v_add_u32 v139, s35, v139
  v_accvgpr_write_b32 a31, v139
  buffer_load_dwordx4 v4, s[8:11], s49 offen offset:2048 lds
  buffer_load_dwordx4 v5, s[8:11], s49 offen offset:3072 lds
  s_mov_b32 m0, s73
  s_nop 0
  buffer_load_dwordx4 v6, s[12:15], s65 offen offset:0 lds
  buffer_load_dwordx4 v7, s[12:15], s65 offen offset:1024 lds
  buffer_load_dwordx4 v8, s[12:15], s65 offen offset:2048 lds
  buffer_load_dwordx4 v9, s[12:15], s65 offen offset:3072 lds
  s_mov_b32 m0, s74
  s_nop 0
  buffer_load_dwordx4 v10, s[12:15], s65 offen offset:0 lds
  buffer_load_dwordx4 v11, s[12:15], s65 offen offset:1024 lds
  buffer_load_dwordx4 v12, s[12:15], s65 offen offset:2048 lds
  s_waitcnt vmcnt(11)
  s_barrier
  s_mov_b32 m0, s75
  s_nop 0
  buffer_load_dwordx4 v2, s[8:11], s50 offen offset:0 lds
  buffer_load_dwordx4 v3, s[8:11], s50 offen offset:1024 lds
  buffer_load_dwordx4 v4, s[8:11], s50 offen offset:2048 lds
  buffer_load_dwordx4 v5, s[8:11], s50 offen offset:3072 lds
  s_mov_b32 m0, s76
  s_nop 0
  buffer_load_dwordx4 v6, s[12:15], s66 offen offset:0 lds
  buffer_load_dwordx4 v7, s[12:15], s66 offen offset:1024 lds
  buffer_load_dwordx4 v8, s[12:15], s66 offen offset:2048 lds
  buffer_load_dwordx4 v9, s[12:15], s66 offen offset:3072 lds
  s_mov_b32 m0, s77
  s_nop 0
  buffer_load_dwordx4 v10, s[12:15], s66 offen offset:0 lds
  buffer_load_dwordx4 v11, s[12:15], s66 offen offset:1024 lds
  buffer_load_dwordx4 v12, s[12:15], s66 offen offset:2048 lds
  s_waitcnt vmcnt(11)
  s_barrier
  s_mov_b32 m0, s78
  s_nop 0
  buffer_load_dwordx4 v2, s[8:11], s51 offen offset:0 lds
  buffer_load_dwordx4 v3, s[8:11], s51 offen offset:1024 lds
  buffer_load_dwordx4 v4, s[8:11], s51 offen offset:2048 lds
  buffer_load_dwordx4 v5, s[8:11], s51 offen offset:3072 lds
  s_mov_b32 m0, s79
  s_nop 0
  buffer_load_dwordx4 v6, s[12:15], s67 offen offset:0 lds
  buffer_load_dwordx4 v7, s[12:15], s67 offen offset:1024 lds
  buffer_load_dwordx4 v8, s[12:15], s67 offen offset:2048 lds
  buffer_load_dwordx4 v9, s[12:15], s67 offen offset:3072 lds
  s_mov_b32 m0, s80
  s_nop 0
  buffer_load_dwordx4 v10, s[12:15], s67 offen offset:0 lds
  buffer_load_dwordx4 v11, s[12:15], s67 offen offset:1024 lds
  buffer_load_dwordx4 v12, s[12:15], s67 offen offset:2048 lds
  s_waitcnt vmcnt(11)
  s_barrier
  s_mov_b32 m0, s72
  s_nop 0
  buffer_load_dwordx4 v2, s[8:11], s52 offen offset:0 lds
  buffer_load_dwordx4 v3, s[8:11], s52 offen offset:1024 lds
  buffer_load_dwordx4 v4, s[8:11], s52 offen offset:2048 lds
  buffer_load_dwordx4 v5, s[8:11], s52 offen offset:3072 lds
  s_mov_b32 m0, s73
  s_nop 0
  buffer_load_dwordx4 v6, s[12:15], s68 offen offset:0 lds
  buffer_load_dwordx4 v7, s[12:15], s68 offen offset:1024 lds
  buffer_load_dwordx4 v8, s[12:15], s68 offen offset:2048 lds
  buffer_load_dwordx4 v9, s[12:15], s68 offen offset:3072 lds
  s_mov_b32 m0, s74
  s_nop 0
  buffer_load_dwordx4 v10, s[12:15], s68 offen offset:0 lds
  buffer_load_dwordx4 v11, s[12:15], s68 offen offset:1024 lds
  buffer_load_dwordx4 v12, s[12:15], s68 offen offset:2048 lds
  s_waitcnt vmcnt(11)
  s_barrier
  s_mov_b32 s16, s98
  s_mov_b32 s17, s99
  s_mov_b32 s18, 0x100
  s_mov_b32 s19, 0x20000
  v_mov_b32 v95, 0
  buffer_load_dword v1, v95, s[16:19], 0 offen sc1
  s_add_u32 s84, s6, 25231360
  s_addc_u32 s85, s7, 0
  s_mov_b32 s86, 0xa000
  s_mov_b32 s87, 0x20000
  v_lshrrev_b32 v94, 4, v0
  v_lshlrev_b32 v94, 7, v94
  v_and_b32 v95, 15, v0
  v_lshl_add_u32 v94, v95, 2, v94
  s_mov_b32 s81, 32768
  buffer_load_dword v96, v94, s[84:87], s81 offen offset:0 sc1
  buffer_load_dword v97, v94, s[84:87], s81 offen offset:512 sc1
  buffer_load_dword v98, v94, s[84:87], s81 offen offset:1024 sc1
  buffer_load_dword v99, v94, s[84:87], s81 offen offset:1536 sc1
  s_mov_b32 m0, s75
  s_nop 0
  buffer_load_dwordx4 v2, s[8:11], s53 offen offset:0 lds
  buffer_load_dwordx4 v3, s[8:11], s53 offen offset:1024 lds
  buffer_load_dwordx4 v4, s[8:11], s53 offen offset:2048 lds
  buffer_load_dwordx4 v5, s[8:11], s53 offen offset:3072 lds
  s_mov_b32 m0, s76
  s_nop 0
  buffer_load_dwordx4 v6, s[12:15], s69 offen offset:0 lds
  buffer_load_dwordx4 v7, s[12:15], s69 offen offset:1024 lds
  buffer_load_dwordx4 v8, s[12:15], s69 offen offset:2048 lds
  buffer_load_dwordx4 v9, s[12:15], s69 offen offset:3072 lds
  s_mov_b32 m0, s77
  s_nop 0
  buffer_load_dwordx4 v10, s[12:15], s69 offen offset:0 lds
  buffer_load_dwordx4 v11, s[12:15], s69 offen offset:1024 lds
  buffer_load_dwordx4 v12, s[12:15], s69 offen offset:2048 lds
  s_waitcnt vmcnt(16)
  s_barrier
  s_mov_b32 m0, s78
  s_nop 0
  buffer_load_dwordx4 v2, s[8:11], s54 offen offset:0 lds
  buffer_load_dwordx4 v3, s[8:11], s54 offen offset:1024 lds
  buffer_load_dwordx4 v4, s[8:11], s54 offen offset:2048 lds
  buffer_load_dwordx4 v5, s[8:11], s54 offen offset:3072 lds
  s_mov_b32 m0, s79
  s_nop 0
  buffer_load_dwordx4 v6, s[12:15], s70 offen offset:0 lds
  buffer_load_dwordx4 v7, s[12:15], s70 offen offset:1024 lds
  buffer_load_dwordx4 v8, s[12:15], s70 offen offset:2048 lds
  buffer_load_dwordx4 v9, s[12:15], s70 offen offset:3072 lds
  s_mov_b32 m0, s80
  s_nop 0
  buffer_load_dwordx4 v10, s[12:15], s70 offen offset:0 lds
  buffer_load_dwordx4 v11, s[12:15], s70 offen offset:1024 lds
  buffer_load_dwordx4 v12, s[12:15], s70 offen offset:2048 lds
  s_waitcnt vmcnt(11)
  s_barrier
  s_mov_b32 m0, s72
  s_nop 0
  buffer_load_dwordx4 v2, s[8:11], s55 offen offset:0 lds
  buffer_load_dwordx4 v3, s[8:11], s55 offen offset:1024 lds
  buffer_load_dwordx4 v4, s[8:11], s55 offen offset:2048 lds
  buffer_load_dwordx4 v5, s[8:11], s55 offen offset:3072 lds
  s_mov_b32 m0, s73
  s_nop 0
  buffer_load_dwordx4 v6, s[12:15], s71 offen offset:0 lds
  buffer_load_dwordx4 v7, s[12:15], s71 offen offset:1024 lds
  buffer_load_dwordx4 v8, s[12:15], s71 offen offset:2048 lds
  buffer_load_dwordx4 v9, s[12:15], s71 offen offset:3072 lds
  s_mov_b32 m0, s74
  s_nop 0
  buffer_load_dwordx4 v10, s[12:15], s71 offen offset:0 lds
  buffer_load_dwordx4 v11, s[12:15], s71 offen offset:1024 lds
  buffer_load_dwordx4 v12, s[12:15], s71 offen offset:2048 lds
  v_mov_b32 v93, 0
  v_readfirstlane_b32 s1, v1
  s_cmp_lg_u32 s1, 0
  s_cbranch_scc1 P2_tag_ok
  s_mov_b32 s49, 0
P2_tag:
  buffer_load_dword v1, v93, s[16:19], 0 offen sc1
  s_waitcnt vmcnt(0)
  v_readfirstlane_b32 s1, v1
  s_cmp_lg_u32 s1, 0
  s_cbranch_scc1 P2_tag_ok
  s_add_u32 s49, s49, 1
  s_cmp_lt_u32 s49, 1048576
  s_cbranch_scc0 P2_tag_ok
  s_sleep 1
  s_branch P2_tag
P2_tag_ok:
  v_xor_b32 v96, s1, v96
  v_xor_b32 v97, s1, v97
  v_xor_b32 v98, s1, v98
  v_xor_b32 v99, s1, v99
  v_or_b32 v100, v96, v97
  v_or3_b32 v100, v100, v98, v99
  v_and_b32 v100, 0x0fffffff, v100
  v_cmp_ne_u32 vcc, 0, v100
  s_nop 1
  s_cmp_eq_u64 vcc, 0
  s_cbranch_scc1 P2_polla_done
  s_mov_b32 s49, 0
P2_polla:
  buffer_load_dword v96, v94, s[84:87], s81 offen offset:0 sc1
  buffer_load_dword v97, v94, s[84:87], s81 offen offset:512 sc1
  buffer_load_dword v98, v94, s[84:87], s81 offen offset:1024 sc1
  buffer_load_dword v99, v94, s[84:87], s81 offen offset:1536 sc1
  s_waitcnt vmcnt(0)
  v_xor_b32 v96, s1, v96
  v_xor_b32 v97, s1, v97
  v_xor_b32 v98, s1, v98
  v_xor_b32 v99, s1, v99
  v_or_b32 v100, v96, v97
  v_or3_b32 v100, v100, v98, v99
  v_and_b32 v100, 0x0fffffff, v100
  v_cmp_ne_u32 vcc, 0, v100
  s_nop 1
  s_cmp_eq_u64 vcc, 0
  s_cbranch_scc1 P2_polla_ok
  s_add_u32 s49, s49, 1
  s_cmp_lt_u32 s49, 1048576
  s_cbranch_scc0 P2_polla_ok
  s_sleep 1
  s_branch P2_polla
P2_polla_ok:
P2_polla_done:
  s_add_u32 s8, s6, 16777216
  s_addc_u32 s9, s7, 0
  s_mov_b32 s10, 0x400000
  s_mov_b32 s11, 0x20000
  s_bfe_u32 s82, s2, 0x20003
  s_lshl_b32 s82, s82, 2
  s_add_u32 s82, s82, s31
  s_lshl_b32 s82, s82, 18
  s_lshl_b32 s83, s38, 11
  s_add_u32 s82, s82, s83
  v_lshrrev_b32 v92, 4, v0
  v_mul_lo_u32 v92, v92, s39
  v_and_b32 v91, 15, v0
  v_lshl_add_u32 v92, v91, 7, v92
  s_mov_b32 exec_lo, -1
  s_mov_b32 exec_hi, 0
  buffer_load_dword v91, v92, s[8:11], s82 offen sc1
  s_mov_b64 exec, -1
  s_waitcnt vmcnt(12)
  s_barrier
  s_waitcnt lgkmcnt(0)
  s_waitcnt vmcnt(1)
  s_barrier
  v_mov_b32 v92, 163584
  v_mov_b32 v93, 0
  s_cmp_eq_u32 s31, 0
  s_cbranch_scc0 P2_nz
  ds_write_b32 v92, v93
  ds_write_b32 v92, v93 offset:4
P2_nz:
  s_add_u32 m0, s37, 0
  s_add_u32 s39, s36, 0
  buffer_load_dwordx4 v144, s[8:11], s39 offen offset:0 sc1 lds
  s_add_u32 s39, s36, 262144
  buffer_load_dwordx4 v145, s[8:11], s39 offen offset:1024 sc1 lds
  s_add_u32 s39, s36, 524288
  buffer_load_dwordx4 v146, s[8:11], s39 offen offset:2048 sc1 lds
  s_add_u32 s39, s36, 786432
  buffer_load_dwordx4 v147, s[8:11], s39 offen offset:3072 sc1 lds
  s_add_u32 m0, s37, 4096
  s_add_u32 s39, s36, 1048576
  buffer_load_dwordx4 v144, s[8:11], s39 offen offset:0 sc1 lds
  s_add_u32 s39, s36, 1310720
  buffer_load_dwordx4 v145, s[8:11], s39 offen offset:1024 sc1 lds
  s_add_u32 s39, s36, 1572864
  buffer_load_dwordx4 v146, s[8:11], s39 offen offset:2048 sc1 lds
  s_add_u32 s39, s36, 1835008
  buffer_load_dwordx4 v147, s[8:11], s39 offen offset:3072 sc1 lds
  s_add_u32 m0, s37, 8192
  s_add_u32 s39, s36, 2097152
  buffer_load_dwordx4 v144, s[8:11], s39 offen offset:0 sc1 lds
  s_add_u32 s39, s36, 2359296
  buffer_load_dwordx4 v145, s[8:11], s39 offen offset:1024 sc1 lds
  s_add_u32 s39, s36, 2621440
  buffer_load_dwordx4 v146, s[8:11], s39 offen offset:2048 sc1 lds
  s_add_u32 s39, s36, 2883584
  buffer_load_dwordx4 v147, s[8:11], s39 offen offset:3072 sc1 lds
  s_add_u32 m0, s37, 12288
  s_add_u32 s39, s36, 3145728
  buffer_load_dwordx4 v144, s[8:11], s39 offen offset:0 sc1 lds
  s_add_u32 s39, s36, 3407872
  buffer_load_dwordx4 v145, s[8:11], s39 offen offset:1024 sc1 lds
  s_add_u32 s39, s36, 3670016
  buffer_load_dwordx4 v146, s[8:11], s39 offen offset:2048 sc1 lds
  s_add_u32 s39, s36, 3932160
  buffer_load_dwordx4 v147, s[8:11], s39 offen offset:3072 sc1 lds
  s_waitcnt lgkmcnt(0)
  s_barrier
  s_mov_b32 s12, s6
  s_mov_b32 s13, s7
  s_mov_b32 s14, 0x1000000
  s_mov_b32 s15, 0x20000
  s_mov_b32 s60, s90
  s_mov_b32 s61, s91
  s_mov_b32 s62, 0x700000
  s_mov_b32 s63, 0x20000
  s_add_u32 s64, s6, 20971520
  s_addc_u32 s65, s7, 0
  s_mov_b32 s66, 0x400000
  s_mov_b32 s67, 0x20000
  s_lshl_b32 s35, s24, 20
  s_mul_i32 s39, s23, 458752
  s_add_u32 s46, s35, s39
  s_mul_i32 s39, s23, 3670016
  s_lshl_b32 s35, s30, 8
  s_add_u32 s47, s39, s35
  s_and_b32 s39, s24, 3
  s_lshl_b32 s39, s39, 20
  s_add_u32 s51, s39, s35
  s_mov_b32 s50, s27
  s_mul_i32 s39, s50, 65536
  s_add_u32 s46, s46, s39
  s_mul_i32 s39, s50, 524288
  s_add_u32 s47, s47, s39
  s_lshl_b32 s35, s31, 12
  v_lshlrev_b32 v2, 4, v0
  v_add_u32 v2, s35, v2
  v_accvgpr_read_b32 v4, a28
  v_accvgpr_read_b32 v5, a29
  v_accvgpr_read_b32 v6, a30
  v_accvgpr_read_b32 v7, a31
  s_lshl_b32 s75, s31, 12
  s_add_u32 s52, s75, 0
  s_add_u32 s53, s75, 16384
  s_add_u32 s54, s75, 32768
  s_add_u32 s55, s75, 49152
  s_add_u32 s56, s75, 65536
  s_add_u32 s57, s75, 81920
  s_add_u32 s58, s75, 98304
  s_add_u32 s59, s75, 114688
  s_add_u32 s35, s26, 0
  s_and_b32 s35, s35, 3
  s_lshl_b32 s76, s35, 14
  s_lshl_b32 s80, s35, 17
  s_add_u32 s35, s26, 1
  s_and_b32 s35, s35, 3
  s_lshl_b32 s77, s35, 14
  s_lshl_b32 s81, s35, 17
  s_add_u32 s35, s26, 2
  s_and_b32 s35, s35, 3
  s_lshl_b32 s78, s35, 14
  s_lshl_b32 s82, s35, 17
  s_add_u32 s35, s26, 3
  s_and_b32 s35, s35, 3
  s_lshl_b32 s79, s35, 14
  s_lshl_b32 s83, s35, 17
  s_add_u32 s85, s47, s80
  s_mov_b32 m0, s53
  s_nop 0
  buffer_load_dwordx4 v4, s[60:63], s85 offen offset:0 lds
  buffer_load_dwordx4 v5, s[60:63], s85 offen offset:1024 lds
  buffer_load_dwordx4 v6, s[60:63], s85 offen offset:2048 lds
  buffer_load_dwordx4 v7, s[60:63], s85 offen offset:3072 lds
  s_add_u32 s85, s47, s81
  s_mov_b32 m0, s55
  s_nop 0
  buffer_load_dwordx4 v4, s[60:63], s85 offen offset:0 lds
  buffer_load_dwordx4 v5, s[60:63], s85 offen offset:1024 lds
  buffer_load_dwordx4 v6, s[60:63], s85 offen offset:2048 lds
  buffer_load_dwordx4 v7, s[60:63], s85 offen offset:3072 lds
  s_mov_b32 s40, s94
  s_mov_b32 s41, s95
  s_mov_b32 s42, 0x201000
  s_mov_b32 s43, 0x20000
  s_mov_b32 s68, s96
  s_mov_b32 s69, s97
  s_mov_b32 s70, 0x201000
  s_mov_b32 s71, 0x20000
  buffer_load_short_d16_hi v20, v16, s[40:43], s33 offen offset:0
  buffer_load_short_d16_hi v36, v16, s[68:71], s33 offen offset:0
  buffer_load_short_d16_hi v21, v16, s[40:43], s33 offen offset:64
  buffer_load_short_d16_hi v37, v16, s[68:71], s33 offen offset:64
  buffer_load_short_d16_hi v22, v16, s[40:43], s33 offen offset:128
  buffer_load_short_d16_hi v38, v16, s[68:71], s33 offen offset:128
  buffer_load_short_d16_hi v23, v16, s[40:43], s33 offen offset:192
  buffer_load_short_d16_hi v39, v16, s[68:71], s33 offen offset:192
  buffer_load_short_d16_hi v24, v16, s[40:43], s33 offen offset:512
  buffer_load_short_d16_hi v40, v16, s[68:71], s33 offen offset:512
  buffer_load_short_d16_hi v25, v16, s[40:43], s33 offen offset:576
  buffer_load_short_d16_hi v41, v16, s[68:71], s33 offen offset:576
  buffer_load_short_d16_hi v26, v16, s[40:43], s33 offen offset:640
  buffer_load_short_d16_hi v42, v16, s[68:71], s33 offen offset:640
  buffer_load_short_d16_hi v27, v16, s[40:43], s33 offen offset:704
  buffer_load_short_d16_hi v43, v16, s[68:71], s33 offen offset:704
  buffer_load_short_d16_hi v28, v17, s[40:43], s34 offen offset:704
  buffer_load_short_d16_hi v44, v17, s[68:71], s34 offen offset:704
  buffer_load_short_d16_hi v29, v17, s[40:43], s34 offen offset:640
  buffer_load_short_d16_hi v45, v17, s[68:71], s34 offen offset:640
  buffer_load_short_d16_hi v30, v17, s[40:43], s34 offen offset:576
  buffer_load_short_d16_hi v46, v17, s[68:71], s34 offen offset:576
  buffer_load_short_d16_hi v31, v17, s[40:43], s34 offen offset:512
  buffer_load_short_d16_hi v47, v17, s[68:71], s34 offen offset:512
  buffer_load_short_d16_hi v32, v17, s[40:43], s34 offen offset:192
  buffer_load_short_d16_hi v48, v17, s[68:71], s34 offen offset:192
  buffer_load_short_d16_hi v33, v17, s[40:43], s34 offen offset:128
  buffer_load_short_d16_hi v49, v17, s[68:71], s34 offen offset:128
  buffer_load_short_d16_hi v34, v17, s[40:43], s34 offen offset:64
  buffer_load_short_d16_hi v50, v17, s[68:71], s34 offen offset:64
  buffer_load_short_d16_hi v35, v17, s[40:43], s34 offen offset:0
  buffer_load_short_d16_hi v51, v17, s[68:71], s34 offen offset:0
  buffer_load_short_d16_hi v52, v18, s[40:43], s34 offen
  buffer_load_short_d16_hi v53, v18, s[68:71], s34 offen
  buffer_load_short_d16_hi v54, v18, s[40:43], s33 offen offset:1024
  buffer_load_short_d16_hi v55, v18, s[68:71], s33 offen offset:1024
  s_waitcnt vmcnt(44)
  ds_read_b64_tr_b16 a[32:33], v148 offset:0
  ds_read_b64_tr_b16 a[34:35], v148 offset:8192
  ds_read_b64_tr_b16 a[36:37], v149 offset:0
  ds_read_b64_tr_b16 a[38:39], v149 offset:8192
  ds_read_b64_tr_b16 a[40:41], v150 offset:0
  ds_read_b64_tr_b16 a[42:43], v150 offset:8192
  ds_read_b64_tr_b16 a[44:45], v151 offset:0
  ds_read_b64_tr_b16 a[46:47], v151 offset:8192
  ds_read_b64_tr_b16 a[48:49], v152 offset:0
  ds_read_b64_tr_b16 a[50:51], v152 offset:8192
  ds_read_b64_tr_b16 a[52:53], v153 offset:0
  ds_read_b64_tr_b16 a[54:55], v153 offset:8192
  ds_read_b64_tr_b16 a[56:57], v154 offset:0
  ds_read_b64_tr_b16 a[58:59], v154 offset:8192
  ds_read_b64_tr_b16 a[60:61], v155 offset:0
  ds_read_b64_tr_b16 a[62:63], v155 offset:8192
  ds_read_b64_tr_b16 a[64:65], v148 offset:256
  ds_read_b64_tr_b16 a[66:67], v148 offset:8448
  ds_read_b64_tr_b16 a[68:69], v149 offset:256
  ds_read_b64_tr_b16 a[70:71], v149 offset:8448
  ds_read_b64_tr_b16 a[72:73], v150 offset:256
  ds_read_b64_tr_b16 a[74:75], v150 offset:8448
  ds_read_b64_tr_b16 a[76:77], v151 offset:256
  ds_read_b64_tr_b16 a[78:79], v151 offset:8448
  ds_read_b64_tr_b16 a[80:81], v152 offset:256
  ds_read_b64_tr_b16 a[82:83], v152 offset:8448
  ds_read_b64_tr_b16 a[84:85], v153 offset:256
  ds_read_b64_tr_b16 a[86:87], v153 offset:8448
  ds_read_b64_tr_b16 a[88:89], v154 offset:256
  ds_read_b64_tr_b16 a[90:91], v154 offset:8448
  ds_read_b64_tr_b16 a[92:93], v155 offset:256
  ds_read_b64_tr_b16 a[94:95], v155 offset:8448
  s_waitcnt lgkmcnt(0)
  v_mfma_f32_16x16x32_bf16 v[104:107], a[32:35], a[24:27], 0
  v_mfma_f32_16x16x32_bf16 v[108:111], a[36:39], a[24:27], 0
  v_mfma_f32_16x16x32_bf16 v[112:115], a[40:43], a[24:27], 0
  v_mfma_f32_16x16x32_bf16 v[116:119], a[44:47], a[24:27], 0
  s_nop 7
  v_cvt_pk_bf16_f32 v104, v104, v105
  v_cvt_pk_bf16_f32 v105, v106, v107
  v_cvt_pk_bf16_f32 v108, v108, v109
  v_cvt_pk_bf16_f32 v109, v110, v111
  v_cvt_pk_bf16_f32 v112, v112, v113
  v_cvt_pk_bf16_f32 v113, v114, v115
  v_cvt_pk_bf16_f32 v116, v116, v117
  v_cvt_pk_bf16_f32 v117, v118, v119
  s_mov_b32 exec_lo, 0x00ff00ff
  s_mov_b32 exec_hi, 0x00ff00ff
  ds_write_b64 v156, v[104:105] offset:0
  ds_write_b64 v156, v[108:109] offset:32
  ds_write_b64 v156, v[112:113] offset:64
  ds_write_b64 v156, v[116:117] offset:96
  s_mov_b64 exec, -1
  v_mfma_f32_16x16x32_bf16 v[104:107], a[48:51], a[24:27], 0
  v_mfma_f32_16x16x32_bf16 v[108:111], a[52:55], a[24:27], 0
  v_mfma_f32_16x16x32_bf16 v[112:115], a[56:59], a[24:27], 0
  v_mfma_f32_16x16x32_bf16 v[116:119], a[60:63], a[24:27], 0
  s_nop 7
  v_cvt_pk_bf16_f32 v104, v104, v105
  v_cvt_pk_bf16_f32 v105, v106, v107
  v_cvt_pk_bf16_f32 v108, v108, v109
  v_cvt_pk_bf16_f32 v109, v110, v111
  v_cvt_pk_bf16_f32 v112, v112, v113
  v_cvt_pk_bf16_f32 v113, v114, v115
  v_cvt_pk_bf16_f32 v116, v116, v117
  v_cvt_pk_bf16_f32 v117, v118, v119
  s_mov_b32 exec_lo, 0x00ff00ff
  s_mov_b32 exec_hi, 0x00ff00ff
  ds_write_b64 v156, v[104:105] offset:128
  ds_write_b64 v156, v[108:109] offset:160
  ds_write_b64 v156, v[112:113] offset:192
  ds_write_b64 v156, v[116:117] offset:224
  s_mov_b64 exec, -1
  v_mfma_f32_16x16x32_bf16 v[104:107], a[64:67], a[24:27], 0
  v_mfma_f32_16x16x32_bf16 v[108:111], a[68:71], a[24:27], 0
  v_mfma_f32_16x16x32_bf16 v[112:115], a[72:75], a[24:27], 0
  v_mfma_f32_16x16x32_bf16 v[116:119], a[76:79], a[24:27], 0
  s_nop 7
  v_cvt_pk_bf16_f32 v104, v104, v105
  v_cvt_pk_bf16_f32 v105, v106, v107
  v_cvt_pk_bf16_f32 v108, v108, v109
  v_cvt_pk_bf16_f32 v109, v110, v111
  v_cvt_pk_bf16_f32 v112, v112, v113
  v_cvt_pk_bf16_f32 v113, v114, v115
  v_cvt_pk_bf16_f32 v116, v116, v117
  v_cvt_pk_bf16_f32 v117, v118, v119
  s_mov_b32 exec_lo, 0x00ff00ff
  s_mov_b32 exec_hi, 0x00ff00ff
  ds_write_b64 v156, v[104:105] offset:256
  ds_write_b64 v156, v[108:109] offset:288
  ds_write_b64 v156, v[112:113] offset:320
  ds_write_b64 v156, v[116:117] offset:352
  s_mov_b64 exec, -1
  v_mfma_f32_16x16x32_bf16 v[104:107], a[80:83], a[24:27], 0
  v_mfma_f32_16x16x32_bf16 v[108:111], a[84:87], a[24:27], 0
  v_mfma_f32_16x16x32_bf16 v[112:115], a[88:91], a[24:27], 0
  v_mfma_f32_16x16x32_bf16 v[116:119], a[92:95], a[24:27], 0
  s_nop 7
  v_cvt_pk_bf16_f32 v104, v104, v105
  v_cvt_pk_bf16_f32 v105, v106, v107
  v_cvt_pk_bf16_f32 v108, v108, v109
  v_cvt_pk_bf16_f32 v109, v110, v111
  v_cvt_pk_bf16_f32 v112, v112, v113
  v_cvt_pk_bf16_f32 v113, v114, v115
  v_cvt_pk_bf16_f32 v116, v116, v117
  v_cvt_pk_bf16_f32 v117, v118, v119
  s_mov_b32 exec_lo, 0x00ff00ff
  s_mov_b32 exec_hi, 0x00ff00ff
  ds_write_b64 v156, v[104:105] offset:384
  ds_write_b64 v156, v[108:109] offset:416
  ds_write_b64 v156, v[112:113] offset:448
  ds_write_b64 v156, v[116:117] offset:480
  s_mov_b64 exec, -1
  s_or_b32 s35, s0, s31
  s_cmp_eq_u32 s35, 0
  s_cselect_b32 s87, 1, 0
  s_cbranch_scc0 P2_now1
  v_accvgpr_write_b32 a32, 0
  v_accvgpr_write_b32 a33, 0
  v_accvgpr_write_b32 a34, 0
  v_accvgpr_write_b32 a35, 0
  v_accvgpr_write_b32 a36, 0
  v_accvgpr_write_b32 a37, 0
  v_accvgpr_write_b32 a38, 0
  v_accvgpr_write_b32 a39, 0
  v_accvgpr_write_b32 a40, 0
  v_accvgpr_write_b32 a41, 0
  v_accvgpr_write_b32 a42, 0
  v_accvgpr_write_b32 a43, 0
  v_accvgpr_write_b32 a44, 0
  v_accvgpr_write_b32 a45, 0
  v_accvgpr_write_b32 a46, 0
  v_accvgpr_write_b32 a47, 0
  v_accvgpr_write_b32 a48, 0
  v_accvgpr_write_b32 a49, 0
  v_accvgpr_write_b32 a50, 0
  v_accvgpr_write_b32 a51, 0
  v_accvgpr_write_b32 a52, 0
  v_accvgpr_write_b32 a53, 0
  v_accvgpr_write_b32 a54, 0
  v_accvgpr_write_b32 a55, 0
  v_accvgpr_write_b32 a56, 0
  v_accvgpr_write_b32 a57, 0
  v_accvgpr_write_b32 a58, 0
  v_accvgpr_write_b32 a59, 0
  v_accvgpr_write_b32 a60, 0
  v_accvgpr_write_b32 a61, 0
  v_accvgpr_write_b32 a62, 0
  v_accvgpr_write_b32 a63, 0
  v_accvgpr_write_b32 a64, 0
  v_accvgpr_write_b32 a65, 0
  v_accvgpr_write_b32 a66, 0
  v_accvgpr_write_b32 a67, 0
  s_mov_b32 s35, 1050624
  buffer_load_short_d16_hi a32, v16, s[40:43], s35 offen offset:0
  buffer_load_short_d16_hi a48, v16, s[68:71], s35 offen offset:0
  buffer_load_short_d16_hi a33, v16, s[40:43], s35 offen offset:64
  buffer_load_short_d16_hi a49, v16, s[68:71], s35 offen offset:64
  buffer_load_short_d16_hi a34, v16, s[40:43], s35 offen offset:128
  buffer_load_short_d16_hi a50, v16, s[68:71], s35 offen offset:128
  buffer_load_short_d16_hi a35, v16, s[40:43], s35 offen offset:192
  buffer_load_short_d16_hi a51, v16, s[68:71], s35 offen offset:192
  buffer_load_short_d16_hi a36, v16, s[40:43], s35 offen offset:512
  buffer_load_short_d16_hi a52, v16, s[68:71], s35 offen offset:512
  buffer_load_short_d16_hi a37, v16, s[40:43], s35 offen offset:576
  buffer_load_short_d16_hi a53, v16, s[68:71], s35 offen offset:576
  buffer_load_short_d16_hi a38, v16, s[40:43], s35 offen offset:640
  buffer_load_short_d16_hi a54, v16, s[68:71], s35 offen offset:640
  buffer_load_short_d16_hi a39, v16, s[40:43], s35 offen offset:704
  buffer_load_short_d16_hi a55, v16, s[68:71], s35 offen offset:704
  buffer_load_short_d16_hi a40, v17, s[40:43], s35 offen offset:704
  buffer_load_short_d16_hi a56, v17, s[68:71], s35 offen offset:704
  buffer_load_short_d16_hi a41, v17, s[40:43], s35 offen offset:640
  buffer_load_short_d16_hi a57, v17, s[68:71], s35 offen offset:640
  buffer_load_short_d16_hi a42, v17, s[40:43], s35 offen offset:576
  buffer_load_short_d16_hi a58, v17, s[68:71], s35 offen offset:576
  buffer_load_short_d16_hi a43, v17, s[40:43], s35 offen offset:512
  buffer_load_short_d16_hi a59, v17, s[68:71], s35 offen offset:512
  buffer_load_short_d16_hi a44, v17, s[40:43], s35 offen offset:192
  buffer_load_short_d16_hi a60, v17, s[68:71], s35 offen offset:192
  buffer_load_short_d16_hi a45, v17, s[40:43], s35 offen offset:128
  buffer_load_short_d16_hi a61, v17, s[68:71], s35 offen offset:128
  buffer_load_short_d16_hi a46, v17, s[40:43], s35 offen offset:64
  buffer_load_short_d16_hi a62, v17, s[68:71], s35 offen offset:64
  buffer_load_short_d16_hi a47, v17, s[40:43], s35 offen offset:0
  buffer_load_short_d16_hi a63, v17, s[68:71], s35 offen offset:0
  buffer_load_short_d16_hi a64, v18, s[40:43], s35 offen
  buffer_load_short_d16_hi a65, v18, s[68:71], s35 offen
  buffer_load_short_d16_hi a66, v18, s[40:43], s35 offen offset:1024
  buffer_load_short_d16_hi a67, v18, s[68:71], s35 offen offset:1024
P2_now1:
  s_waitcnt lgkmcnt(0)
  v_mov_b32 v136, 163584
  v_mov_b32 v137, 1
  s_mov_b64 exec, 1
  ds_add_u32 v136, v137
  s_mov_b64 exec, -1
  s_mov_b32 s49, 0
PB_1:
  ds_read_b32 v138, v136
  s_waitcnt lgkmcnt(0)
  v_readfirstlane_b32 s48, v138
  s_cmp_ge_u32 s48, 4
  s_cbranch_scc1 PB_1_ok
  s_add_u32 s49, s49, 1
  s_cmp_lt_u32 s49, 1048576
  s_cbranch_scc1 PB_1
PB_1_ok:
  s_add_u32 s85, s47, s82
  s_mov_b32 m0, s57
  s_nop 0
  buffer_load_dwordx4 v4, s[60:63], s85 offen offset:0 lds
  buffer_load_dwordx4 v5, s[60:63], s85 offen offset:1024 lds
  buffer_load_dwordx4 v6, s[60:63], s85 offen offset:2048 lds
  buffer_load_dwordx4 v7, s[60:63], s85 offen offset:3072 lds
  s_add_u32 s85, s47, s83
  s_mov_b32 m0, s59
  s_nop 0
  buffer_load_dwordx4 v4, s[60:63], s85 offen offset:0 lds
  buffer_load_dwordx4 v5, s[60:63], s85 offen offset:1024 lds
  buffer_load_dwordx4 v6, s[60:63], s85 offen offset:2048 lds
  buffer_load_dwordx4 v7, s[60:63], s85 offen offset:3072 lds
  ds_read_b64_tr_b16 v[88:89], v157 offset:0
  ds_read_b64_tr_b16 v[90:91], v157 offset:512
  ds_read_b64_tr_b16 v[92:93], v157 offset:1024
  ds_read_b64_tr_b16 v[94:95], v157 offset:1536
  ds_read_b64_tr_b16 v[96:97], v157 offset:2080
  ds_read_b64_tr_b16 v[98:99], v157 offset:2592
  ds_read_b64_tr_b16 v[100:101], v157 offset:3104
  ds_read_b64_tr_b16 v[102:103], v157 offset:3616
  s_waitcnt vmcnt(8)
  s_mov_b64 exec, 1
  v_add_f32 v20, v20, v52
  v_sub_f32 v36, v36, v53
  v_mul_f32 v20, 0.5, v20
  v_mul_f32 v36, 0.5, v36
  v_add_f32 v28, v28, v54
  v_sub_f32 v44, v44, v55
  v_mul_f32 v28, 0.5, v28
  v_mul_f32 v44, 0.5, v44
  s_mov_b64 exec, -1
  s_waitcnt lgkmcnt(0)
  v_mfma_f32_32x32x16_bf16 v[104:119], v[88:91], a[0:3], 0
  v_mfma_f32_32x32x16_bf16 v[104:119], v[92:95], a[4:7], v[104:119]
  v_mfma_f32_32x32x16_bf16 v[120:135], v[96:99], a[0:3], 0
  v_mfma_f32_32x32x16_bf16 v[120:135], v[100:103], a[4:7], v[120:135]
  v_mfma_f32_32x32x16_bf16 v[104:119], v[96:99], a[16:19], v[104:119]
  v_mfma_f32_32x32x16_bf16 v[104:119], v[100:103], a[20:23], v[104:119]
  v_mfma_f32_32x32x16_bf16 v[120:135], v[88:91], a[8:11], v[120:135]
  v_mfma_f32_32x32x16_bf16 v[120:135], v[92:95], a[12:15], v[120:135]
  s_nop 15
  v_pk_mul_f32 v[136:137], v[104:105], v[72:73]
  v_pk_mul_f32 v[138:139], v[106:107], v[74:75]
  v_pk_mul_f32 v[140:141], v[108:109], v[76:77]
  v_pk_mul_f32 v[142:143], v[110:111], v[78:79]
  v_pk_mul_f32 v[104:105], v[104:105], v[56:57]
  v_pk_mul_f32 v[106:107], v[106:107], v[58:59]
  v_pk_mul_f32 v[108:109], v[108:109], v[60:61]
  v_pk_mul_f32 v[110:111], v[110:111], v[62:63]
  v_pk_fma_f32 v[104:105], v[120:121], v[72:73], v[104:105] neg_lo:[1,0,0] neg_hi:[1,0,0]
  v_pk_fma_f32 v[106:107], v[122:123], v[74:75], v[106:107] neg_lo:[1,0,0] neg_hi:[1,0,0]
  v_pk_fma_f32 v[108:109], v[124:125], v[76:77], v[108:109] neg_lo:[1,0,0] neg_hi:[1,0,0]
  v_pk_fma_f32 v[110:111], v[126:127], v[78:79], v[110:111] neg_lo:[1,0,0] neg_hi:[1,0,0]
  v_pk_fma_f32 v[120:121], v[120:121], v[56:57], v[136:137]
  v_pk_fma_f32 v[122:123], v[122:123], v[58:59], v[138:139]
  v_pk_fma_f32 v[124:125], v[124:125], v[60:61], v[140:141]
  v_pk_fma_f32 v[126:127], v[126:127], v[62:63], v[142:143]
  v_pk_mul_f32 v[136:137], v[112:113], v[80:81]
  v_pk_mul_f32 v[138:139], v[114:115], v[82:83]
  v_pk_mul_f32 v[140:141], v[116:117], v[84:85]
  v_pk_mul_f32 v[142:143], v[118:119], v[86:87]
  v_pk_mul_f32 v[112:113], v[112:113], v[64:65]
  v_pk_mul_f32 v[114:115], v[114:115], v[66:67]
  v_pk_mul_f32 v[116:117], v[116:117], v[68:69]
  v_pk_mul_f32 v[118:119], v[118:119], v[70:71]
  v_pk_fma_f32 v[112:113], v[128:129], v[80:81], v[112:113] neg_lo:[1,0,0] neg_hi:[1,0,0]
  v_pk_fma_f32 v[114:115], v[130:131], v[82:83], v[114:115] neg_lo:[1,0,0] neg_hi:[1,0,0]
  v_pk_fma_f32 v[116:117], v[132:133], v[84:85], v[116:117] neg_lo:[1,0,0] neg_hi:[1,0,0]
  v_pk_fma_f32 v[118:119], v[134:135], v[86:87], v[118:119] neg_lo:[1,0,0] neg_hi:[1,0,0]
  v_pk_fma_f32 v[128:129], v[128:129], v[64:65], v[136:137]
  v_pk_fma_f32 v[130:131], v[130:131], v[66:67], v[138:139]
  v_pk_fma_f32 v[132:133], v[132:133], v[68:69], v[140:141]
  v_pk_fma_f32 v[134:135], v[134:135], v[70:71], v[142:143]
  v_cvt_pk_bf16_f32 v88, v104, v105
  v_cvt_pk_bf16_f32 v96, v120, v121
  v_cvt_pk_bf16_f32 v89, v106, v107
  v_cvt_pk_bf16_f32 v97, v122, v123
  v_cvt_pk_bf16_f32 v90, v108, v109
  v_cvt_pk_bf16_f32 v98, v124, v125
  v_cvt_pk_bf16_f32 v91, v110, v111
  v_cvt_pk_bf16_f32 v99, v126, v127
  v_cvt_pk_bf16_f32 v92, v112, v113
  v_cvt_pk_bf16_f32 v100, v128, v129
  v_cvt_pk_bf16_f32 v93, v114, v115
  v_cvt_pk_bf16_f32 v101, v130, v131
  v_cvt_pk_bf16_f32 v94, v116, v117
  v_cvt_pk_bf16_f32 v102, v132, v133
  v_cvt_pk_bf16_f32 v95, v118, v119
  v_cvt_pk_bf16_f32 v103, v134, v135
  s_nop 1
  v_mfma_f32_32x32x16_bf16 v[104:119], a[0:3], v[88:91], 0
  v_mfma_f32_32x32x16_bf16 v[104:119], a[4:7], v[92:95], v[104:119]
  v_mfma_f32_32x32x16_bf16 v[120:135], a[0:3], v[96:99], 0
  v_mfma_f32_32x32x16_bf16 v[120:135], a[4:7], v[100:103], v[120:135]
  v_mfma_f32_32x32x16_bf16 v[104:119], a[16:19], v[96:99], v[104:119]
  v_mfma_f32_32x32x16_bf16 v[104:119], a[20:23], v[100:103], v[104:119]
  v_mfma_f32_32x32x16_bf16 v[120:135], a[8:11], v[88:91], v[120:135]
  v_mfma_f32_32x32x16_bf16 v[120:135], a[12:15], v[92:95], v[120:135]
  s_nop 15
  s_cmp_eq_u32 s87, 1
  s_cbranch_scc1 P2_special_w
  v_pk_mul_f32 v[136:137], v[104:105], v[36:37]
  v_pk_mul_f32 v[138:139], v[106:107], v[38:39]
  v_pk_mul_f32 v[140:141], v[108:109], v[40:41]
  v_pk_mul_f32 v[142:143], v[110:111], v[42:43]
  v_pk_mul_f32 v[104:105], v[104:105], v[20:21]
  v_pk_mul_f32 v[106:107], v[106:107], v[22:23]
  v_pk_mul_f32 v[108:109], v[108:109], v[24:25]
  v_pk_mul_f32 v[110:111], v[110:111], v[26:27]
  v_pk_fma_f32 v[104:105], v[120:121], v[36:37], v[104:105] neg_lo:[1,0,0] neg_hi:[1,0,0]
  v_pk_fma_f32 v[106:107], v[122:123], v[38:39], v[106:107] neg_lo:[1,0,0] neg_hi:[1,0,0]
  v_pk_fma_f32 v[108:109], v[124:125], v[40:41], v[108:109] neg_lo:[1,0,0] neg_hi:[1,0,0]
  v_pk_fma_f32 v[110:111], v[126:127], v[42:43], v[110:111] neg_lo:[1,0,0] neg_hi:[1,0,0]
  v_pk_fma_f32 v[120:121], v[120:121], v[20:21], v[136:137]
  v_pk_fma_f32 v[122:123], v[122:123], v[22:23], v[138:139]
  v_pk_fma_f32 v[124:125], v[124:125], v[24:25], v[140:141]
  v_pk_fma_f32 v[126:127], v[126:127], v[26:27], v[142:143]
  v_pk_mul_f32 v[136:137], v[112:113], v[44:45]
  v_pk_mul_f32 v[138:139], v[114:115], v[46:47]
  v_pk_mul_f32 v[140:141], v[116:117], v[48:49]
  v_pk_mul_f32 v[142:143], v[118:119], v[50:51]
  v_pk_mul_f32 v[112:113], v[112:113], v[28:29]
  v_pk_mul_f32 v[114:115], v[114:115], v[30:31]
  v_pk_mul_f32 v[116:117], v[116:117], v[32:33]
  v_pk_mul_f32 v[118:119], v[118:119], v[34:35]
  v_pk_fma_f32 v[112:113], v[128:129], v[44:45], v[112:113]
  v_pk_fma_f32 v[114:115], v[130:131], v[46:47], v[114:115]
  v_pk_fma_f32 v[116:117], v[132:133], v[48:49], v[116:117]
  v_pk_fma_f32 v[118:119], v[134:135], v[50:51], v[118:119]
  v_pk_fma_f32 v[128:129], v[128:129], v[28:29], v[136:137] neg_lo:[0,0,1] neg_hi:[0,0,1]
  v_pk_fma_f32 v[130:131], v[130:131], v[30:31], v[138:139] neg_lo:[0,0,1] neg_hi:[0,0,1]
  v_pk_fma_f32 v[132:133], v[132:133], v[32:33], v[140:141] neg_lo:[0,0,1] neg_hi:[0,0,1]
  v_pk_fma_f32 v[134:135], v[134:135], v[34:35], v[142:143] neg_lo:[0,0,1] neg_hi:[0,0,1]
P2_w_done:
  v_cvt_pk_bf16_f32 v88, v104, v105
  v_cvt_pk_bf16_f32 v96, v120, v121
  v_cvt_pk_bf16_f32 v89, v106, v107
  v_cvt_pk_bf16_f32 v97, v122, v123
  v_cvt_pk_bf16_f32 v90, v108, v109
  v_cvt_pk_bf16_f32 v98, v124, v125
  v_cvt_pk_bf16_f32 v91, v110, v111
  v_cvt_pk_bf16_f32 v99, v126, v127
  v_cvt_pk_bf16_f32 v92, v112, v113
  v_cvt_pk_bf16_f32 v100, v128, v129
  v_cvt_pk_bf16_f32 v93, v114, v115
  v_cvt_pk_bf16_f32 v101, v130, v131
  v_cvt_pk_bf16_f32 v94, v116, v117
  v_cvt_pk_bf16_f32 v102, v132, v133
  v_cvt_pk_bf16_f32 v95, v118, v119
  v_cvt_pk_bf16_f32 v103, v134, v135
  s_nop 1
  v_mfma_f32_32x32x16_bf16 v[104:119], v[88:91], a[0:3], 0
  v_mfma_f32_32x32x16_bf16 v[104:119], v[92:95], a[4:7], v[104:119]
  v_mfma_f32_32x32x16_bf16 v[120:135], v[96:99], a[0:3], 0
  v_mfma_f32_32x32x16_bf16 v[120:135], v[100:103], a[4:7], v[120:135]
  v_mfma_f32_32x32x16_bf16 v[104:119], v[96:99], a[8:11], v[104:119]
  v_mfma_f32_32x32x16_bf16 v[104:119], v[100:103], a[12:15], v[104:119]
  v_mfma_f32_32x32x16_bf16 v[120:135], v[88:91], a[16:19], v[120:135]
  v_mfma_f32_32x32x16_bf16 v[120:135], v[92:95], a[20:23], v[120:135]
  s_nop 15
  v_pk_mul_f32 v[136:137], v[104:105], v[72:73]
  v_pk_mul_f32 v[138:139], v[106:107], v[74:75]
  v_pk_mul_f32 v[140:141], v[108:109], v[76:77]
  v_pk_mul_f32 v[142:143], v[110:111], v[78:79]
  v_pk_mul_f32 v[104:105], v[104:105], v[56:57]
  v_pk_mul_f32 v[106:107], v[106:107], v[58:59]
  v_pk_mul_f32 v[108:109], v[108:109], v[60:61]
  v_pk_mul_f32 v[110:111], v[110:111], v[62:63]
  v_pk_fma_f32 v[104:105], v[120:121], v[72:73], v[104:105]
  v_pk_fma_f32 v[106:107], v[122:123], v[74:75], v[106:107]
  v_pk_fma_f32 v[108:109], v[124:125], v[76:77], v[108:109]
  v_pk_fma_f32 v[110:111], v[126:127], v[78:79], v[110:111]
  v_pk_fma_f32 v[120:121], v[120:121], v[56:57], v[136:137] neg_lo:[0,0,1] neg_hi:[0,0,1]
  v_pk_fma_f32 v[122:123], v[122:123], v[58:59], v[138:139] neg_lo:[0,0,1] neg_hi:[0,0,1]
  v_pk_fma_f32 v[124:125], v[124:125], v[60:61], v[140:141] neg_lo:[0,0,1] neg_hi:[0,0,1]
  v_pk_fma_f32 v[126:127], v[126:127], v[62:63], v[142:143] neg_lo:[0,0,1] neg_hi:[0,0,1]
  v_pk_mul_f32 v[136:137], v[112:113], v[80:81]
  v_pk_mul_f32 v[138:139], v[114:115], v[82:83]
  v_pk_mul_f32 v[140:141], v[116:117], v[84:85]
  v_pk_mul_f32 v[142:143], v[118:119], v[86:87]
  v_pk_mul_f32 v[112:113], v[112:113], v[64:65]
  v_pk_mul_f32 v[114:115], v[114:115], v[66:67]
  v_pk_mul_f32 v[116:117], v[116:117], v[68:69]
  v_pk_mul_f32 v[118:119], v[118:119], v[70:71]
  v_pk_fma_f32 v[112:113], v[128:129], v[80:81], v[112:113]
  v_pk_fma_f32 v[114:115], v[130:131], v[82:83], v[114:115]
  v_pk_fma_f32 v[116:117], v[132:133], v[84:85], v[116:117]
  v_pk_fma_f32 v[118:119], v[134:135], v[86:87], v[118:119]
  v_pk_fma_f32 v[128:129], v[128:129], v[64:65], v[136:137] neg_lo:[0,0,1] neg_hi:[0,0,1]
  v_pk_fma_f32 v[130:131], v[130:131], v[66:67], v[138:139] neg_lo:[0,0,1] neg_hi:[0,0,1]
  v_pk_fma_f32 v[132:133], v[132:133], v[68:69], v[140:141] neg_lo:[0,0,1] neg_hi:[0,0,1]
  v_pk_fma_f32 v[134:135], v[134:135], v[70:71], v[142:143] neg_lo:[0,0,1] neg_hi:[0,0,1]
  v_cvt_pk_bf16_f32 v88, v104, v105
  v_cvt_pk_bf16_f32 v96, v120, v121
  v_cvt_pk_bf16_f32 v89, v106, v107
  v_cvt_pk_bf16_f32 v97, v122, v123
  v_cvt_pk_bf16_f32 v90, v108, v109
  v_cvt_pk_bf16_f32 v98, v124, v125
  v_cvt_pk_bf16_f32 v91, v110, v111
  v_cvt_pk_bf16_f32 v99, v126, v127
  v_cvt_pk_bf16_f32 v92, v112, v113
  v_cvt_pk_bf16_f32 v100, v128, v129
  v_cvt_pk_bf16_f32 v93, v114, v115
  v_cvt_pk_bf16_f32 v101, v130, v131
  v_cvt_pk_bf16_f32 v94, v116, v117
  v_cvt_pk_bf16_f32 v102, v132, v133
  v_cvt_pk_bf16_f32 v95, v118, v119
  v_cvt_pk_bf16_f32 v103, v134, v135
  s_nop 1
  v_mfma_f32_32x32x16_bf16 v[104:119], v[88:91], a[0:3], 0
  v_mfma_f32_32x32x16_bf16 v[104:119], v[92:95], a[4:7], v[104:119]
  v_mfma_f32_32x32x16_bf16 v[120:135], v[96:99], a[0:3], 0
  v_mfma_f32_32x32x16_bf16 v[120:135], v[100:103], a[4:7], v[120:135]
  v_mfma_f32_32x32x16_bf16 v[104:119], v[96:99], a[8:11], v[104:119]
  v_mfma_f32_32x32x16_bf16 v[104:119], v[100:103], a[12:15], v[104:119]
  v_mfma_f32_32x32x16_bf16 v[120:135], v[88:91], a[16:19], v[120:135]
  v_mfma_f32_32x32x16_bf16 v[120:135], v[92:95], a[20:23], v[120:135]
  s_nop 15
  v_and_b32 v136, 31, v0
  v_lshrrev_b32 v137, 5, v0
  v_and_b32 v138, 7, v136
  v_xor_b32 v138, v138, v137
  v_lshlrev_b32 v138, 4, v138
  v_lshl_add_u32 v138, v136, 7, v138
  s_and_b32 s37, s31, 1
  s_lshl_b32 s37, s37, 13
  s_lshr_b32 s35, s31, 1
  s_lshl_b32 s35, s35, 15
  s_add_u32 s37, s37, s35
  s_add_u32 s37, s37, 65536
  v_add_u32 v138, s37, v138
  v_xor_b32 v139, 0, v138
  v_xor_b32 v140, 32, v138
  v_xor_b32 v141, 64, v138
  v_xor_b32 v142, 96, v138
  ds_write_b128 v139, v[104:107]
  ds_write_b128 v139, v[120:123] offset:4096
  ds_write_b128 v140, v[108:111]
  ds_write_b128 v140, v[124:127] offset:4096
  ds_write_b128 v141, v[112:115]
  ds_write_b128 v141, v[128:131] offset:4096
  ds_write_b128 v142, v[116:119]
  ds_write_b128 v142, v[132:135] offset:4096
  s_mov_b32 s86, 0x35800000
  s_mul_i32 s35, s0, 1
  s_and_b32 s35, s35, 2047
  v_cvt_f32_u32 v146, s35
  v_mul_f32 v146, 0x3a000000, v146
  v_add_f32 v147, 0xbe800000, v146
  s_mul_i32 s35, s0, 2
  s_and_b32 s35, s35, 2047
  v_cvt_f32_u32 v148, s35
  v_mul_f32 v148, 0x3a000000, v148
  v_add_f32 v149, 0xbe800000, v148
  s_mul_i32 s35, s0, 3
  s_and_b32 s35, s35, 2047
  v_cvt_f32_u32 v150, s35
  v_mul_f32 v150, 0x3a000000, v150
  v_add_f32 v151, 0xbe800000, v150
  v_cos_f32 v146, v146
  v_cos_f32 v147, v147
  v_cos_f32 v148, v148
  v_cos_f32 v149, v149
  v_cos_f32 v150, v150
  v_cos_f32 v151, v151
  s_nop 0
  v_mul_f32 v146, s86, v146
  v_mul_f32 v147, s86, v147
  v_mul_f32 v148, s86, v148
  v_mul_f32 v149, s86, v149
  v_mul_f32 v150, s86, v150
  v_mul_f32 v151, s86, v151
  s_add_u32 s16, s6, 25231360
  s_addc_u32 s17, s7, 0
  s_mov_b32 s18, 0xa000
  s_mov_b32 s19, 0x20000
  s_lshl_b32 s35, s24, 4
  s_add_u32 s35, s35, s22
  s_lshl_b32 s35, s35, 7
  v_lshlrev_b32 v13, 2, v0
  s_mov_b32 s49, 0
P3_pollh:
  buffer_load_dword v14, v13, s[16:19], s35 offen sc1
  s_waitcnt vmcnt(0)
  v_cmp_ne_u32 vcc, s1, v14
  s_nop 1
  s_and_b32 vcc_lo, vcc_lo, 0xff
  s_mov_b32 vcc_hi, 0
  s_cmp_eq_u64 vcc, 0
  s_cbranch_scc1 P3_pollh_ok
  s_add_u32 s49, s49, 1
  s_cmp_lt_u32 s49, 1048576
  s_cbranch_scc0 P3_pollh_ok
  s_sleep 1
  s_branch P3_pollh
P3_pollh_ok:
  s_add_u32 s84, s46, s76
  s_mov_b32 m0, s52
  s_nop 0
  buffer_load_dwordx4 v2, s[12:15], s84 offen offset:0 sc1 lds
  buffer_load_dwordx4 v2, s[12:15], s84 offen offset:1024 sc1 lds
  buffer_load_dwordx4 v2, s[12:15], s84 offen offset:2048 sc1 lds
  buffer_load_dwordx4 v2, s[12:15], s84 offen offset:3072 sc1 lds
  s_add_u32 s84, s46, s77
  s_mov_b32 m0, s54
  s_nop 0
  buffer_load_dwordx4 v2, s[12:15], s84 offen offset:0 sc1 lds
  buffer_load_dwordx4 v2, s[12:15], s84 offen offset:1024 sc1 lds
  buffer_load_dwordx4 v2, s[12:15], s84 offen offset:2048 sc1 lds
  buffer_load_dwordx4 v2, s[12:15], s84 offen offset:3072 sc1 lds
  s_waitcnt lgkmcnt(0)
  v_mov_b32 v136, 163584
  v_mov_b32 v137, 1
  s_mov_b64 exec, 1
  ds_add_u32 v136, v137
  s_mov_b64 exec, -1
  s_mov_b32 s49, 0
PB_2:
  ds_read_b32 v138, v136
  s_waitcnt lgkmcnt(0)
  v_readfirstlane_b32 s48, v138
  s_cmp_ge_u32 s48, 8
  s_cbranch_scc1 PB_2_ok
  s_add_u32 s49, s49, 1
  s_cmp_lt_u32 s49, 1048576
  s_cbranch_scc1 PB_2
PB_2_ok:
  v_lshrrev_b32 v136, 3, v0
  v_and_b32 v137, 7, v0
  v_xor_b32 v137, v137, v136
  v_lshlrev_b32 v137, 4, v137
  v_lshl_add_u32 v137, v136, 7, v137
  s_lshl_b32 s35, s31, 10
  s_add_u32 s35, s35, 65536
  v_add_u32 v137, s35, v137
  ds_read_b128 v[104:107], v137 offset:0
  ds_read_b128 v[108:111], v137 offset:4096
  ds_read_b128 v[112:115], v137 offset:8192
  ds_read_b128 v[116:119], v137 offset:12288
  ds_read_b128 v[120:123], v137 offset:32768
  ds_read_b128 v[124:127], v137 offset:36864
  ds_read_b128 v[128:131], v137 offset:40960
  ds_read_b128 v[132:135], v137 offset:45056
  v_lshlrev_b32 v138, 3, v0
  s_waitcnt lgkmcnt(0)
  s_mov_b32 s87, s86
  v_pk_add_f32 v[152:153], v[104:105], v[120:121]
  v_pk_add_f32 v[154:155], v[108:109], v[124:125]
  v_pk_add_f32 v[156:157], v[104:105], v[120:121] neg_lo:[0,1] neg_hi:[0,1]
  v_pk_add_f32 v[158:159], v[108:109], v[124:125] neg_lo:[0,1] neg_hi:[0,1]
  v_pk_add_f32 v[140:141], v[112:113], v[128:129]
  v_pk_add_f32 v[142:143], v[116:117], v[132:133]
  v_pk_add_f32 v[20:21], v[152:153], v[140:141]
  v_pk_add_f32 v[24:25], v[154:155], v[142:143]
  v_pk_mul_f32 v[20:21], v[20:21], s[86:87]
  v_pk_mul_f32 v[24:25], v[24:25], s[86:87]
  v_pk_add_f32 v[152:153], v[152:153], v[140:141] neg_lo:[0,1] neg_hi:[0,1]
  v_pk_add_f32 v[154:155], v[154:155], v[142:143] neg_lo:[0,1] neg_hi:[0,1]
  v_pk_mul_f32 v[36:37], v[152:153], v[148:149] op_sel_hi:[1,0]
  v_pk_mul_f32 v[40:41], v[154:155], v[148:149] op_sel_hi:[1,0]
  v_pk_fma_f32 v[36:37], v[154:155], v[148:149], v[36:37] op_sel:[0,1,0] op_sel_hi:[1,1,1] neg_lo:[1,0,0] neg_hi:[1,0,0]
  v_pk_fma_f32 v[40:41], v[152:153], v[148:149], v[40:41] op_sel:[0,1,0] op_sel_hi:[1,1,1]
  v_pk_add_f32 v[144:145], v[112:113], v[128:129] neg_lo:[0,1] neg_hi:[0,1]
  v_pk_add_f32 v[152:153], v[116:117], v[132:133] neg_lo:[0,1] neg_hi:[0,1]
  v_pk_add_f32 v[140:141], v[156:157], v[152:153] neg_lo:[0,1] neg_hi:[0,1]
  v_pk_add_f32 v[142:143], v[158:159], v[144:145]
  v_pk_mul_f32 v[28:29], v[140:141], v[146:147] op_sel_hi:[1,0]
  v_pk_mul_f32 v[32:33], v[142:143], v[146:147] op_sel_hi:[1,0]
  v_pk_fma_f32 v[28:29], v[142:143], v[146:147], v[28:29] op_sel:[0,1,0] op_sel_hi:[1,1,1] neg_lo:[1,0,0] neg_hi:[1,0,0]
  v_pk_fma_f32 v[32:33], v[140:141], v[146:147], v[32:33] op_sel:[0,1,0] op_sel_hi:[1,1,1]
  v_pk_add_f32 v[140:141], v[156:157], v[152:153]
  v_pk_add_f32 v[142:143], v[158:159], v[144:145] neg_lo:[0,1] neg_hi:[0,1]
  v_pk_mul_f32 v[44:45], v[140:141], v[150:151] op_sel_hi:[1,0]
  v_pk_mul_f32 v[48:49], v[142:143], v[150:151] op_sel_hi:[1,0]
  v_pk_fma_f32 v[44:45], v[142:143], v[150:151], v[44:45] op_sel:[0,1,0] op_sel_hi:[1,1,1] neg_lo:[1,0,0] neg_hi:[1,0,0]
  v_pk_fma_f32 v[48:49], v[140:141], v[150:151], v[48:49] op_sel:[0,1,0] op_sel_hi:[1,1,1]
  v_pk_add_f32 v[152:153], v[106:107], v[122:123]
  v_pk_add_f32 v[154:155], v[110:111], v[126:127]
  v_pk_add_f32 v[156:157], v[106:107], v[122:123] neg_lo:[0,1] neg_hi:[0,1]
  v_pk_add_f32 v[158:159], v[110:111], v[126:127] neg_lo:[0,1] neg_hi:[0,1]
  v_pk_add_f32 v[140:141], v[114:115], v[130:131]
  v_pk_add_f32 v[142:143], v[118:119], v[134:135]
  v_pk_add_f32 v[22:23], v[152:153], v[140:141]
  v_pk_add_f32 v[26:27], v[154:155], v[142:143]
  v_pk_mul_f32 v[22:23], v[22:23], s[86:87]
  v_pk_mul_f32 v[26:27], v[26:27], s[86:87]
  v_pk_add_f32 v[152:153], v[152:153], v[140:141] neg_lo:[0,1] neg_hi:[0,1]
  v_pk_add_f32 v[154:155], v[154:155], v[142:143] neg_lo:[0,1] neg_hi:[0,1]
  v_pk_mul_f32 v[38:39], v[152:153], v[148:149] op_sel_hi:[1,0]
  v_pk_mul_f32 v[42:43], v[154:155], v[148:149] op_sel_hi:[1,0]
  v_pk_fma_f32 v[38:39], v[154:155], v[148:149], v[38:39] op_sel:[0,1,0] op_sel_hi:[1,1,1] neg_lo:[1,0,0] neg_hi:[1,0,0]
  v_pk_fma_f32 v[42:43], v[152:153], v[148:149], v[42:43] op_sel:[0,1,0] op_sel_hi:[1,1,1]
  v_pk_add_f32 v[144:145], v[114:115], v[130:131] neg_lo:[0,1] neg_hi:[0,1]
  v_pk_add_f32 v[152:153], v[118:119], v[134:135] neg_lo:[0,1] neg_hi:[0,1]
  v_pk_add_f32 v[140:141], v[156:157], v[152:153] neg_lo:[0,1] neg_hi:[0,1]
  v_pk_add_f32 v[142:143], v[158:159], v[144:145]
  v_pk_mul_f32 v[30:31], v[140:141], v[146:147] op_sel_hi:[1,0]
  v_pk_mul_f32 v[34:35], v[142:143], v[146:147] op_sel_hi:[1,0]
  v_pk_fma_f32 v[30:31], v[142:143], v[146:147], v[30:31] op_sel:[0,1,0] op_sel_hi:[1,1,1] neg_lo:[1,0,0] neg_hi:[1,0,0]
  v_pk_fma_f32 v[34:35], v[140:141], v[146:147], v[34:35] op_sel:[0,1,0] op_sel_hi:[1,1,1]
  v_pk_add_f32 v[140:141], v[156:157], v[152:153]
  v_pk_add_f32 v[142:143], v[158:159], v[144:145] neg_lo:[0,1] neg_hi:[0,1]
  v_pk_mul_f32 v[46:47], v[140:141], v[150:151] op_sel_hi:[1,0]
  v_pk_mul_f32 v[50:51], v[142:143], v[150:151] op_sel_hi:[1,0]
  v_pk_fma_f32 v[46:47], v[142:143], v[150:151], v[46:47] op_sel:[0,1,0] op_sel_hi:[1,1,1] neg_lo:[1,0,0] neg_hi:[1,0,0]
  v_pk_fma_f32 v[50:51], v[140:141], v[150:151], v[50:51] op_sel:[0,1,0] op_sel_hi:[1,1,1]
  s_cmp_eq_u32 s0, 0
  s_cbranch_scc0 P2_fin_generic
  s_mov_b32 s86, 0x35000000
  s_mov_b32 s37, 0x35800000
  s_mov_b32 s38, 0x353504f3
  v_add_f32 v152, v104, v108
  v_sub_f32 v153, v104, v108
  v_mul_f32 v152, s86, v152
  v_mul_f32 v153, s86, v153
  v_fma_f32 v20, v112, s37, v152
  v_fma_f32 v28, -v116, s37, v153
  v_fma_f32 v36, -v112, s37, v152
  v_fma_f32 v44, v116, s37, v153
  v_add_f32 v152, v120, v128
  v_mul_f32 v24, s37, v152
  v_sub_f32 v152, v120, v124
  v_sub_f32 v152, v152, v128
  v_sub_f32 v152, v152, v132
  v_mul_f32 v32, s38, v152
  v_sub_f32 v152, v132, v124
  v_mul_f32 v40, s37, v152
  v_sub_f32 v152, v128, v132
  v_sub_f32 v152, v152, v120
  v_sub_f32 v152, v152, v124
  v_mul_f32 v48, s38, v152
  v_add_f32 v152, v105, v109
  v_sub_f32 v153, v105, v109
  v_mul_f32 v152, s86, v152
  v_mul_f32 v153, s86, v153
  v_fma_f32 v21, v113, s37, v152
  v_fma_f32 v29, -v117, s37, v153
  v_fma_f32 v37, -v113, s37, v152
  v_fma_f32 v45, v117, s37, v153
  v_add_f32 v152, v121, v129
  v_mul_f32 v25, s37, v152
  v_sub_f32 v152, v121, v125
  v_sub_f32 v152, v152, v129
  v_sub_f32 v152, v152, v133
  v_mul_f32 v33, s38, v152
  v_sub_f32 v152, v133, v125
  v_mul_f32 v41, s37, v152
  v_sub_f32 v152, v129, v133
  v_sub_f32 v152, v152, v121
  v_sub_f32 v152, v152, v125
  v_mul_f32 v49, s38, v152
  v_add_f32 v152, v106, v110
  v_sub_f32 v153, v106, v110
  v_mul_f32 v152, s86, v152
  v_mul_f32 v153, s86, v153
  v_fma_f32 v22, v114, s37, v152
  v_fma_f32 v30, -v118, s37, v153
  v_fma_f32 v38, -v114, s37, v152
  v_fma_f32 v46, v118, s37, v153
  v_add_f32 v152, v122, v130
  v_mul_f32 v26, s37, v152
  v_sub_f32 v152, v122, v126
  v_sub_f32 v152, v152, v130
  v_sub_f32 v152, v152, v134
  v_mul_f32 v34, s38, v152
  v_sub_f32 v152, v134, v126
  v_mul_f32 v42, s37, v152
  v_sub_f32 v152, v130, v134
  v_sub_f32 v152, v152, v122
  v_sub_f32 v152, v152, v126
  v_mul_f32 v50, s38, v152
  v_add_f32 v152, v107, v111
  v_sub_f32 v153, v107, v111
  v_mul_f32 v152, s86, v152
  v_mul_f32 v153, s86, v153
  v_fma_f32 v23, v115, s37, v152
  v_fma_f32 v31, -v119, s37, v153
  v_fma_f32 v39, -v115, s37, v152
  v_fma_f32 v47, v119, s37, v153
  v_add_f32 v152, v123, v131
  v_mul_f32 v27, s37, v152
  v_sub_f32 v152, v123, v127
  v_sub_f32 v152, v152, v131
  v_sub_f32 v152, v152, v135
  v_mul_f32 v35, s38, v152
  v_sub_f32 v152, v135, v127
  v_mul_f32 v43, s37, v152
  v_sub_f32 v152, v131, v135
  v_sub_f32 v152, v152, v123
  v_sub_f32 v152, v152, v127
  v_mul_f32 v51, s38, v152
P2_fin_generic:
  v_cvt_pk_bf16_f32 v20, v20, v21
  v_cvt_pk_bf16_f32 v21, v22, v23
  v_cvt_pk_bf16_f32 v24, v24, v25
  v_cvt_pk_bf16_f32 v25, v26, v27
  v_cvt_pk_bf16_f32 v28, v28, v29
  v_cvt_pk_bf16_f32 v29, v30, v31
  v_cvt_pk_bf16_f32 v32, v32, v33
  v_cvt_pk_bf16_f32 v33, v34, v35
  v_cvt_pk_bf16_f32 v36, v36, v37
  v_cvt_pk_bf16_f32 v37, v38, v39
  v_cvt_pk_bf16_f32 v40, v40, v41
  v_cvt_pk_bf16_f32 v41, v42, v43
  v_cvt_pk_bf16_f32 v44, v44, v45
  v_cvt_pk_bf16_f32 v45, v46, v47
  v_cvt_pk_bf16_f32 v48, v48, v49
  v_cvt_pk_bf16_f32 v49, v50, v51
  s_lshl_b32 s37, s31, 9
  s_add_u32 s37, s37, 131072
  v_add_u32 v139, s37, v138
  ds_write_b64 v139, v[20:21] offset:0
  ds_write_b64 v139, v[24:25] offset:2048
  ds_write_b64 v139, v[28:29] offset:4096
  ds_write_b64 v139, v[32:33] offset:6144
  ds_write_b64 v139, v[36:37] offset:8192
  ds_write_b64 v139, v[40:41] offset:10240
  ds_write_b64 v139, v[44:45] offset:12288
  ds_write_b64 v139, v[48:49] offset:14336
  s_waitcnt vmcnt(4) lgkmcnt(0)
  s_barrier
  s_add_u32 s84, s46, s78
  s_mov_b32 m0, s56
  s_nop 0
  buffer_load_dwordx4 v2, s[12:15], s84 offen offset:0 sc1 lds
  buffer_load_dwordx4 v2, s[12:15], s84 offen offset:1024 sc1 lds
  buffer_load_dwordx4 v2, s[12:15], s84 offen offset:2048 sc1 lds
  buffer_load_dwordx4 v2, s[12:15], s84 offen offset:3072 sc1 lds
  s_add_u32 s84, s46, s79
  s_mov_b32 m0, s58
  s_nop 0
  buffer_load_dwordx4 v2, s[12:15], s84 offen offset:0 sc1 lds
  buffer_load_dwordx4 v2, s[12:15], s84 offen offset:1024 sc1 lds
  buffer_load_dwordx4 v2, s[12:15], s84 offen offset:2048 sc1 lds
  buffer_load_dwordx4 v2, s[12:15], s84 offen offset:3072 sc1 lds
  s_waitcnt vmcnt(8)
  s_barrier
  s_setprio 0
  s_add_u32 s46, s46, 65536
  s_add_u32 s47, s47, 524288
  s_add_u32 s50, s50, 1
  s_cmp_eq_u32 s50, 7
  s_cselect_b32 s45, 458752, 0
  s_sub_u32 s46, s46, s45
  s_cmp_eq_u32 s50, 7
  s_cselect_b32 s45, 3670016, 0
  s_sub_u32 s47, s47, s45
  s_cmp_eq_u32 s50, 7
  s_cselect_b32 s50, 0, s50
  s_add_u32 s84, s46, s76
  s_mov_b32 m0, s52
  s_nop 0
  buffer_load_dwordx4 v2, s[12:15], s84 offen offset:0 sc1 lds
  v_mov_b32 v106, v0
  s_lshr_b32 s35, s31, 1
  s_lshl_b32 s35, s35, 2
  buffer_load_dwordx4 v2, s[12:15], s84 offen offset:1024 sc1 lds
  s_lshl_b32 s39, s23, 1
  s_add_u32 s35, s35, s39
  s_and_b32 s39, s31, 1
  buffer_load_dwordx4 v2, s[12:15], s84 offen offset:2048 sc1 lds
  s_add_u32 s35, s35, s39
  s_lshl_b32 s35, s35, 6
  s_lshr_b32 s39, s24, 2
  buffer_load_dwordx4 v2, s[12:15], s84 offen offset:3072 sc1 lds
  s_add_u32 s35, s35, s39
  v_and_b32 v112, 15, v106
  v_lshlrev_b32 v112, 2, v112
  s_add_u32 s85, s47, s80
  s_mov_b32 m0, s53
  s_nop 0
  buffer_load_dwordx4 v4, s[60:63], s85 offen offset:0 lds
  v_add_u32 v112, s35, v112
  v_cvt_f32_u32 v112, v112
  v_mul_f32 v112, 0x3b000000, v112
  buffer_load_dwordx4 v5, s[60:63], s85 offen offset:1024 lds
  v_lshrrev_b32 v113, 4, v106
  v_lshlrev_b32 v113, 1, v113
  v_cvt_f32_u32 v113, v113
  buffer_load_dwordx4 v6, s[60:63], s85 offen offset:2048 lds
  v_mul_f32 v113, v113, v112
  v_add_f32 v114, 0x3e800000, v113
  v_fmamk_f32 v116, v112, 0x00000000, v113
  buffer_load_dwordx4 v7, s[60:63], s85 offen offset:3072 lds
  v_fmamk_f32 v117, v112, 0x00000000, v114
  v_fmamk_f32 v118, v112, 0x3f800000, v113
  v_fmamk_f32 v119, v112, 0x3f800000, v114
  s_waitcnt vmcnt(12)
  s_barrier
  s_add_u32 s84, s46, s77
  s_mov_b32 m0, s54
  s_nop 0
  buffer_load_dwordx4 v2, s[12:15], s84 offen offset:0 sc1 lds
  v_fmamk_f32 v120, v112, 0x41000000, v113
  v_fmamk_f32 v121, v112, 0x41000000, v114
  v_fmamk_f32 v122, v112, 0x41100000, v113
  buffer_load_dwordx4 v2, s[12:15], s84 offen offset:1024 sc1 lds
  v_fmamk_f32 v123, v112, 0x41100000, v114
  v_cmp_gt_u32 vcc, 16, v106
  v_mul_f32 v115, 0x43800000, v112
  buffer_load_dwordx4 v2, s[12:15], s84 offen offset:2048 sc1 lds
  s_nop 0
  v_cndmask_b32 v117, v117, v115, vcc
  v_fract_f32 v116, v116
  buffer_load_dwordx4 v2, s[12:15], s84 offen offset:3072 sc1 lds
  v_fract_f32 v117, v117
  v_fract_f32 v118, v118
  v_fract_f32 v119, v119
  s_add_u32 s85, s47, s81
  s_mov_b32 m0, s55
  s_nop 0
  buffer_load_dwordx4 v4, s[60:63], s85 offen offset:0 lds
  v_fract_f32 v120, v120
  v_fract_f32 v121, v121
  v_fract_f32 v122, v122
  buffer_load_dwordx4 v5, s[60:63], s85 offen offset:1024 lds
  v_fract_f32 v123, v123
  v_cos_f32 v116, v116
  v_cos_f32 v117, v117
  buffer_load_dwordx4 v6, s[60:63], s85 offen offset:2048 lds
  v_cos_f32 v118, v118
  v_cos_f32 v119, v119
  v_cos_f32 v120, v120
  buffer_load_dwordx4 v7, s[60:63], s85 offen offset:3072 lds
  v_cos_f32 v121, v121
  v_cos_f32 v122, v122
  v_cos_f32 v123, v123
  s_waitcnt vmcnt(16)
  s_barrier
  s_add_u32 s84, s46, s78
  s_mov_b32 m0, s56
  s_nop 0
  buffer_load_dwordx4 v2, s[12:15], s84 offen offset:0 sc1 lds
  s_nop 0
  v_cvt_pk_bf16_f32 v32, v116, v117
  v_cvt_pk_bf16_f32 v33, v118, v119
  buffer_load_dwordx4 v2, s[12:15], s84 offen offset:1024 sc1 lds
  v_cvt_pk_bf16_f32 v34, v120, v121
  v_cvt_pk_bf16_f32 v35, v122, v123
  v_fmamk_f32 v116, v112, 0x41800000, v113
  buffer_load_dwordx4 v2, s[12:15], s84 offen offset:2048 sc1 lds
  v_fmamk_f32 v117, v112, 0x41800000, v114
  v_fmamk_f32 v118, v112, 0x41880000, v113
  v_fmamk_f32 v119, v112, 0x41880000, v114
  buffer_load_dwordx4 v2, s[12:15], s84 offen offset:3072 sc1 lds
  v_fmamk_f32 v120, v112, 0x41c00000, v113
  v_fmamk_f32 v121, v112, 0x41c00000, v114
  v_fmamk_f32 v122, v112, 0x41c80000, v113
  s_add_u32 s85, s47, s82
  s_mov_b32 m0, s57
  s_nop 0
  buffer_load_dwordx4 v4, s[60:63], s85 offen offset:0 lds
  v_fmamk_f32 v123, v112, 0x41c80000, v114
  v_fract_f32 v116, v116
  v_fract_f32 v117, v117
  buffer_load_dwordx4 v5, s[60:63], s85 offen offset:1024 lds
  v_fract_f32 v118, v118
  v_fract_f32 v119, v119
  v_fract_f32 v120, v120
  buffer_load_dwordx4 v6, s[60:63], s85 offen offset:2048 lds
  v_fract_f32 v121, v121
  v_fract_f32 v122, v122
  v_fract_f32 v123, v123
  buffer_load_dwordx4 v7, s[60:63], s85 offen offset:3072 lds
  v_cos_f32 v116, v116
  v_cos_f32 v117, v117
  v_cos_f32 v118, v118
  s_waitcnt vmcnt(16)
  s_barrier
  s_add_u32 s84, s46, s79
  s_mov_b32 m0, s58
  s_nop 0
  buffer_load_dwordx4 v2, s[12:15], s84 offen offset:0 sc1 lds
  v_cos_f32 v119, v119
  v_cos_f32 v120, v120
  v_cos_f32 v121, v121
  buffer_load_dwordx4 v2, s[12:15], s84 offen offset:1024 sc1 lds
  v_cos_f32 v122, v122
  v_cos_f32 v123, v123
  s_nop 0
  buffer_load_dwordx4 v2, s[12:15], s84 offen offset:2048 sc1 lds
  v_cvt_pk_bf16_f32 v36, v116, v117
  v_cvt_pk_bf16_f32 v37, v118, v119
  v_cvt_pk_bf16_f32 v38, v120, v121
  buffer_load_dwordx4 v2, s[12:15], s84 offen offset:3072 sc1 lds
  v_cvt_pk_bf16_f32 v39, v122, v123
  v_fmamk_f32 v116, v112, 0x42000000, v113
  v_fmamk_f32 v117, v112, 0x42000000, v114
  s_add_u32 s85, s47, s83
  s_mov_b32 m0, s59
  s_nop 0
  buffer_load_dwordx4 v4, s[60:63], s85 offen offset:0 lds
  v_fmamk_f32 v118, v112, 0x42040000, v113
  v_fmamk_f32 v119, v112, 0x42040000, v114
  v_fmamk_f32 v120, v112, 0x42200000, v113
  buffer_load_dwordx4 v5, s[60:63], s85 offen offset:1024 lds
  v_fmamk_f32 v121, v112, 0x42200000, v114
  v_fmamk_f32 v122, v112, 0x42240000, v113
  v_fmamk_f32 v123, v112, 0x42240000, v114
  buffer_load_dwordx4 v6, s[60:63], s85 offen offset:2048 lds
  v_fract_f32 v116, v116
  v_fract_f32 v117, v117
  v_fract_f32 v118, v118
  buffer_load_dwordx4 v7, s[60:63], s85 offen offset:3072 lds
  v_fract_f32 v119, v119
  v_fract_f32 v120, v120
  v_fract_f32 v121, v121
  s_waitcnt vmcnt(16)
  s_barrier
  s_add_u32 s46, s46, 65536
  s_add_u32 s47, s47, 524288
  s_add_u32 s50, s50, 1
  s_cmp_eq_u32 s50, 7
  s_cselect_b32 s45, 458752, 0
  s_sub_u32 s46, s46, s45
  s_cmp_eq_u32 s50, 7
  s_cselect_b32 s45, 3670016, 0
  s_sub_u32 s47, s47, s45
  s_cmp_eq_u32 s50, 7
  s_cselect_b32 s50, 0, s50
  s_add_u32 s84, s46, s76
  s_mov_b32 m0, s52
  s_nop 0
  buffer_load_dwordx4 v2, s[12:15], s84 offen offset:0 sc1 lds
  v_fract_f32 v122, v122
  v_fract_f32 v123, v123
  v_cos_f32 v116, v116
  buffer_load_dwordx4 v2, s[12:15], s84 offen offset:1024 sc1 lds
  v_cos_f32 v117, v117
  v_cos_f32 v118, v118
  v_cos_f32 v119, v119
  buffer_load_dwordx4 v2, s[12:15], s84 offen offset:2048 sc1 lds
  v_cos_f32 v120, v120
  v_cos_f32 v121, v121
  v_cos_f32 v122, v122
  buffer_load_dwordx4 v2, s[12:15], s84 offen offset:3072 sc1 lds
  v_cos_f32 v123, v123
  s_nop 0
  v_cvt_pk_bf16_f32 v40, v116, v117
  s_add_u32 s85, s47, s80
  s_mov_b32 m0, s53
  s_nop 0
  buffer_load_dwordx4 v4, s[60:63], s85 offen offset:0 lds
  v_cvt_pk_bf16_f32 v41, v118, v119
  v_cvt_pk_bf16_f32 v42, v120, v121
  v_cvt_pk_bf16_f32 v43, v122, v123
  buffer_load_dwordx4 v5, s[60:63], s85 offen offset:1024 lds
  v_fmamk_f32 v116, v112, 0x42400000, v113
  v_fmamk_f32 v117, v112, 0x42400000, v114
  v_fmamk_f32 v118, v112, 0x42440000, v113
  buffer_load_dwordx4 v6, s[60:63], s85 offen offset:2048 lds
  v_fmamk_f32 v119, v112, 0x42440000, v114
  v_fmamk_f32 v120, v112, 0x42600000, v113
  v_fmamk_f32 v121, v112, 0x42600000, v114
  buffer_load_dwordx4 v7, s[60:63], s85 offen offset:3072 lds
  v_fmamk_f32 v122, v112, 0x42640000, v113
  v_fmamk_f32 v123, v112, 0x42640000, v114
  v_fract_f32 v116, v116
  s_waitcnt vmcnt(16)
  s_barrier
  s_add_u32 s84, s46, s77
  s_mov_b32 m0, s54
  s_nop 0
  buffer_load_dwordx4 v2, s[12:15], s84 offen offset:0 sc1 lds
  v_fract_f32 v117, v117
  v_fract_f32 v118, v118
  v_fract_f32 v119, v119
  buffer_load_dwordx4 v2, s[12:15], s84 offen offset:1024 sc1 lds
  v_fract_f32 v120, v120
  v_fract_f32 v121, v121
  v_fract_f32 v122, v122
  buffer_load_dwordx4 v2, s[12:15], s84 offen offset:2048 sc1 lds
  v_fract_f32 v123, v123
  v_cos_f32 v116, v116
  v_cos_f32 v117, v117
  buffer_load_dwordx4 v2, s[12:15], s84 offen offset:3072 sc1 lds
  v_cos_f32 v118, v118
  v_cos_f32 v119, v119
  v_cos_f32 v120, v120
  s_add_u32 s85, s47, s81
  s_mov_b32 m0, s55
  s_nop 0
  buffer_load_dwordx4 v4, s[60:63], s85 offen offset:0 lds
  v_cos_f32 v121, v121
  v_cos_f32 v122, v122
  v_cos_f32 v123, v123
  buffer_load_dwordx4 v5, s[60:63], s85 offen offset:1024 lds
  s_nop 0
  v_cvt_pk_bf16_f32 v44, v116, v117
  v_cvt_pk_bf16_f32 v45, v118, v119
  buffer_load_dwordx4 v6, s[60:63], s85 offen offset:2048 lds
  v_cvt_pk_bf16_f32 v46, v120, v121
  v_cvt_pk_bf16_f32 v47, v122, v123
  v_fmamk_f32 v116, v112, 0x42800000, v113
  buffer_load_dwordx4 v7, s[60:63], s85 offen offset:3072 lds
  v_fmamk_f32 v117, v112, 0x42800000, v114
  v_fmamk_f32 v118, v112, 0x42820000, v113
  v_fmamk_f32 v119, v112, 0x42820000, v114
  s_waitcnt vmcnt(16)
  s_barrier
  s_add_u32 s84, s46, s78
  s_mov_b32 m0, s56
  s_nop 0
  buffer_load_dwordx4 v2, s[12:15], s84 offen offset:0 sc1 lds
  v_fmamk_f32 v120, v112, 0x42900000, v113
  v_fmamk_f32 v121, v112, 0x42900000, v114
  v_fmamk_f32 v122, v112, 0x42920000, v113
  buffer_load_dwordx4 v2, s[12:15], s84 offen offset:1024 sc1 lds
  v_fmamk_f32 v123, v112, 0x42920000, v114
  v_fract_f32 v116, v116
  v_fract_f32 v117, v117
  buffer_load_dwordx4 v2, s[12:15], s84 offen offset:2048 sc1 lds
  v_fract_f32 v118, v118
  v_fract_f32 v119, v119
  v_fract_f32 v120, v120
  buffer_load_dwordx4 v2, s[12:15], s84 offen offset:3072 sc1 lds
  v_fract_f32 v121, v121
  v_fract_f32 v122, v122
  v_fract_f32 v123, v123
  s_add_u32 s85, s47, s82
  s_mov_b32 m0, s57
  s_nop 0
  buffer_load_dwordx4 v4, s[60:63], s85 offen offset:0 lds
  v_cos_f32 v116, v116
  v_cos_f32 v117, v117
  v_cos_f32 v118, v118
  buffer_load_dwordx4 v5, s[60:63], s85 offen offset:1024 lds
  v_cos_f32 v119, v119
  v_cos_f32 v120, v120
  v_cos_f32 v121, v121
  buffer_load_dwordx4 v6, s[60:63], s85 offen offset:2048 lds
  v_cos_f32 v122, v122
  v_cos_f32 v123, v123
  s_nop 0
  buffer_load_dwordx4 v7, s[60:63], s85 offen offset:3072 lds
  v_cvt_pk_bf16_f32 v48, v116, v117
  v_cvt_pk_bf16_f32 v49, v118, v119
  v_cvt_pk_bf16_f32 v50, v120, v121
  s_waitcnt vmcnt(16)
  s_barrier
  s_add_u32 s84, s46, s79
  s_mov_b32 m0, s58
  s_nop 0
  buffer_load_dwordx4 v2, s[12:15], s84 offen offset:0 sc1 lds
  v_cvt_pk_bf16_f32 v51, v122, v123
  v_fmamk_f32 v116, v112, 0x42a00000, v113
  v_fmamk_f32 v117, v112, 0x42a00000, v114
  buffer_load_dwordx4 v2, s[12:15], s84 offen offset:1024 sc1 lds
  v_fmamk_f32 v118, v112, 0x42a20000, v113
  v_fmamk_f32 v119, v112, 0x42a20000, v114
  v_fmamk_f32 v120, v112, 0x42b00000, v113
  buffer_load_dwordx4 v2, s[12:15], s84 offen offset:2048 sc1 lds
  v_fmamk_f32 v121, v112, 0x42b00000, v114
  v_fmamk_f32 v122, v112, 0x42b20000, v113
  v_fmamk_f32 v123, v112, 0x42b20000, v114
  buffer_load_dwordx4 v2, s[12:15], s84 offen offset:3072 sc1 lds
  v_fract_f32 v116, v116
  v_fract_f32 v117, v117
  v_fract_f32 v118, v118
  s_add_u32 s85, s47, s83
  s_mov_b32 m0, s59
  s_nop 0
  buffer_load_dwordx4 v4, s[60:63], s85 offen offset:0 lds
  v_fract_f32 v119, v119
  v_fract_f32 v120, v120
  v_fract_f32 v121, v121
  buffer_load_dwordx4 v5, s[60:63], s85 offen offset:1024 lds
  v_fract_f32 v122, v122
  v_fract_f32 v123, v123
  v_cos_f32 v116, v116
  buffer_load_dwordx4 v6, s[60:63], s85 offen offset:2048 lds
  v_cos_f32 v117, v117
  v_cos_f32 v118, v118
  v_cos_f32 v119, v119
  buffer_load_dwordx4 v7, s[60:63], s85 offen offset:3072 lds
  v_cos_f32 v120, v120
  v_cos_f32 v121, v121
  v_cos_f32 v122, v122
  s_waitcnt vmcnt(16)
  s_barrier
  s_add_u32 s46, s46, 65536
  s_add_u32 s47, s47, 524288
  s_add_u32 s50, s50, 1
  s_cmp_eq_u32 s50, 7
  s_cselect_b32 s45, 458752, 0
  s_sub_u32 s46, s46, s45
  s_cmp_eq_u32 s50, 7
  s_cselect_b32 s45, 3670016, 0
  s_sub_u32 s47, s47, s45
  s_cmp_eq_u32 s50, 7
  s_cselect_b32 s50, 0, s50
  s_add_u32 s84, s46, s76
  s_mov_b32 m0, s52
  s_nop 0
  buffer_load_dwordx4 v2, s[12:15], s84 offen offset:0 sc1 lds
  v_cos_f32 v123, v123
  s_nop 0
  v_cvt_pk_bf16_f32 v52, v116, v117
  buffer_load_dwordx4 v2, s[12:15], s84 offen offset:1024 sc1 lds
  v_cvt_pk_bf16_f32 v53, v118, v119
  v_cvt_pk_bf16_f32 v54, v120, v121
  v_cvt_pk_bf16_f32 v55, v122, v123
  buffer_load_dwordx4 v2, s[12:15], s84 offen offset:2048 sc1 lds
  v_fmamk_f32 v116, v112, 0x42c00000, v113
  v_fmamk_f32 v117, v112, 0x42c00000, v114
  v_fmamk_f32 v118, v112, 0x42c20000, v113
  buffer_load_dwordx4 v2, s[12:15], s84 offen offset:3072 sc1 lds
  v_fmamk_f32 v119, v112, 0x42c20000, v114
  v_fmamk_f32 v120, v112, 0x42d00000, v113
  v_fmamk_f32 v121, v112, 0x42d00000, v114
  s_add_u32 s85, s47, s80
  s_mov_b32 m0, s53
  s_nop 0
  buffer_load_dwordx4 v4, s[60:63], s85 offen offset:0 lds
  v_fmamk_f32 v122, v112, 0x42d20000, v113
  v_fmamk_f32 v123, v112, 0x42d20000, v114
  v_fract_f32 v116, v116
  buffer_load_dwordx4 v5, s[60:63], s85 offen offset:1024 lds
  v_fract_f32 v117, v117
  v_fract_f32 v118, v118
  v_fract_f32 v119, v119
  buffer_load_dwordx4 v6, s[60:63], s85 offen offset:2048 lds
  v_fract_f32 v120, v120
  v_fract_f32 v121, v121
  v_fract_f32 v122, v122
  buffer_load_dwordx4 v7, s[60:63], s85 offen offset:3072 lds
  v_fract_f32 v123, v123
  v_cos_f32 v116, v116
  v_cos_f32 v117, v117
  s_waitcnt vmcnt(16)
  s_barrier
  s_add_u32 s84, s46, s77
  s_mov_b32 m0, s54
  s_nop 0
  buffer_load_dwordx4 v2, s[12:15], s84 offen offset:0 sc1 lds
  v_cos_f32 v118, v118
  v_cos_f32 v119, v119
  v_cos_f32 v120, v120
  buffer_load_dwordx4 v2, s[12:15], s84 offen offset:1024 sc1 lds
  v_cos_f32 v121, v121
  v_cos_f32 v122, v122
  v_cos_f32 v123, v123
  buffer_load_dwordx4 v2, s[12:15], s84 offen offset:2048 sc1 lds
  s_nop 0
  v_cvt_pk_bf16_f32 v56, v116, v117
  v_cvt_pk_bf16_f32 v57, v118, v119
  buffer_load_dwordx4 v2, s[12:15], s84 offen offset:3072 sc1 lds
  v_cvt_pk_bf16_f32 v58, v120, v121
  v_cvt_pk_bf16_f32 v59, v122, v123
  v_fmamk_f32 v116, v112, 0x42e00000, v113
  s_add_u32 s85, s47, s81
  s_mov_b32 m0, s55
  s_nop 0
  buffer_load_dwordx4 v4, s[60:63], s85 offen offset:0 lds
  v_fmamk_f32 v117, v112, 0x42e00000, v114
  v_fmamk_f32 v118, v112, 0x42e20000, v113
  v_fmamk_f32 v119, v112, 0x42e20000, v114
  buffer_load_dwordx4 v5, s[60:63], s85 offen offset:1024 lds
  v_fmamk_f32 v120, v112, 0x42f00000, v113
  v_fmamk_f32 v121, v112, 0x42f00000, v114
  v_fmamk_f32 v122, v112, 0x42f20000, v113
  buffer_load_dwordx4 v6, s[60:63], s85 offen offset:2048 lds
  v_fmamk_f32 v123, v112, 0x42f20000, v114
  v_fract_f32 v116, v116
  v_fract_f32 v117, v117
  buffer_load_dwordx4 v7, s[60:63], s85 offen offset:3072 lds
  v_fract_f32 v118, v118
  v_fract_f32 v119, v119
  v_fract_f32 v120, v120
  s_waitcnt vmcnt(16)
  s_barrier
  s_add_u32 s84, s46, s78
  s_mov_b32 m0, s56
  s_nop 0
  buffer_load_dwordx4 v2, s[12:15], s84 offen offset:0 sc1 lds
  v_fract_f32 v121, v121
  v_fract_f32 v122, v122
  v_fract_f32 v123, v123
  buffer_load_dwordx4 v2, s[12:15], s84 offen offset:1024 sc1 lds
  v_cos_f32 v116, v116
  v_cos_f32 v117, v117
  v_cos_f32 v118, v118
  buffer_load_dwordx4 v2, s[12:15], s84 offen offset:2048 sc1 lds
  v_cos_f32 v119, v119
  v_cos_f32 v120, v120
  v_cos_f32 v121, v121
  buffer_load_dwordx4 v2, s[12:15], s84 offen offset:3072 sc1 lds
  v_cos_f32 v122, v122
  v_cos_f32 v123, v123
  s_nop 0
  s_add_u32 s85, s47, s82
  s_mov_b32 m0, s57
  s_nop 0
  buffer_load_dwordx4 v4, s[60:63], s85 offen offset:0 lds
  v_cvt_pk_bf16_f32 v60, v116, v117
  v_cvt_pk_bf16_f32 v61, v118, v119
  v_cvt_pk_bf16_f32 v62, v120, v121
  buffer_load_dwordx4 v5, s[60:63], s85 offen offset:1024 lds
  v_cvt_pk_bf16_f32 v63, v122, v123
  v_fmamk_f32 v116, v112, 0x43000000, v113
  v_fmamk_f32 v117, v112, 0x43000000, v114
  buffer_load_dwordx4 v6, s[60:63], s85 offen offset:2048 lds
  v_fmamk_f32 v118, v112, 0x43010000, v113
  v_fmamk_f32 v119, v112, 0x43010000, v114
  v_fmamk_f32 v120, v112, 0x43080000, v113
  buffer_load_dwordx4 v7, s[60:63], s85 offen offset:3072 lds
  v_fmamk_f32 v121, v112, 0x43080000, v114
  v_fmamk_f32 v122, v112, 0x43090000, v113
  v_fmamk_f32 v123, v112, 0x43090000, v114
  s_waitcnt vmcnt(16)
  s_barrier
  s_add_u32 s84, s46, s79
  s_mov_b32 m0, s58
  s_nop 0
  buffer_load_dwordx4 v2, s[12:15], s84 offen offset:0 sc1 lds
  v_fract_f32 v116, v116
  v_fract_f32 v117, v117
  v_fract_f32 v118, v118
  buffer_load_dwordx4 v2, s[12:15], s84 offen offset:1024 sc1 lds
  v_fract_f32 v119, v119
  v_fract_f32 v120, v120
  v_fract_f32 v121, v121
  buffer_load_dwordx4 v2, s[12:15], s84 offen offset:2048 sc1 lds
  v_fract_f32 v122, v122
  v_fract_f32 v123, v123
  v_cos_f32 v116, v116
  buffer_load_dwordx4 v2, s[12:15], s84 offen offset:3072 sc1 lds
  v_cos_f32 v117, v117
  v_cos_f32 v118, v118
  v_cos_f32 v119, v119
  s_add_u32 s85, s47, s83
  s_mov_b32 m0, s59
  s_nop 0
  buffer_load_dwordx4 v4, s[60:63], s85 offen offset:0 lds
  v_cos_f32 v120, v120
  v_cos_f32 v121, v121
  v_cos_f32 v122, v122
  buffer_load_dwordx4 v5, s[60:63], s85 offen offset:1024 lds
  v_cos_f32 v123, v123
  s_nop 0
  v_cvt_pk_bf16_f32 v64, v116, v117
  buffer_load_dwordx4 v6, s[60:63], s85 offen offset:2048 lds
  v_cvt_pk_bf16_f32 v65, v118, v119
  v_cvt_pk_bf16_f32 v66, v120, v121
  v_cvt_pk_bf16_f32 v67, v122, v123
  buffer_load_dwordx4 v7, s[60:63], s85 offen offset:3072 lds
  v_fmamk_f32 v116, v112, 0x43100000, v113
  v_fmamk_f32 v117, v112, 0x43100000, v114
  v_fmamk_f32 v118, v112, 0x43110000, v113
  s_waitcnt vmcnt(16)
  s_barrier
  s_add_u32 s46, s46, 65536
  s_add_u32 s47, s47, 524288
  s_add_u32 s50, s50, 1
  s_cmp_eq_u32 s50, 7
  s_cselect_b32 s45, 458752, 0
  s_sub_u32 s46, s46, s45
  s_cmp_eq_u32 s50, 7
  s_cselect_b32 s45, 3670016, 0
  s_sub_u32 s47, s47, s45
  s_cmp_eq_u32 s50, 7
  s_cselect_b32 s50, 0, s50
  s_add_u32 s84, s46, s76
  s_mov_b32 m0, s52
  s_nop 0
  buffer_load_dwordx4 v2, s[12:15], s84 offen offset:0 sc1 lds
  v_fmamk_f32 v119, v112, 0x43110000, v114
  v_fmamk_f32 v120, v112, 0x43180000, v113
  v_fmamk_f32 v121, v112, 0x43180000, v114
  buffer_load_dwordx4 v2, s[12:15], s84 offen offset:1024 sc1 lds
  v_fmamk_f32 v122, v112, 0x43190000, v113
  v_fmamk_f32 v123, v112, 0x43190000, v114
  v_fract_f32 v116, v116
  buffer_load_dwordx4 v2, s[12:15], s84 offen offset:2048 sc1 lds
  v_fract_f32 v117, v117
  v_fract_f32 v118, v118
  v_fract_f32 v119, v119
  buffer_load_dwordx4 v2, s[12:15], s84 offen offset:3072 sc1 lds
  v_fract_f32 v120, v120
  v_fract_f32 v121, v121
  v_fract_f32 v122, v122
  s_add_u32 s85, s47, s80
  s_mov_b32 m0, s53
  s_nop 0
  buffer_load_dwordx4 v4, s[60:63], s85 offen offset:0 lds
  v_fract_f32 v123, v123
  v_cos_f32 v116, v116
  v_cos_f32 v117, v117
  buffer_load_dwordx4 v5, s[60:63], s85 offen offset:1024 lds
  v_cos_f32 v118, v118
  v_cos_f32 v119, v119
  v_cos_f32 v120, v120
  buffer_load_dwordx4 v6, s[60:63], s85 offen offset:2048 lds
  v_cos_f32 v121, v121
  v_cos_f32 v122, v122
  v_cos_f32 v123, v123
  buffer_load_dwordx4 v7, s[60:63], s85 offen offset:3072 lds
  s_nop 0
  v_cvt_pk_bf16_f32 v68, v116, v117
  v_cvt_pk_bf16_f32 v69, v118, v119
  s_waitcnt vmcnt(16)
  s_barrier
  s_add_u32 s84, s46, s77
  s_mov_b32 m0, s54
  s_nop 0
  buffer_load_dwordx4 v2, s[12:15], s84 offen offset:0 sc1 lds
  v_cvt_pk_bf16_f32 v70, v120, v121
  v_cvt_pk_bf16_f32 v71, v122, v123
  v_fmamk_f32 v116, v112, 0x43200000, v113
  buffer_load_dwordx4 v2, s[12:15], s84 offen offset:1024 sc1 lds
  v_fmamk_f32 v117, v112, 0x43200000, v114
  v_fmamk_f32 v118, v112, 0x43210000, v113
  v_fmamk_f32 v119, v112, 0x43210000, v114
  buffer_load_dwordx4 v2, s[12:15], s84 offen offset:2048 sc1 lds
  v_fmamk_f32 v120, v112, 0x43280000, v113
  v_fmamk_f32 v121, v112, 0x43280000, v114
  v_fmamk_f32 v122, v112, 0x43290000, v113
  buffer_load_dwordx4 v2, s[12:15], s84 offen offset:3072 sc1 lds
  v_fmamk_f32 v123, v112, 0x43290000, v114
  v_fract_f32 v116, v116
  v_fract_f32 v117, v117
  s_add_u32 s85, s47, s81
  s_mov_b32 m0, s55
  s_nop 0
  buffer_load_dwordx4 v4, s[60:63], s85 offen offset:0 lds
  v_fract_f32 v118, v118
  v_fract_f32 v119, v119
  v_fract_f32 v120, v120
  buffer_load_dwordx4 v5, s[60:63], s85 offen offset:1024 lds
  v_fract_f32 v121, v121
  v_fract_f32 v122, v122
  v_fract_f32 v123, v123
  buffer_load_dwordx4 v6, s[60:63], s85 offen offset:2048 lds
  v_cos_f32 v116, v116
  v_cos_f32 v117, v117
  v_cos_f32 v118, v118
  buffer_load_dwordx4 v7, s[60:63], s85 offen offset:3072 lds
  v_cos_f32 v119, v119
  v_cos_f32 v120, v120
  v_cos_f32 v121, v121
  s_waitcnt vmcnt(16)
  s_barrier
  s_add_u32 s84, s46, s78
  s_mov_b32 m0, s56
  s_nop 0
  buffer_load_dwordx4 v2, s[12:15], s84 offen offset:0 sc1 lds
  v_cos_f32 v122, v122
  v_cos_f32 v123, v123
  s_nop 0
  buffer_load_dwordx4 v2, s[12:15], s84 offen offset:1024 sc1 lds
  v_cvt_pk_bf16_f32 v72, v116, v117
  v_cvt_pk_bf16_f32 v73, v118, v119
  v_cvt_pk_bf16_f32 v74, v120, v121
  buffer_load_dwordx4 v2, s[12:15], s84 offen offset:2048 sc1 lds
  v_cvt_pk_bf16_f32 v75, v122, v123
  v_fmamk_f32 v116, v112, 0x43300000, v113
  v_fmamk_f32 v117, v112, 0x43300000, v114
  buffer_load_dwordx4 v2, s[12:15], s84 offen offset:3072 sc1 lds
  v_fmamk_f32 v118, v112, 0x43310000, v113
  v_fmamk_f32 v119, v112, 0x43310000, v114
  v_fmamk_f32 v120, v112, 0x43380000, v113
  s_add_u32 s85, s47, s82
  s_mov_b32 m0, s57
  s_nop 0
  buffer_load_dwordx4 v4, s[60:63], s85 offen offset:0 lds
  v_fmamk_f32 v121, v112, 0x43380000, v114
  v_fmamk_f32 v122, v112, 0x43390000, v113
  v_fmamk_f32 v123, v112, 0x43390000, v114
  buffer_load_dwordx4 v5, s[60:63], s85 offen offset:1024 lds
  v_fract_f32 v116, v116
  v_fract_f32 v117, v117
  v_fract_f32 v118, v118
  buffer_load_dwordx4 v6, s[60:63], s85 offen offset:2048 lds
  v_fract_f32 v119, v119
  v_fract_f32 v120, v120
  v_fract_f32 v121, v121
  buffer_load_dwordx4 v7, s[60:63], s85 offen offset:3072 lds
  v_fract_f32 v122, v122
  v_fract_f32 v123, v123
  v_cos_f32 v116, v116
  s_waitcnt vmcnt(16)
  s_barrier
  s_add_u32 s84, s46, s79
  s_mov_b32 m0, s58
  s_nop 0
  buffer_load_dwordx4 v2, s[12:15], s84 offen offset:0 sc1 lds
  v_cos_f32 v117, v117
  v_cos_f32 v118, v118
  v_cos_f32 v119, v119
  buffer_load_dwordx4 v2, s[12:15], s84 offen offset:1024 sc1 lds
  v_cos_f32 v120, v120
  v_cos_f32 v121, v121
  v_cos_f32 v122, v122
  buffer_load_dwordx4 v2, s[12:15], s84 offen offset:2048 sc1 lds
  v_cos_f32 v123, v123
  s_nop 0
  v_cvt_pk_bf16_f32 v76, v116, v117
  buffer_load_dwordx4 v2, s[12:15], s84 offen offset:3072 sc1 lds
  v_cvt_pk_bf16_f32 v77, v118, v119
  v_cvt_pk_bf16_f32 v78, v120, v121
  v_cvt_pk_bf16_f32 v79, v122, v123
  s_add_u32 s85, s47, s83
  s_mov_b32 m0, s59
  s_nop 0
  buffer_load_dwordx4 v4, s[60:63], s85 offen offset:0 lds
  v_fmamk_f32 v116, v112, 0x43400000, v113
  v_fmamk_f32 v117, v112, 0x43400000, v114
  v_fmamk_f32 v118, v112, 0x43410000, v113
  buffer_load_dwordx4 v5, s[60:63], s85 offen offset:1024 lds
  v_fmamk_f32 v119, v112, 0x43410000, v114
  v_fmamk_f32 v120, v112, 0x43480000, v113
  v_fmamk_f32 v121, v112, 0x43480000, v114
  buffer_load_dwordx4 v6, s[60:63], s85 offen offset:2048 lds
  v_fmamk_f32 v122, v112, 0x43490000, v113
  v_fmamk_f32 v123, v112, 0x43490000, v114
  v_fract_f32 v116, v116
  buffer_load_dwordx4 v7, s[60:63], s85 offen offset:3072 lds
  v_fract_f32 v117, v117
  v_fract_f32 v118, v118
  v_fract_f32 v119, v119
  s_waitcnt vmcnt(16)
  s_barrier
  s_add_u32 s46, s46, 65536
  s_add_u32 s47, s47, 524288
  s_add_u32 s50, s50, 1
  s_cmp_eq_u32 s50, 7
  s_cselect_b32 s45, 458752, 0
  s_sub_u32 s46, s46, s45
  s_cmp_eq_u32 s50, 7
  s_cselect_b32 s45, 3670016, 0
  s_sub_u32 s47, s47, s45
  s_cmp_eq_u32 s50, 7
  s_cselect_b32 s50, 0, s50
  s_add_u32 s84, s46, s76
  s_mov_b32 m0, s52
  s_nop 0
  buffer_load_dwordx4 v2, s[12:15], s84 offen offset:0 sc1 lds
  v_fract_f32 v120, v120
  v_fract_f32 v121, v121
  v_fract_f32 v122, v122
  buffer_load_dwordx4 v2, s[12:15], s84 offen offset:1024 sc1 lds
  v_fract_f32 v123, v123
  v_cos_f32 v116, v116
  v_cos_f32 v117, v117
  buffer_load_dwordx4 v2, s[12:15], s84 offen offset:2048 sc1 lds
  v_cos_f32 v118, v118
  v_cos_f32 v119, v119
  v_cos_f32 v120, v120
  buffer_load_dwordx4 v2, s[12:15], s84 offen offset:3072 sc1 lds
  v_cos_f32 v121, v121
  v_cos_f32 v122, v122
  v_cos_f32 v123, v123
  s_add_u32 s85, s47, s80
  s_mov_b32 m0, s53
  s_nop 0
  buffer_load_dwordx4 v4, s[60:63], s85 offen offset:0 lds
  s_nop 0
  v_cvt_pk_bf16_f32 v80, v116, v117
  v_cvt_pk_bf16_f32 v81, v118, v119
  buffer_load_dwordx4 v5, s[60:63], s85 offen offset:1024 lds
  v_cvt_pk_bf16_f32 v82, v120, v121
  v_cvt_pk_bf16_f32 v83, v122, v123
  v_fmamk_f32 v116, v112, 0x43500000, v113
  buffer_load_dwordx4 v6, s[60:63], s85 offen offset:2048 lds
  v_fmamk_f32 v117, v112, 0x43500000, v114
  v_fmamk_f32 v118, v112, 0x43510000, v113
  v_fmamk_f32 v119, v112, 0x43510000, v114
  buffer_load_dwordx4 v7, s[60:63], s85 offen offset:3072 lds
  v_fmamk_f32 v120, v112, 0x43580000, v113
  v_fmamk_f32 v121, v112, 0x43580000, v114
  v_fmamk_f32 v122, v112, 0x43590000, v113
  s_waitcnt vmcnt(16)
  s_barrier
  s_add_u32 s84, s46, s77
  s_mov_b32 m0, s54
  s_nop 0
  buffer_load_dwordx4 v2, s[12:15], s84 offen offset:0 sc1 lds
  v_fmamk_f32 v123, v112, 0x43590000, v114
  v_fract_f32 v116, v116
  v_fract_f32 v117, v117
  buffer_load_dwordx4 v2, s[12:15], s84 offen offset:1024 sc1 lds
  v_fract_f32 v118, v118
  v_fract_f32 v119, v119
  v_fract_f32 v120, v120
  buffer_load_dwordx4 v2, s[12:15], s84 offen offset:2048 sc1 lds
  v_fract_f32 v121, v121
  v_fract_f32 v122, v122
  v_fract_f32 v123, v123
  buffer_load_dwordx4 v2, s[12:15], s84 offen offset:3072 sc1 lds
  v_cos_f32 v116, v116
  v_cos_f32 v117, v117
  v_cos_f32 v118, v118
  s_add_u32 s85, s47, s81
  s_mov_b32 m0, s55
  s_nop 0
  buffer_load_dwordx4 v4, s[60:63], s85 offen offset:0 lds
  v_cos_f32 v119, v119
  v_cos_f32 v120, v120
  v_cos_f32 v121, v121
  buffer_load_dwordx4 v5, s[60:63], s85 offen offset:1024 lds
  v_cos_f32 v122, v122
  v_cos_f32 v123, v123
  s_nop 0
  buffer_load_dwordx4 v6, s[60:63], s85 offen offset:2048 lds
  v_cvt_pk_bf16_f32 v84, v116, v117
  v_cvt_pk_bf16_f32 v85, v118, v119
  v_cvt_pk_bf16_f32 v86, v120, v121
  buffer_load_dwordx4 v7, s[60:63], s85 offen offset:3072 lds
  v_cvt_pk_bf16_f32 v87, v122, v123
  v_fmamk_f32 v116, v112, 0x43600000, v113
  v_fmamk_f32 v117, v112, 0x43600000, v114
  s_waitcnt vmcnt(16)
  s_barrier
  s_add_u32 s84, s46, s78
  s_mov_b32 m0, s56
  s_nop 0
  buffer_load_dwordx4 v2, s[12:15], s84 offen offset:0 sc1 lds
  v_fmamk_f32 v118, v112, 0x43610000, v113
  v_fmamk_f32 v119, v112, 0x43610000, v114
  v_fmamk_f32 v120, v112, 0x43680000, v113
  buffer_load_dwordx4 v2, s[12:15], s84 offen offset:1024 sc1 lds
  v_fmamk_f32 v121, v112, 0x43680000, v114
  v_fmamk_f32 v122, v112, 0x43690000, v113
  v_fmamk_f32 v123, v112, 0x43690000, v114
  buffer_load_dwordx4 v2, s[12:15], s84 offen offset:2048 sc1 lds
  v_fract_f32 v116, v116
  v_fract_f32 v117, v117
  v_fract_f32 v118, v118
  buffer_load_dwordx4 v2, s[12:15], s84 offen offset:3072 sc1 lds
  v_fract_f32 v119, v119
  v_fract_f32 v120, v120
  v_fract_f32 v121, v121
  s_add_u32 s85, s47, s82
  s_mov_b32 m0, s57
  s_nop 0
  buffer_load_dwordx4 v4, s[60:63], s85 offen offset:0 lds
  v_fract_f32 v122, v122
  v_fract_f32 v123, v123
  v_cos_f32 v116, v116
  buffer_load_dwordx4 v5, s[60:63], s85 offen offset:1024 lds
  v_cos_f32 v117, v117
  v_cos_f32 v118, v118
  v_cos_f32 v119, v119
  buffer_load_dwordx4 v6, s[60:63], s85 offen offset:2048 lds
  v_cos_f32 v120, v120
  v_cos_f32 v121, v121
  v_cos_f32 v122, v122
  buffer_load_dwordx4 v7, s[60:63], s85 offen offset:3072 lds
  v_cos_f32 v123, v123
  s_nop 0
  v_cvt_pk_bf16_f32 v88, v116, v117
  s_waitcnt vmcnt(16)
  s_barrier
  s_add_u32 s84, s46, s79
  s_mov_b32 m0, s58
  s_nop 0
  buffer_load_dwordx4 v2, s[12:15], s84 offen offset:0 sc1 lds
  v_cvt_pk_bf16_f32 v89, v118, v119
  v_cvt_pk_bf16_f32 v90, v120, v121
  v_cvt_pk_bf16_f32 v91, v122, v123
  buffer_load_dwordx4 v2, s[12:15], s84 offen offset:1024 sc1 lds
  v_fmamk_f32 v116, v112, 0x43700000, v113
  v_fmamk_f32 v117, v112, 0x43700000, v114
  v_fmamk_f32 v118, v112, 0x43710000, v113
  buffer_load_dwordx4 v2, s[12:15], s84 offen offset:2048 sc1 lds
  v_fmamk_f32 v119, v112, 0x43710000, v114
  v_fmamk_f32 v120, v112, 0x43780000, v113
  v_fmamk_f32 v121, v112, 0x43780000, v114
  buffer_load_dwordx4 v2, s[12:15], s84 offen offset:3072 sc1 lds
  v_fmamk_f32 v122, v112, 0x43790000, v113
  v_fmamk_f32 v123, v112, 0x43790000, v114
  v_fract_f32 v116, v116
  s_add_u32 s85, s47, s83
  s_mov_b32 m0, s59
  s_nop 0
  buffer_load_dwordx4 v4, s[60:63], s85 offen offset:0 lds
  v_fract_f32 v117, v117
  v_fract_f32 v118, v118
  v_fract_f32 v119, v119
  buffer_load_dwordx4 v5, s[60:63], s85 offen offset:1024 lds
  v_fract_f32 v120, v120
  v_fract_f32 v121, v121
  v_fract_f32 v122, v122
  buffer_load_dwordx4 v6, s[60:63], s85 offen offset:2048 lds
  v_fract_f32 v123, v123
  v_cos_f32 v116, v116
  v_cos_f32 v117, v117
  buffer_load_dwordx4 v7, s[60:63], s85 offen offset:3072 lds
  v_cos_f32 v118, v118
  v_cos_f32 v119, v119
  v_cos_f32 v120, v120
  s_waitcnt vmcnt(16)
  s_barrier
  s_add_u32 s46, s46, 65536
  s_add_u32 s47, s47, 524288
  s_add_u32 s50, s50, 1
  s_cmp_eq_u32 s50, 7
  s_cselect_b32 s45, 458752, 0
  s_sub_u32 s46, s46, s45
  s_cmp_eq_u32 s50, 7
  s_cselect_b32 s45, 3670016, 0
  s_sub_u32 s47, s47, s45
  s_cmp_eq_u32 s50, 7
  s_cselect_b32 s50, 0, s50
  s_add_u32 s84, s46, s76
  s_mov_b32 m0, s52
  s_nop 0
  buffer_load_dwordx4 v2, s[12:15], s84 offen offset:0 sc1 lds
  v_cos_f32 v121, v121
  v_cos_f32 v122, v122
  v_cos_f32 v123, v123
  buffer_load_dwordx4 v2, s[12:15], s84 offen offset:1024 sc1 lds
  s_nop 0
  v_cvt_pk_bf16_f32 v92, v116, v117
  v_cvt_pk_bf16_f32 v93, v118, v119
  buffer_load_dwordx4 v2, s[12:15], s84 offen offset:2048 sc1 lds
  v_cvt_pk_bf16_f32 v94, v120, v121
  v_cvt_pk_bf16_f32 v95, v122, v123
  s_lshl_b32 s35, s31, 10
  buffer_load_dwordx4 v2, s[12:15], s84 offen offset:3072 sc1 lds
  s_add_u32 s35, s35, 131072
  v_lshlrev_b32 v12, 4, v106
  v_add_u32 v12, s35, v12
  s_add_u32 s85, s47, s80
  s_mov_b32 m0, s53
  s_nop 0
  buffer_load_dwordx4 v4, s[60:63], s85 offen offset:0 lds
  buffer_load_dwordx4 v5, s[60:63], s85 offen offset:1024 lds
  buffer_load_dwordx4 v6, s[60:63], s85 offen offset:2048 lds
  buffer_load_dwordx4 v7, s[60:63], s85 offen offset:3072 lds
  v_lshrrev_b32 v14, 4, v0
  v_lshlrev_b32 v14, 7, v14
  v_and_b32 v15, 15, v0
  v_lshl_add_u32 v14, v15, 2, v14
  s_mov_b32 s44, 34816
  buffer_load_dword v96, v14, s[16:19], s44 offen offset:0 sc1
  buffer_load_dword v97, v14, s[16:19], s44 offen offset:512 sc1
  buffer_load_dword v98, v14, s[16:19], s44 offen offset:1024 sc1
  buffer_load_dword v99, v14, s[16:19], s44 offen offset:1536 sc1
  s_waitcnt vmcnt(20)
  s_barrier
  s_add_u32 s84, s46, s77
  s_mov_b32 m0, s54
  s_nop 0
  buffer_load_dwordx4 v2, s[12:15], s84 offen offset:0 sc1 lds
  buffer_load_dwordx4 v2, s[12:15], s84 offen offset:1024 sc1 lds
  buffer_load_dwordx4 v2, s[12:15], s84 offen offset:2048 sc1 lds
  buffer_load_dwordx4 v2, s[12:15], s84 offen offset:3072 sc1 lds
  s_add_u32 s85, s47, s81
  s_mov_b32 m0, s55
  s_nop 0
  buffer_load_dwordx4 v4, s[60:63], s85 offen offset:0 lds
  buffer_load_dwordx4 v5, s[60:63], s85 offen offset:1024 lds
  buffer_load_dwordx4 v6, s[60:63], s85 offen offset:2048 lds
  buffer_load_dwordx4 v7, s[60:63], s85 offen offset:3072 lds
  s_waitcnt vmcnt(20)
  s_barrier
  s_add_u32 s84, s46, s78
  s_mov_b32 m0, s56
  s_nop 0
  buffer_load_dwordx4 v2, s[12:15], s84 offen offset:0 sc1 lds
  buffer_load_dwordx4 v2, s[12:15], s84 offen offset:1024 sc1 lds
  buffer_load_dwordx4 v2, s[12:15], s84 offen offset:2048 sc1 lds
  buffer_load_dwordx4 v2, s[12:15], s84 offen offset:3072 sc1 lds
  s_add_u32 s85, s47, s82
  s_mov_b32 m0, s57
  s_nop 0
  buffer_load_dwordx4 v4, s[60:63], s85 offen offset:0 lds
  buffer_load_dwordx4 v5, s[60:63], s85 offen offset:1024 lds
  buffer_load_dwordx4 v6, s[60:63], s85 offen offset:2048 lds
  buffer_load_dwordx4 v7, s[60:63], s85 offen offset:3072 lds
  s_waitcnt vmcnt(20)
  s_barrier
  s_add_u32 s84, s46, s79
  s_mov_b32 m0, s58
  s_nop 0
  buffer_load_dwordx4 v2, s[12:15], s84 offen offset:0 sc1 lds
  buffer_load_dwordx4 v2, s[12:15], s84 offen offset:1024 sc1 lds
  buffer_load_dwordx4 v2, s[12:15], s84 offen offset:2048 sc1 lds
  buffer_load_dwordx4 v2, s[12:15], s84 offen offset:3072 sc1 lds
  s_add_u32 s85, s47, s83
  s_mov_b32 m0, s59
  s_nop 0
  buffer_load_dwordx4 v4, s[60:63], s85 offen offset:0 lds
  buffer_load_dwordx4 v5, s[60:63], s85 offen offset:1024 lds
  buffer_load_dwordx4 v6, s[60:63], s85 offen offset:2048 lds
  buffer_load_dwordx4 v7, s[60:63], s85 offen offset:3072 lds
  s_waitcnt vmcnt(16)
  s_barrier
  v_xor_b32 v96, s1, v96
  v_xor_b32 v97, s1, v97
  v_xor_b32 v98, s1, v98
  v_xor_b32 v99, s1, v99
  v_or_b32 v100, v96, v97
  v_or3_b32 v100, v100, v98, v99
  v_and_b32 v100, 0x0fffffff, v100
  v_cmp_ne_u32 vcc, 0, v100
  s_nop 1
  s_cmp_eq_u64 vcc, 0
  s_cbranch_scc1 P3_t_ok
  s_mov_b32 s49, 0
P3_pollt:
  buffer_load_dword v96, v14, s[16:19], s44 offen offset:0 sc1
  buffer_load_dword v97, v14, s[16:19], s44 offen offset:512 sc1
  buffer_load_dword v98, v14, s[16:19], s44 offen offset:1024 sc1
  buffer_load_dword v99, v14, s[16:19], s44 offen offset:1536 sc1
  s_waitcnt vmcnt(0)
  v_xor_b32 v96, s1, v96
  v_xor_b32 v97, s1, v97
  v_xor_b32 v98, s1, v98
  v_xor_b32 v99, s1, v99
  v_or_b32 v100, v96, v97
  v_or3_b32 v100, v100, v98, v99
  v_and_b32 v100, 0x0fffffff, v100
  v_cmp_ne_u32 vcc, 0, v100
  s_nop 1
  s_cmp_eq_u64 vcc, 0
  s_cbranch_scc1 P3_pollt_ok
  s_add_u32 s49, s49, 1
  s_cmp_lt_u32 s49, 1048576
  s_cbranch_scc0 P3_pollt_ok
  s_sleep 1
  s_branch P3_pollt
P3_pollt_ok:
P3_t_ok:
  s_add_u32 m0, s75, 16384
  s_add_u32 s85, s51, 0
  buffer_load_dwordx4 v4, s[64:67], s85 offen offset:0 sc1 lds
  buffer_load_dwordx4 v5, s[64:67], s85 offen offset:1024 sc1 lds
  buffer_load_dwordx4 v6, s[64:67], s85 offen offset:2048 sc1 lds
  buffer_load_dwordx4 v7, s[64:67], s85 offen offset:3072 sc1 lds
  s_add_u32 m0, s75, 0
  s_add_u32 s85, s51, 131072
  buffer_load_dwordx4 v4, s[64:67], s85 offen offset:0 sc1 lds
  buffer_load_dwordx4 v5, s[64:67], s85 offen offset:1024 sc1 lds
  buffer_load_dwordx4 v6, s[64:67], s85 offen offset:2048 sc1 lds
  buffer_load_dwordx4 v7, s[64:67], s85 offen offset:3072 sc1 lds
  ds_write_b128 v12, v[32:35] offset:0
  ds_write_b128 v12, v[36:39] offset:4096
  s_waitcnt vmcnt(16) lgkmcnt(0)
  s_barrier
  s_add_u32 m0, s75, 49152
  s_add_u32 s85, s51, 262144
  buffer_load_dwordx4 v4, s[64:67], s85 offen offset:0 sc1 lds
  buffer_load_dwordx4 v5, s[64:67], s85 offen offset:1024 sc1 lds
  buffer_load_dwordx4 v6, s[64:67], s85 offen offset:2048 sc1 lds
  buffer_load_dwordx4 v7, s[64:67], s85 offen offset:3072 sc1 lds
  s_add_u32 m0, s75, 32768
  s_add_u32 s85, s51, 393216
  buffer_load_dwordx4 v4, s[64:67], s85 offen offset:0 sc1 lds
  buffer_load_dwordx4 v5, s[64:67], s85 offen offset:1024 sc1 lds
  buffer_load_dwordx4 v6, s[64:67], s85 offen offset:2048 sc1 lds
  buffer_load_dwordx4 v7, s[64:67], s85 offen offset:3072 sc1 lds
  ds_write_b128 v12, v[40:43] offset:8192
  ds_write_b128 v12, v[44:47] offset:12288
  s_waitcnt vmcnt(16) lgkmcnt(0)
  s_barrier
  s_add_u32 m0, s75, 81920
  s_add_u32 s85, s51, 524288
  buffer_load_dwordx4 v4, s[64:67], s85 offen offset:0 sc1 lds
  buffer_load_dwordx4 v5, s[64:67], s85 offen offset:1024 sc1 lds
  buffer_load_dwordx4 v6, s[64:67], s85 offen offset:2048 sc1 lds
  buffer_load_dwordx4 v7, s[64:67], s85 offen offset:3072 sc1 lds
  s_add_u32 m0, s75, 65536
  s_add_u32 s85, s51, 655360
  buffer_load_dwordx4 v4, s[64:67], s85 offen offset:0 sc1 lds
  buffer_load_dwordx4 v5, s[64:67], s85 offen offset:1024 sc1 lds
  buffer_load_dwordx4 v6, s[64:67], s85 offen offset:2048 sc1 lds
  buffer_load_dwordx4 v7, s[64:67], s85 offen offset:3072 sc1 lds
  ds_write_b128 v12, v[48:51] offset:16384
  ds_write_b128 v12, v[52:55] offset:20480
  s_waitcnt vmcnt(16) lgkmcnt(0)
  s_barrier
  s_add_u32 m0, s75, 114688
  s_add_u32 s85, s51, 786432
  buffer_load_dwordx4 v4, s[64:67], s85 offen offset:0 sc1 lds
  buffer_load_dwordx4 v5, s[64:67], s85 offen offset:1024 sc1 lds
  buffer_load_dwordx4 v6, s[64:67], s85 offen offset:2048 sc1 lds
  buffer_load_dwordx4 v7, s[64:67], s85 offen offset:3072 sc1 lds
  s_add_u32 m0, s75, 98304
  s_add_u32 s85, s51, 917504
  buffer_load_dwordx4 v4, s[64:67], s85 offen offset:0 sc1 lds
  buffer_load_dwordx4 v5, s[64:67], s85 offen offset:1024 sc1 lds
  buffer_load_dwordx4 v6, s[64:67], s85 offen offset:2048 sc1 lds
  buffer_load_dwordx4 v7, s[64:67], s85 offen offset:3072 sc1 lds
  ds_write_b128 v12, v[56:59] offset:24576
  ds_write_b128 v12, v[60:63] offset:28672
  s_waitcnt vmcnt(16) lgkmcnt(0)
  s_barrier
  s_waitcnt lgkmcnt(0)
  s_barrier
  ds_write_b128 v12, v[64:67] offset:0
  ds_write_b128 v12, v[68:71] offset:4096
  s_waitcnt vmcnt(8) lgkmcnt(0)
  s_barrier
  ds_write_b128 v12, v[72:75] offset:8192
  ds_write_b128 v12, v[76:79] offset:12288
  s_waitcnt lgkmcnt(0)
  s_barrier
  ds_write_b128 v12, v[80:83] offset:16384
  ds_write_b128 v12, v[84:87] offset:20480
  s_waitcnt vmcnt(0) lgkmcnt(0)
  s_barrier
  ds_write_b128 v12, v[88:91] offset:24576
  ds_write_b128 v12, v[92:95] offset:28672
  s_waitcnt lgkmcnt(0)
  s_barrier
  s_waitcnt lgkmcnt(0)
  s_barrier
  s_waitcnt lgkmcnt(0)
  s_barrier
  s_branch MG_end
P2_special_w:
  s_waitcnt vmcnt(0)
  s_mov_b64 exec, 1
  v_accvgpr_read_b32 v136, a32
  v_accvgpr_read_b32 v137, a48
  v_accvgpr_read_b32 v138, a64
  v_accvgpr_read_b32 v139, a65
  v_add_f32 v136, v136, v138
  v_sub_f32 v137, v137, v139
  v_mul_f32 v136, 0.5, v136
  v_mul_f32 v137, 0.5, v137
  v_accvgpr_write_b32 a32, v136
  v_accvgpr_write_b32 a48, v137
  v_accvgpr_read_b32 v136, a40
  v_accvgpr_read_b32 v137, a56
  v_accvgpr_read_b32 v138, a66
  v_accvgpr_read_b32 v139, a67
  v_add_f32 v136, v136, v138
  v_sub_f32 v137, v137, v139
  v_mul_f32 v136, 0.5, v136
  v_mul_f32 v137, 0.5, v137
  v_accvgpr_write_b32 a40, v136
  v_accvgpr_write_b32 a56, v137
  s_mov_b64 exec, -1
  v_and_b32 v136, 31, v0
  v_lshrrev_b32 v137, 5, v0
  v_lshl_add_u32 v136, v137, 7, v136
  v_lshlrev_b32 v138, 2, v136
  v_add_u32 v138, 147712, v138
  ds_write_b32 v138, v104 offset:0
  ds_write_b32 v138, v120 offset:4352
  ds_write_b32 v138, v105 offset:128
  ds_write_b32 v138, v121 offset:4480
  ds_write_b32 v138, v106 offset:256
  ds_write_b32 v138, v122 offset:4608
  ds_write_b32 v138, v107 offset:384
  ds_write_b32 v138, v123 offset:4736
  ds_write_b32 v138, v108 offset:1024
  ds_write_b32 v138, v124 offset:5376
  ds_write_b32 v138, v109 offset:1152
  ds_write_b32 v138, v125 offset:5504
  ds_write_b32 v138, v110 offset:1280
  ds_write_b32 v138, v126 offset:5632
  ds_write_b32 v138, v111 offset:1408
  ds_write_b32 v138, v127 offset:5760
  ds_write_b32 v138, v112 offset:2048
  ds_write_b32 v138, v128 offset:6400
  ds_write_b32 v138, v113 offset:2176
  ds_write_b32 v138, v129 offset:6528
  ds_write_b32 v138, v114 offset:2304
  ds_write_b32 v138, v130 offset:6656
  ds_write_b32 v138, v115 offset:2432
  ds_write_b32 v138, v131 offset:6784
  ds_write_b32 v138, v116 offset:3072
  ds_write_b32 v138, v132 offset:7424
  ds_write_b32 v138, v117 offset:3200
  ds_write_b32 v138, v133 offset:7552
  ds_write_b32 v138, v118 offset:3328
  ds_write_b32 v138, v134 offset:7680
  ds_write_b32 v138, v119 offset:3456
  ds_write_b32 v138, v135 offset:7808
  s_mov_b64 exec, 1
  ds_write_b32 v138, v104 offset:4096
  ds_write_b32 v138, v120 offset:8448
  s_mov_b64 exec, -1
  v_sub_u32 v139, 160, v136
  v_lshlrev_b32 v139, 2, v139
  v_add_u32 v139, 147712, v139
  s_waitcnt lgkmcnt(0)
  ds_read_b32 v140, v139 offset:3456
  ds_read_b32 v141, v139 offset:7808
  v_accvgpr_read_b32 v142, a32
  v_accvgpr_read_b32 v143, a48
  s_waitcnt lgkmcnt(0)
  v_add_f32 v144, v104, v140
  v_sub_f32 v145, v120, v141
  v_sub_f32 v146, v104, v140
  v_add_f32 v147, v120, v141
  v_mul_f32 v104, v144, v20
  v_fma_f32 v104, -v145, v36, v104
  v_fma_f32 v104, v146, v142, v104
  v_fma_f32 v104, -v147, v143, v104
  v_mul_f32 v120, v145, v20
  v_fma_f32 v120, v144, v36, v120
  v_fma_f32 v120, v147, v142, v120
  v_fma_f32 v120, v146, v143, v120
  v_mul_f32 v104, 0.5, v104
  v_mul_f32 v120, 0.5, v120
  ds_read_b32 v140, v139 offset:3328
  ds_read_b32 v141, v139 offset:7680
  v_accvgpr_read_b32 v142, a33
  v_accvgpr_read_b32 v143, a49
  s_waitcnt lgkmcnt(0)
  v_add_f32 v144, v105, v140
  v_sub_f32 v145, v121, v141
  v_sub_f32 v146, v105, v140
  v_add_f32 v147, v121, v141
  v_mul_f32 v105, v144, v21
  v_fma_f32 v105, -v145, v37, v105
  v_fma_f32 v105, v146, v142, v105
  v_fma_f32 v105, -v147, v143, v105
  v_mul_f32 v121, v145, v21
  v_fma_f32 v121, v144, v37, v121
  v_fma_f32 v121, v147, v142, v121
  v_fma_f32 v121, v146, v143, v121
  v_mul_f32 v105, 0.5, v105
  v_mul_f32 v121, 0.5, v121
  ds_read_b32 v140, v139 offset:3200
  ds_read_b32 v141, v139 offset:7552
  v_accvgpr_read_b32 v142, a34
  v_accvgpr_read_b32 v143, a50
  s_waitcnt lgkmcnt(0)
  v_add_f32 v144, v106, v140
  v_sub_f32 v145, v122, v141
  v_sub_f32 v146, v106, v140
  v_add_f32 v147, v122, v141
  v_mul_f32 v106, v144, v22
  v_fma_f32 v106, -v145, v38, v106
  v_fma_f32 v106, v146, v142, v106
  v_fma_f32 v106, -v147, v143, v106
  v_mul_f32 v122, v145, v22
  v_fma_f32 v122, v144, v38, v122
  v_fma_f32 v122, v147, v142, v122
  v_fma_f32 v122, v146, v143, v122
  v_mul_f32 v106, 0.5, v106
  v_mul_f32 v122, 0.5, v122
  ds_read_b32 v140, v139 offset:3072
  ds_read_b32 v141, v139 offset:7424
  v_accvgpr_read_b32 v142, a35
  v_accvgpr_read_b32 v143, a51
  s_waitcnt lgkmcnt(0)
  v_add_f32 v144, v107, v140
  v_sub_f32 v145, v123, v141
  v_sub_f32 v146, v107, v140
  v_add_f32 v147, v123, v141
  v_mul_f32 v107, v144, v23
  v_fma_f32 v107, -v145, v39, v107
  v_fma_f32 v107, v146, v142, v107
  v_fma_f32 v107, -v147, v143, v107
  v_mul_f32 v123, v145, v23
  v_fma_f32 v123, v144, v39, v123
  v_fma_f32 v123, v147, v142, v123
  v_fma_f32 v123, v146, v143, v123
  v_mul_f32 v107, 0.5, v107
  v_mul_f32 v123, 0.5, v123
  ds_read_b32 v140, v139 offset:2432
  ds_read_b32 v141, v139 offset:6784
  v_accvgpr_read_b32 v142, a36
  v_accvgpr_read_b32 v143, a52
  s_waitcnt lgkmcnt(0)
  v_add_f32 v144, v108, v140
  v_sub_f32 v145, v124, v141
  v_sub_f32 v146, v108, v140
  v_add_f32 v147, v124, v141
  v_mul_f32 v108, v144, v24
  v_fma_f32 v108, -v145, v40, v108
  v_fma_f32 v108, v146, v142, v108
  v_fma_f32 v108, -v147, v143, v108
  v_mul_f32 v124, v145, v24
  v_fma_f32 v124, v144, v40, v124
  v_fma_f32 v124, v147, v142, v124
  v_fma_f32 v124, v146, v143, v124
  v_mul_f32 v108, 0.5, v108
  v_mul_f32 v124, 0.5, v124
  ds_read_b32 v140, v139 offset:2304
  ds_read_b32 v141, v139 offset:6656
  v_accvgpr_read_b32 v142, a37
  v_accvgpr_read_b32 v143, a53
  s_waitcnt lgkmcnt(0)
  v_add_f32 v144, v109, v140
  v_sub_f32 v145, v125, v141
  v_sub_f32 v146, v109, v140
  v_add_f32 v147, v125, v141
  v_mul_f32 v109, v144, v25
  v_fma_f32 v109, -v145, v41, v109
  v_fma_f32 v109, v146, v142, v109
  v_fma_f32 v109, -v147, v143, v109
  v_mul_f32 v125, v145, v25
  v_fma_f32 v125, v144, v41, v125
  v_fma_f32 v125, v147, v142, v125
  v_fma_f32 v125, v146, v143, v125
  v_mul_f32 v109, 0.5, v109
  v_mul_f32 v125, 0.5, v125
  ds_read_b32 v140, v139 offset:2176
  ds_read_b32 v141, v139 offset:6528
  v_accvgpr_read_b32 v142, a38
  v_accvgpr_read_b32 v143, a54
  s_waitcnt lgkmcnt(0)
  v_add_f32 v144, v110, v140
  v_sub_f32 v145, v126, v141
  v_sub_f32 v146, v110, v140
  v_add_f32 v147, v126, v141
  v_mul_f32 v110, v144, v26
  v_fma_f32 v110, -v145, v42, v110
  v_fma_f32 v110, v146, v142, v110
  v_fma_f32 v110, -v147, v143, v110
  v_mul_f32 v126, v145, v26
  v_fma_f32 v126, v144, v42, v126
  v_fma_f32 v126, v147, v142, v126
  v_fma_f32 v126, v146, v143, v126
  v_mul_f32 v110, 0.5, v110
  v_mul_f32 v126, 0.5, v126
  ds_read_b32 v140, v139 offset:2048
  ds_read_b32 v141, v139 offset:6400
  v_accvgpr_read_b32 v142, a39
  v_accvgpr_read_b32 v143, a55
  s_waitcnt lgkmcnt(0)
  v_add_f32 v144, v111, v140
  v_sub_f32 v145, v127, v141
  v_sub_f32 v146, v111, v140
  v_add_f32 v147, v127, v141
  v_mul_f32 v111, v144, v27
  v_fma_f32 v111, -v145, v43, v111
  v_fma_f32 v111, v146, v142, v111
  v_fma_f32 v111, -v147, v143, v111
  v_mul_f32 v127, v145, v27
  v_fma_f32 v127, v144, v43, v127
  v_fma_f32 v127, v147, v142, v127
  v_fma_f32 v127, v146, v143, v127
  v_mul_f32 v111, 0.5, v111
  v_mul_f32 v127, 0.5, v127
  ds_read_b32 v140, v139 offset:1408
  ds_read_b32 v141, v139 offset:5760
  v_accvgpr_read_b32 v142, a40
  v_accvgpr_read_b32 v143, a56
  s_waitcnt lgkmcnt(0)
  v_add_f32 v144, v112, v140
  v_sub_f32 v145, v128, v141
  v_sub_f32 v146, v112, v140
  v_add_f32 v147, v128, v141
  v_mul_f32 v112, v144, v28
  v_fma_f32 v112, v145, v44, v112
  v_fma_f32 v112, v146, v142, v112
  v_fma_f32 v112, v147, v143, v112
  v_mul_f32 v128, v145, v28
  v_fma_f32 v128, -v144, v44, v128
  v_fma_f32 v128, v147, v142, v128
  v_fma_f32 v128, -v146, v143, v128
  v_mul_f32 v112, 0.5, v112
  v_mul_f32 v128, 0.5, v128
  ds_read_b32 v140, v139 offset:1280
  ds_read_b32 v141, v139 offset:5632
  v_accvgpr_read_b32 v142, a41
  v_accvgpr_read_b32 v143, a57
  s_waitcnt lgkmcnt(0)
  v_add_f32 v144, v113, v140
  v_sub_f32 v145, v129, v141
  v_sub_f32 v146, v113, v140
  v_add_f32 v147, v129, v141
  v_mul_f32 v113, v144, v29
  v_fma_f32 v113, v145, v45, v113
  v_fma_f32 v113, v146, v142, v113
  v_fma_f32 v113, v147, v143, v113
  v_mul_f32 v129, v145, v29
  v_fma_f32 v129, -v144, v45, v129
  v_fma_f32 v129, v147, v142, v129
  v_fma_f32 v129, -v146, v143, v129
  v_mul_f32 v113, 0.5, v113
  v_mul_f32 v129, 0.5, v129
  ds_read_b32 v140, v139 offset:1152
  ds_read_b32 v141, v139 offset:5504
  v_accvgpr_read_b32 v142, a42
  v_accvgpr_read_b32 v143, a58
  s_waitcnt lgkmcnt(0)
  v_add_f32 v144, v114, v140
  v_sub_f32 v145, v130, v141
  v_sub_f32 v146, v114, v140
  v_add_f32 v147, v130, v141
  v_mul_f32 v114, v144, v30
  v_fma_f32 v114, v145, v46, v114
  v_fma_f32 v114, v146, v142, v114
  v_fma_f32 v114, v147, v143, v114
  v_mul_f32 v130, v145, v30
  v_fma_f32 v130, -v144, v46, v130
  v_fma_f32 v130, v147, v142, v130
  v_fma_f32 v130, -v146, v143, v130
  v_mul_f32 v114, 0.5, v114
  v_mul_f32 v130, 0.5, v130
  ds_read_b32 v140, v139 offset:1024
  ds_read_b32 v141, v139 offset:5376
  v_accvgpr_read_b32 v142, a43
  v_accvgpr_read_b32 v143, a59
  s_waitcnt lgkmcnt(0)
  v_add_f32 v144, v115, v140
  v_sub_f32 v145, v131, v141
  v_sub_f32 v146, v115, v140
  v_add_f32 v147, v131, v141
  v_mul_f32 v115, v144, v31
  v_fma_f32 v115, v145, v47, v115
  v_fma_f32 v115, v146, v142, v115
  v_fma_f32 v115, v147, v143, v115
  v_mul_f32 v131, v145, v31
  v_fma_f32 v131, -v144, v47, v131
  v_fma_f32 v131, v147, v142, v131
  v_fma_f32 v131, -v146, v143, v131
  v_mul_f32 v115, 0.5, v115
  v_mul_f32 v131, 0.5, v131
  ds_read_b32 v140, v139 offset:384
  ds_read_b32 v141, v139 offset:4736
  v_accvgpr_read_b32 v142, a44
  v_accvgpr_read_b32 v143, a60
  s_waitcnt lgkmcnt(0)
  v_add_f32 v144, v116, v140
  v_sub_f32 v145, v132, v141
  v_sub_f32 v146, v116, v140
  v_add_f32 v147, v132, v141
  v_mul_f32 v116, v144, v32
  v_fma_f32 v116, v145, v48, v116
  v_fma_f32 v116, v146, v142, v116
  v_fma_f32 v116, v147, v143, v116
  v_mul_f32 v132, v145, v32
  v_fma_f32 v132, -v144, v48, v132
  v_fma_f32 v132, v147, v142, v132
  v_fma_f32 v132, -v146, v143, v132
  v_mul_f32 v116, 0.5, v116
  v_mul_f32 v132, 0.5, v132
  ds_read_b32 v140, v139 offset:256
  ds_read_b32 v141, v139 offset:4608
  v_accvgpr_read_b32 v142, a45
  v_accvgpr_read_b32 v143, a61
  s_waitcnt lgkmcnt(0)
  v_add_f32 v144, v117, v140
  v_sub_f32 v145, v133, v141
  v_sub_f32 v146, v117, v140
  v_add_f32 v147, v133, v141
  v_mul_f32 v117, v144, v33
  v_fma_f32 v117, v145, v49, v117
  v_fma_f32 v117, v146, v142, v117
  v_fma_f32 v117, v147, v143, v117
  v_mul_f32 v133, v145, v33
  v_fma_f32 v133, -v144, v49, v133
  v_fma_f32 v133, v147, v142, v133
  v_fma_f32 v133, -v146, v143, v133
  v_mul_f32 v117, 0.5, v117
  v_mul_f32 v133, 0.5, v133
  ds_read_b32 v140, v139 offset:128
  ds_read_b32 v141, v139 offset:4480
  v_accvgpr_read_b32 v142, a46
  v_accvgpr_read_b32 v143, a62
  s_waitcnt lgkmcnt(0)
  v_add_f32 v144, v118, v140
  v_sub_f32 v145, v134, v141
  v_sub_f32 v146, v118, v140
  v_add_f32 v147, v134, v141
  v_mul_f32 v118, v144, v34
  v_fma_f32 v118, v145, v50, v118
  v_fma_f32 v118, v146, v142, v118
  v_fma_f32 v118, v147, v143, v118
  v_mul_f32 v134, v145, v34
  v_fma_f32 v134, -v144, v50, v134
  v_fma_f32 v134, v147, v142, v134
  v_fma_f32 v134, -v146, v143, v134
  v_mul_f32 v118, 0.5, v118
  v_mul_f32 v134, 0.5, v134
  ds_read_b32 v140, v139 offset:0
  ds_read_b32 v141, v139 offset:4352
  v_accvgpr_read_b32 v142, a47
  v_accvgpr_read_b32 v143, a63
  s_waitcnt lgkmcnt(0)
  v_add_f32 v144, v119, v140
  v_sub_f32 v145, v135, v141
  v_sub_f32 v146, v119, v140
  v_add_f32 v147, v135, v141
  v_mul_f32 v119, v144, v35
  v_fma_f32 v119, v145, v51, v119
  v_fma_f32 v119, v146, v142, v119
  v_fma_f32 v119, v147, v143, v119
  v_mul_f32 v135, v145, v35
  v_fma_f32 v135, -v144, v51, v135
  v_fma_f32 v135, v147, v142, v135
  v_fma_f32 v135, -v146, v143, v135
  v_mul_f32 v119, 0.5, v119
  v_mul_f32 v135, 0.5, v135
  s_branch P2_w_done
MG_end:
  s_endpgm
.section .rodata,"a"
.p2align 6
.amdhsa_kernel gated_mix__spectral_gfnet__dense_activation_silu__prompt_kernel
  .amdhsa_next_free_vgpr 256
  .amdhsa_next_free_sgpr 102
  .amdhsa_accum_offset 160
  .amdhsa_group_segment_fixed_size 0
  .amdhsa_kernarg_size 80
  .amdhsa_user_sgpr_count 2
  .amdhsa_user_sgpr_kernarg_segment_ptr 1
  .amdhsa_system_sgpr_workgroup_id_x 1
.end_amdhsa_kernel
.text
```
